```python
import torch

def _softmax(x, axis=-1):
    return torch.softmax(x, dim=axis)

def _gelu(x):
    return torch.nn.functional.gelu(x, approximate='tanh')

def _silu(x):
    return torch.nn.functional.silu(x)

def _sigmoid(x):
    return torch.sigmoid(x)

def _layernorm(x, axis=-1, eps=1e-05):
    m = x.mean(dim=axis, keepdim=True)
    v = x.var(dim=axis, keepdim=True, unbiased=False)
    return (x - m) / torch.sqrt(v + eps)

def _scatter_add(tgt, idx, src, axis=0):
    return tgt.clone().index_add_(axis, idx, src)

def _segment_sum(src, seg, n):
    out = torch.zeros((n,) + src.shape[1:], dtype=src.dtype)
    return out.index_add_(0, seg, src)

def _pad(x, pw):
    flat = tuple((v for pair in reversed(pw) for v in pair))
    return torch.nn.functional.pad(x, flat)
kernel_name = 'concat_heads__memory_aug_recurrent_mem_tr__ssm_conv_h3__prompt'

def setup_inputs():

    _w = lambda a: (lambda t: t.to(torch.bfloat16) if t.is_floating_point() else t)(torch.as_tensor(a))

    def _A_setup():
        B, S, Dm = (1, 2048, 1024)
        H, Dh = (32, 128)
        M, seg = (8, 32)
        seg = min(seg, S)
        S = S // seg * seg
        return {'x': _w((lambda *s: torch.randn(*s, dtype=torch.bfloat16) * 0.05)(B, S, Dm)), 'mem0': _w((lambda *s: torch.randn(*s, dtype=torch.bfloat16) * 0.4)(B, M, Dm)), 'Wq': _w((lambda *s: torch.randn(*s, dtype=torch.bfloat16) * 6.4)(Dm, H, Dh) * Dm ** (-0.5)), 'Wk': _w((lambda *s: torch.randn(*s, dtype=torch.bfloat16) * 6.4)(Dm, H, Dh) * Dm ** (-0.5)), 'Wv': _w((lambda *s: torch.randn(*s, dtype=torch.bfloat16) * 0.4)(Dm, H, Dh) * Dm ** (-0.5)), 'Wo': _w((lambda *s: torch.randn(*s, dtype=torch.bfloat16) * 0.4)(H, Dh, Dm) * (H * Dh) ** (-0.5)), 'seg_len': seg}
    _A_in = _A_setup()

    def _B_setup():
        B, S, D = (1, 2048, 1024)
        ks = 4
        return {'q': _w((lambda *s: torch.randn(*s, dtype=torch.bfloat16) * 0.05)(B, S, D)), 'k': _w((lambda *s: torch.randn(*s, dtype=torch.bfloat16) * 0.4)(B, S, D)), 'v': _w((lambda *s: torch.randn(*s, dtype=torch.bfloat16) * 0.4)(B, S, D)), 'shift_k': _w((lambda *s: torch.randn(*s, dtype=torch.bfloat16) * 0.4)(D, ks) * 0.5), 'ssm_k': _w((lambda *s: torch.randn(*s, dtype=torch.bfloat16) * 0.4)(D, S) * (1.0 / S ** 0.5)), 'ssm_D': _w((lambda *s: torch.randn(*s, dtype=torch.bfloat16) * 0.4)(D))}
    _B_in = _B_setup()
    return {'A_x': _A_in['x'], 'A_mem0': _A_in['mem0'], 'A_Wq': _A_in['Wq'], 'A_Wk': _A_in['Wk'], 'A_Wv': _A_in['Wv'], 'A_Wo': _A_in['Wo'], 'A_seg_len': _A_in['seg_len'], 'B_q': _B_in['q'], 'B_k': _B_in['k'], 'B_v': _B_in['v'], 'B_shift_k': _B_in['shift_k'], 'B_ssm_k': _B_in['ssm_k'], 'B_ssm_D': _B_in['ssm_D']}

def reference(A_x, A_mem0, A_Wq, A_Wk, A_Wv, A_Wo, A_seg_len, B_q, B_k, B_v, B_shift_k, B_ssm_k, B_ssm_D):

    def _A_ref(x, mem0, Wq, Wk, Wv, Wo, seg_len):
        B, S, Dm = x.shape
        H, Dh = (Wq.shape[1], Wq.shape[2])
        M = mem0.shape[1]
        scale = Dh ** (-0.5)
        n_seg = S // seg_len
        L = M + seg_len
        idx = torch.arange(L)
        mask = (idx[:, None] < M) | (idx[:, None] >= idx[None, :])
        mem = mem0
        outs = []
        for s in range(n_seg):
            xs = x[:, s * seg_len:(s + 1) * seg_len, :].clone()
            h = torch.concatenate([mem, xs], axis=1)
            q = torch.einsum('btd,dhe->bhte', h, Wq)
            k = torch.einsum('btd,dhe->bhte', h, Wk)
            v = torch.einsum('btd,dhe->bhte', h, Wv)
            scores = torch.einsum('bhqe,bhke->bhqk', q, k) * scale
            scores = torch.where(mask[None, None], scores, -1000000000.0)
            p = _softmax(scores, axis=-1)
            o = torch.einsum('bhqk,bhke->bhqe', p, v)
            o = torch.einsum('bhte,hed->btd', o, Wo)
            mem = o[:, :M, :].clone()
            outs.append(o[:, M:, :])
        return torch.concatenate(outs, axis=1)

    def _B_ref(q, k, v, shift_k, ssm_k, ssm_D):
        B, S, D = q.shape
        ks = shift_k.shape[-1]
        k_pad = _pad(k, ((0, 0), (ks - 1, 0), (0, 0)))
        k_shift = torch.zeros_like(k)
        for t in range(ks):
            k_shift = k_shift + k_pad[:, t:t + S, :] * shift_k[:, ks - 1 - t][None, None, :]
        kv = k_shift * v
        L = 2 * S
        kv_pad = _pad(kv, ((0, 0), (0, S), (0, 0)))
        kf_pad = _pad(ssm_k, ((0, 0), (0, S)))
        kv_f = (lambda x, axes=(-2, -1): torch.fft.rfft2(x.float(), dim=axes))(kv_pad[:, None, :, :], axes=(1, 2))
        kf_f = (lambda x, axes=(-2, -1): torch.fft.rfft2(x.float(), dim=axes))(kf_pad[:, None, :], axes=(1, 2))
        kf_f = (lambda x, *d: x.permute(*d))(kf_f, 1, 2, 0)
        y_f = kv_f * kf_f[None, :, :, :]
        y = (lambda x, s, axes=(-2, -1): torch.fft.irfft2(x, s=s, dim=axes).to(torch.bfloat16))(y_f, (1, L), axes=(1, 2))[:, 0, :S, :]
        y = y + kv * ssm_D[None, None, :]
        return q * y
    a = _A_ref(A_x, A_mem0, A_Wq, A_Wk, A_Wv, A_Wo, A_seg_len)
    b = _B_ref(B_q, B_k, B_v, B_shift_k, B_ssm_k, B_ssm_D)
    return torch.concatenate([a, b], axis=-1)
```

```asm
; @launch grid=(256,1,1) block=(512,1,1) lds=163840
.amdgcn_target "amdgcn-amd-amdhsa--gfx950"
.text
.globl concat_heads__memory_aug_recurrent_mem_tr__ssm_conv_h3__prompt_kernel
.p2align 8
.type concat_heads__memory_aug_recurrent_mem_tr__ssm_conv_h3__prompt_kernel,@function
concat_heads__memory_aug_recurrent_mem_tr__ssm_conv_h3__prompt_kernel:
    s_cmp_ge_u32 s2, 256
    s_cbranch_scc1 L_end
    s_getpc_b64 s[40:41]
L_pc:
    v_lshlrev_b32 v6, 7, v0
    v_min_u32 v7, L_code_end-L_pc-4, v6
    global_load_dword v255, v7, s[40:41]
    v_add_u32 v6, 0x10000, v6
    v_cmp_gt_u32 vcc, L_code_end-L_pc-4, v6
    s_and_saveexec_b64 s[42:43], vcc
    s_cbranch_execz L_pc2
    global_load_dword v255, v6, s[40:41]
L_pc2:
    s_mov_b64 exec, s[42:43]
    s_load_dwordx4 s[32:35], s[0:1], 112
    s_getreg_b32 s25, hwreg(HW_REG_XCC_ID, 0, 3)
    v_lshrrev_b32 v1, 6, v0
    v_mov_b32 v5, 163824
    v_readfirstlane_b32 s24, v1
    s_waitcnt lgkmcnt(0)
    s_mov_b32 s20, s32
    s_and_b32 s21, s33, 0xffff
    s_mov_b32 s22, 256
    s_mov_b32 s23, 0x20000
    s_mov_b32 s4, s34
    s_and_b32 s5, s35, 0xffff
    s_mov_b32 s6, 268435456
    s_mov_b32 s7, 0x20000
    s_cmp_lg_u32 s24, 0
    s_cbranch_scc1 L_t1
    s_lshl_b32 s36, s25, 5
    s_mov_b32 s26, 1
    s_atomic_add s26, s[32:33], s36 glc
    s_waitcnt lgkmcnt(0)
    s_cmp_lt_u32 s26, 32
    s_cbranch_scc1 L_t0
    s_mov_b32 s26, 1
    s_atomic_add s26, s[32:33], 8 glc
    v_lshlrev_b32 v2, 2, v0
    s_mov_b32 s48, 400000
    s_waitcnt lgkmcnt(0)
L_t2:
    buffer_load_dword v3, v2, s[20:23], 0 offen sc1
    s_sub_u32 s48, s48, 1
    s_cbranch_scc1 L_abort
    s_waitcnt vmcnt(0)
    s_mov_b32 s36, 0
    v_readlane_b32 s40, v3, 0
    s_add_u32 s36, s36, s40
    v_readlane_b32 s41, v3, 8
    s_add_u32 s36, s36, s41
    v_readlane_b32 s42, v3, 16
    s_add_u32 s36, s36, s42
    v_readlane_b32 s43, v3, 24
    s_add_u32 s36, s36, s43
    v_readlane_b32 s44, v3, 32
    s_add_u32 s36, s36, s44
    v_readlane_b32 s45, v3, 40
    s_add_u32 s36, s36, s45
    v_readlane_b32 s46, v3, 48
    s_add_u32 s36, s36, s46
    v_readlane_b32 s47, v3, 56
    s_add_u32 s36, s36, s47
    s_cmp_lt_u32 s36, 256
    s_cbranch_scc1 L_t2
    s_min_u32 s36, s40, 32
    s_add_u32 s26, s26, s36
    s_mov_b32 s25, 0
    s_cmp_lt_u32 s26, 32
    s_cbranch_scc1 L_t0
    s_sub_u32 s26, s26, 32
    s_min_u32 s36, s41, 32
    s_add_u32 s26, s26, s36
    s_mov_b32 s25, 1
    s_cmp_lt_u32 s26, 32
    s_cbranch_scc1 L_t0
    s_sub_u32 s26, s26, 32
    s_min_u32 s36, s42, 32
    s_add_u32 s26, s26, s36
    s_mov_b32 s25, 2
    s_cmp_lt_u32 s26, 32
    s_cbranch_scc1 L_t0
    s_sub_u32 s26, s26, 32
    s_min_u32 s36, s43, 32
    s_add_u32 s26, s26, s36
    s_mov_b32 s25, 3
    s_cmp_lt_u32 s26, 32
    s_cbranch_scc1 L_t0
    s_sub_u32 s26, s26, 32
    s_min_u32 s36, s44, 32
    s_add_u32 s26, s26, s36
    s_mov_b32 s25, 4
    s_cmp_lt_u32 s26, 32
    s_cbranch_scc1 L_t0
    s_sub_u32 s26, s26, 32
    s_min_u32 s36, s45, 32
    s_add_u32 s26, s26, s36
    s_mov_b32 s25, 5
    s_cmp_lt_u32 s26, 32
    s_cbranch_scc1 L_t0
    s_sub_u32 s26, s26, 32
    s_min_u32 s36, s46, 32
    s_add_u32 s26, s26, s36
    s_mov_b32 s25, 6
    s_cmp_lt_u32 s26, 32
    s_cbranch_scc1 L_t0
    s_sub_u32 s26, s26, 32
    s_min_u32 s36, s47, 32
    s_add_u32 s26, s26, s36
    s_mov_b32 s25, 7
    s_cmp_lt_u32 s26, 32
    s_cbranch_scc1 L_t0
    s_sub_u32 s26, s26, 32
    s_branch L_abort
L_t0:
    s_lshl_b32 s36, s25, 5
    s_add_u32 s36, s36, s26
    v_mov_b32 v8, s36
    v_mov_b32 v9, 0
    v_mov_b32 v10, 0
    v_mov_b32 v11, 0
    ds_write_b128 v5, v[8:11]
    s_waitcnt lgkmcnt(0)
L_t1:
    s_barrier
    ds_read_b32 v4, v5
    s_waitcnt lgkmcnt(0)
    v_readfirstlane_b32 s26, v4
    s_nop 3
    s_bfe_u32 s25, s26, 0x30005
    s_and_b32 s26, s26, 31
    s_cmp_lt_u32 s25, 4
    s_cbranch_scc1 L_rec
    s_cmp_ge_u32 s26, 24
    s_cbranch_scc1 L_o
    s_cmp_ge_u32 s26, 16
    s_cbranch_scc1 L_q
L_kv:
    v_and_b32 v40, 63, v0
    v_mov_b32 v10, 0
    s_and_b32 s60, s24, 3
    s_lshr_b32 s61, s24, 2
    s_bfe_u32 s47, s25, 0x20000
    s_mul_i32 s62, s47, 16
    s_mul_i32 s47, s26, 1
    s_add_u32 s62, s62, s47
    s_lshr_b32 s47, s62, 3
    s_mul_i32 s51, s47, 128
    s_bfe_u32 s47, s62, 0x30000
    s_mul_i32 s47, s47, 4
    s_add_u32 s51, s51, s47
    s_add_u32 s51, s51, 98566144
    s_lshr_b32 s47, s62, 2
    s_mul_i32 s32, s47, 16384
    s_bfe_u32 s47, s62, 0x20000
    s_mul_i32 s47, s47, 2048
    s_add_u32 s32, s32, s47
    s_bfe_u32 s47, s24, 0x10000
    s_mul_i32 s47, s47, 1024
    s_add_u32 s32, s32, s47
    v_lshlrev_b32 v12, 4, v40
    v_add_u32 v12, s32, v12
    v_mov_b32 v72, -1
    v_mov_b32 v73, -1
    v_mov_b32 v74, -1
    v_mov_b32 v75, -1
    s_cmp_lg_u32 s24, 0
    s_cbranch_scc1 KI_1
    s_mov_b32 s32, 100663296
    buffer_store_dwordx4 v[72:75], v12, s[4:7], s32 offen sc1
    buffer_store_dwordx4 v[72:75], v12, s[4:7], s32 offen offset:1024 sc1
    s_mov_b32 s32, 100671488
    buffer_store_dwordx4 v[72:75], v12, s[4:7], s32 offen sc1
    buffer_store_dwordx4 v[72:75], v12, s[4:7], s32 offen offset:1024 sc1
KI_1:
    s_mul_i32 s3, s25, 128
    s_add_u32 s3, s3, 98568192
    s_cmp_lg_u32 s24, 0
    s_cbranch_scc1 GC_2
    s_mov_b64 exec, 1
    buffer_store_dword v10, v10, s[4:7], s3 offen sc1
    buffer_store_dword v10, v10, s[4:7], s51 offen offset:0 sc1
    s_mov_b64 exec, -1
GC_2:
    s_load_dwordx4 s[40:43], s[0:1], 24
    s_waitcnt lgkmcnt(0)
    s_bitcmp1_b32 s62, 0
    s_cselect_b64 s[40:41], s[42:43], s[40:41]
    s_mul_i32 s32, s61, 4194304
    s_lshr_b32 s47, s62, 1
    s_mul_i32 s47, s47, 256
    s_add_u32 s32, s32, s47
    s_mul_i32 s47, s60, 262144
    s_add_u32 s32, s32, s47
    s_mov_b32 s8, s40
    s_and_b32 s9, s41, 0xffff
    s_mov_b32 s10, 8388608
    s_mov_b32 s11, 0x20000
    v_lshrrev_b32 v42, 4, v40
    v_lshlrev_b32 v42, 2, v42
    v_xor_b32 v45, v42, v40
    v_bfe_u32 v41, v40, 4, 2
    v_lshlrev_b32 v42, 13, v41
    v_and_b32 v41, 15, v45
    v_lshl_add_u32 v42, v41, 4, v42
    v_add_u32 v42, s32, v42
    v_bfe_u32 v41, v40, 2, 2
    v_xor_b32 v46, s60, v41
    s_mul_i32 s32, s61, 32768
    v_bfe_u32 v41, v40, 4, 2
    v_lshlrev_b32 v45, 11, v41
    v_bfe_u32 v41, v40, 2, 2
    v_lshl_add_u32 v45, v41, 8, v45
    v_lshl_add_u32 v45, v46, 6, v45
    v_and_b32 v41, 3, v40
    v_lshl_add_u32 v45, v41, 4, v45
    v_add_u32 v45, s32, v45
    s_lshl_b32 s56, s24, 13
    s_load_dwordx2 s[42:43], s[0:1], 0
    s_bfe_u32 s47, s26, 0x40000
    s_mul_i32 s32, s47, 2048
    s_mul_i32 s47, s24, 32768
    s_add_u32 s32, s32, s47
    v_and_b32 v41, 15, v40
    v_lshlrev_b32 v77, 7, v41
    v_add_u32 v77, s32, v77
    s_waitcnt lgkmcnt(0)
    s_mov_b32 s12, s42
    s_and_b32 s13, s43, 0xffff
    s_mov_b32 s14, 4194304
    s_mov_b32 s15, 0x20000
    s_mov_b64 exec, 0xffff
    buffer_load_dword v76, v77, s[12:15], 0 offen
    s_mov_b64 exec, -1
    s_barrier
    s_cmp_lg_u32 s24, 0
    s_cbranch_scc1 GA_3
    s_waitcnt vmcnt(0)
    s_mov_b32 s72, 1
    s_atomic_add s72, s[20:21], 4
GA_3:
    s_add_u32 m0, s56, 0
    s_mov_b32 s40, 0
    buffer_load_dwordx4 v42, s[8:11], s40 offen lds
    s_add_u32 m0, s56, 1024
    s_mov_b32 s40, 32768
    buffer_load_dwordx4 v42, s[8:11], s40 offen lds
    s_add_u32 m0, s56, 2048
    s_mov_b32 s40, 65536
    buffer_load_dwordx4 v42, s[8:11], s40 offen lds
    s_add_u32 m0, s56, 3072
    s_mov_b32 s40, 98304
    buffer_load_dwordx4 v42, s[8:11], s40 offen lds
    s_add_u32 m0, s56, 4096
    s_mov_b32 s40, 131072
    buffer_load_dwordx4 v42, s[8:11], s40 offen lds
    s_add_u32 m0, s56, 5120
    s_mov_b32 s40, 163840
    buffer_load_dwordx4 v42, s[8:11], s40 offen lds
    s_add_u32 m0, s56, 6144
    s_mov_b32 s40, 196608
    buffer_load_dwordx4 v42, s[8:11], s40 offen lds
    s_add_u32 m0, s56, 7168
    s_mov_b32 s40, 229376
    buffer_load_dwordx4 v42, s[8:11], s40 offen lds
    s_add_u32 m0, s56, 65536
    s_mov_b32 s40, 1048576
    buffer_load_dwordx4 v42, s[8:11], s40 offen lds
    s_add_u32 m0, s56, 66560
    s_mov_b32 s40, 1081344
    buffer_load_dwordx4 v42, s[8:11], s40 offen lds
    s_add_u32 m0, s56, 67584
    s_mov_b32 s40, 1114112
    buffer_load_dwordx4 v42, s[8:11], s40 offen lds
    s_add_u32 m0, s56, 68608
    s_mov_b32 s40, 1146880
    buffer_load_dwordx4 v42, s[8:11], s40 offen lds
    s_add_u32 m0, s56, 69632
    s_mov_b32 s40, 1179648
    buffer_load_dwordx4 v42, s[8:11], s40 offen lds
    s_add_u32 m0, s56, 70656
    s_mov_b32 s40, 1212416
    buffer_load_dwordx4 v42, s[8:11], s40 offen lds
    s_add_u32 m0, s56, 71680
    s_mov_b32 s40, 1245184
    buffer_load_dwordx4 v42, s[8:11], s40 offen lds
    s_add_u32 m0, s56, 72704
    s_mov_b32 s40, 1277952
    buffer_load_dwordx4 v42, s[8:11], s40 offen lds
    s_load_dwordx2 s[42:43], s[0:1], 0
    v_bfe_u32 v41, v40, 1, 3
    v_lshrrev_b32 v43, 4, v40
    v_xor_b32 v43, v43, v41
    s_mul_i32 s32, s61, 32768
    v_bfe_u32 v41, v40, 3, 1
    v_lshlrev_b32 v1, 10, v41
    v_and_b32 v41, 7, v40
    v_lshl_add_u32 v1, v41, 7, v1
    v_lshl_add_u32 v1, v43, 4, v1
    v_add_u32 v1, s32, v1
    v_xor_b32 v2, 64, v1
    v_and_b32 v41, 7, v40
    v_lshrrev_b32 v43, 4, v40
    v_xor_b32 v43, v43, v41
    s_lshl_b32 s30, s60, 13
    s_mov_b32 s31, 0
    s_mul_i32 s32, s60, 256
    v_lshrrev_b32 v41, 3, v40
    v_lshlrev_b32 v5, 11, v41
    v_lshl_add_u32 v5, v43, 4, v5
    v_add_u32 v5, s32, v5
    v_xor_b32 v6, 64, v5
    s_waitcnt lgkmcnt(0)
    s_mov_b32 s12, s42
    s_and_b32 s13, s43, 0xffff
    s_mov_b32 s14, 4194304
    s_mov_b32 s15, 0x20000
    s_mul_i32 s32, s60, 4096
    s_add_u32 s32, s32, 131072
    v_lshlrev_b32 v7, 4, v40
    v_add_u32 v7, s32, v7
    v_xor_b32 v8, 0x2000, v7
    v_and_b32 v41, 3, v40
    v_lshlrev_b32 v0, 7, v41
    s_mul_i32 s32, s62, 8192
    s_mul_i32 s47, s60, 1024
    s_add_u32 s32, s32, s47
    v_lshlrev_b32 v9, 4, v40
    v_add_u32 v9, s32, v9
    s_bfe_u32 s47, s26, 0x40000
    s_mul_i32 s32, s47, 4096
    s_mul_i32 s47, s60, 1024
    s_add_u32 s32, s32, s47
    v_and_b32 v41, 7, v40
    v_lshlrev_b32 v13, 7, v41
    v_add_u32 v13, s32, v13
    s_lshr_b32 s47, s62, 2
    s_mul_i32 s32, s47, 16384
    s_bfe_u32 s47, s62, 0x20000
    s_mul_i32 s47, s47, 2048
    s_add_u32 s32, s32, s47
    s_mul_i32 s47, s60, 512
    s_add_u32 s32, s32, s47
    v_lshlrev_b32 v14, 3, v40
    v_add_u32 v14, s32, v14
    s_waitcnt vmcnt(8)
    s_barrier
    ds_read_b64_tr_b16 v[128:129], v45 offset:0
    ds_read_b64_tr_b16 v[130:131], v45 offset:1024
    ds_read_b64_tr_b16 v[132:133], v45 offset:8
    ds_read_b64_tr_b16 v[134:135], v45 offset:1032
    ds_read_b64_tr_b16 v[136:137], v45 offset:8192
    ds_read_b64_tr_b16 v[138:139], v45 offset:9216
    ds_read_b64_tr_b16 v[140:141], v45 offset:8200
    ds_read_b64_tr_b16 v[142:143], v45 offset:9224
    ds_read_b64_tr_b16 v[144:145], v45 offset:16384
    ds_read_b64_tr_b16 v[146:147], v45 offset:17408
    ds_read_b64_tr_b16 v[148:149], v45 offset:16392
    ds_read_b64_tr_b16 v[150:151], v45 offset:17416
    ds_read_b64_tr_b16 v[152:153], v45 offset:24576
    ds_read_b64_tr_b16 v[154:155], v45 offset:25600
    ds_read_b64_tr_b16 v[156:157], v45 offset:24584
    ds_read_b64_tr_b16 v[158:159], v45 offset:25608
    v_xor_b32 v45, 0x10000, v45
    s_waitcnt lgkmcnt(0)
    s_barrier
    s_add_u32 m0, s56, 0
    s_mov_b32 s40, 2097152
    buffer_load_dwordx4 v42, s[8:11], s40 offen lds
    s_add_u32 m0, s56, 1024
    s_mov_b32 s40, 2129920
    buffer_load_dwordx4 v42, s[8:11], s40 offen lds
    s_add_u32 m0, s56, 2048
    s_mov_b32 s40, 2162688
    buffer_load_dwordx4 v42, s[8:11], s40 offen lds
    s_add_u32 m0, s56, 3072
    s_mov_b32 s40, 2195456
    buffer_load_dwordx4 v42, s[8:11], s40 offen lds
    s_add_u32 m0, s56, 4096
    s_mov_b32 s40, 2228224
    buffer_load_dwordx4 v42, s[8:11], s40 offen lds
    s_add_u32 m0, s56, 5120
    s_mov_b32 s40, 2260992
    buffer_load_dwordx4 v42, s[8:11], s40 offen lds
    s_add_u32 m0, s56, 6144
    s_mov_b32 s40, 2293760
    buffer_load_dwordx4 v42, s[8:11], s40 offen lds
    s_add_u32 m0, s56, 7168
    s_mov_b32 s40, 2326528
    buffer_load_dwordx4 v42, s[8:11], s40 offen lds
    s_waitcnt vmcnt(8)
    s_barrier
    ds_read_b64_tr_b16 v[160:161], v45 offset:0
    ds_read_b64_tr_b16 v[162:163], v45 offset:1024
    ds_read_b64_tr_b16 v[164:165], v45 offset:8
    ds_read_b64_tr_b16 v[166:167], v45 offset:1032
    ds_read_b64_tr_b16 v[168:169], v45 offset:8192
    ds_read_b64_tr_b16 v[170:171], v45 offset:9216
    ds_read_b64_tr_b16 v[172:173], v45 offset:8200
    ds_read_b64_tr_b16 v[174:175], v45 offset:9224
    ds_read_b64_tr_b16 v[176:177], v45 offset:16384
    ds_read_b64_tr_b16 v[178:179], v45 offset:17408
    ds_read_b64_tr_b16 v[180:181], v45 offset:16392
    ds_read_b64_tr_b16 v[182:183], v45 offset:17416
    ds_read_b64_tr_b16 v[184:185], v45 offset:24576
    ds_read_b64_tr_b16 v[186:187], v45 offset:25600
    ds_read_b64_tr_b16 v[188:189], v45 offset:24584
    ds_read_b64_tr_b16 v[190:191], v45 offset:25608
    v_xor_b32 v45, 0x10000, v45
    s_waitcnt lgkmcnt(0)
    s_barrier
    s_add_u32 m0, s56, 65536
    s_mov_b32 s40, 3145728
    buffer_load_dwordx4 v42, s[8:11], s40 offen lds
    s_add_u32 m0, s56, 66560
    s_mov_b32 s40, 3178496
    buffer_load_dwordx4 v42, s[8:11], s40 offen lds
    s_add_u32 m0, s56, 67584
    s_mov_b32 s40, 3211264
    buffer_load_dwordx4 v42, s[8:11], s40 offen lds
    s_add_u32 m0, s56, 68608
    s_mov_b32 s40, 3244032
    buffer_load_dwordx4 v42, s[8:11], s40 offen lds
    s_add_u32 m0, s56, 69632
    s_mov_b32 s40, 3276800
    buffer_load_dwordx4 v42, s[8:11], s40 offen lds
    s_add_u32 m0, s56, 70656
    s_mov_b32 s40, 3309568
    buffer_load_dwordx4 v42, s[8:11], s40 offen lds
    s_add_u32 m0, s56, 71680
    s_mov_b32 s40, 3342336
    buffer_load_dwordx4 v42, s[8:11], s40 offen lds
    s_add_u32 m0, s56, 72704
    s_mov_b32 s40, 3375104
    buffer_load_dwordx4 v42, s[8:11], s40 offen lds
    s_waitcnt vmcnt(8)
    s_barrier
    ds_read_b64_tr_b16 v[192:193], v45 offset:0
    ds_read_b64_tr_b16 v[194:195], v45 offset:1024
    ds_read_b64_tr_b16 v[196:197], v45 offset:8
    ds_read_b64_tr_b16 v[198:199], v45 offset:1032
    ds_read_b64_tr_b16 v[200:201], v45 offset:8192
    ds_read_b64_tr_b16 v[202:203], v45 offset:9216
    ds_read_b64_tr_b16 v[204:205], v45 offset:8200
    ds_read_b64_tr_b16 v[206:207], v45 offset:9224
    ds_read_b64_tr_b16 v[208:209], v45 offset:16384
    ds_read_b64_tr_b16 v[210:211], v45 offset:17408
    ds_read_b64_tr_b16 v[212:213], v45 offset:16392
    ds_read_b64_tr_b16 v[214:215], v45 offset:17416
    ds_read_b64_tr_b16 v[216:217], v45 offset:24576
    ds_read_b64_tr_b16 v[218:219], v45 offset:25600
    ds_read_b64_tr_b16 v[220:221], v45 offset:24584
    ds_read_b64_tr_b16 v[222:223], v45 offset:25608
    v_xor_b32 v45, 0x10000, v45
    s_waitcnt lgkmcnt(0)
    s_barrier
    s_waitcnt vmcnt(0)
    s_barrier
    ds_read_b64_tr_b16 v[224:225], v45 offset:0
    ds_read_b64_tr_b16 v[226:227], v45 offset:1024
    ds_read_b64_tr_b16 v[228:229], v45 offset:8
    ds_read_b64_tr_b16 v[230:231], v45 offset:1032
    ds_read_b64_tr_b16 v[232:233], v45 offset:8192
    ds_read_b64_tr_b16 v[234:235], v45 offset:9216
    ds_read_b64_tr_b16 v[236:237], v45 offset:8200
    ds_read_b64_tr_b16 v[238:239], v45 offset:9224
    ds_read_b64_tr_b16 v[240:241], v45 offset:16384
    ds_read_b64_tr_b16 v[242:243], v45 offset:17408
    ds_read_b64_tr_b16 v[244:245], v45 offset:16392
    ds_read_b64_tr_b16 v[246:247], v45 offset:17416
    ds_read_b64_tr_b16 v[248:249], v45 offset:24576
    ds_read_b64_tr_b16 v[250:251], v45 offset:25600
    ds_read_b64_tr_b16 v[252:253], v45 offset:24584
    ds_read_b64_tr_b16 v[254:255], v45 offset:25608
    v_xor_b32 v45, 0x10000, v45
    s_waitcnt lgkmcnt(0)
    s_barrier
    s_cmp_eq_u32 s61, 0
    s_cbranch_scc1 YF_4
    s_sub_u32 s31, s31, 65536
    s_xor_b32 s30, s30, 0x10000
    s_xor_b32 m0, s30, 98304
    s_add_u32 s34, s31, 66560
    buffer_load_dwordx4 v5, s[12:15], s34 offen lds
    s_xor_b32 m0, s30, 99328
    s_add_u32 s34, s31, 82944
    buffer_load_dwordx4 v6, s[12:15], s34 offen lds
    s_xor_b32 m0, s30, 100352
    s_add_u32 s34, s31, 99328
    buffer_load_dwordx4 v5, s[12:15], s34 offen lds
    s_xor_b32 m0, s30, 101376
    s_add_u32 s34, s31, 115712
    buffer_load_dwordx4 v6, s[12:15], s34 offen lds
    s_xor_b32 m0, s30, 102400
    s_add_u32 s34, s31, 66688
    buffer_load_dwordx4 v5, s[12:15], s34 offen lds
    s_xor_b32 m0, s30, 103424
    s_add_u32 s34, s31, 83072
    buffer_load_dwordx4 v6, s[12:15], s34 offen lds
    s_xor_b32 m0, s30, 104448
    s_add_u32 s34, s31, 99456
    buffer_load_dwordx4 v5, s[12:15], s34 offen lds
    s_xor_b32 m0, s30, 105472
    s_add_u32 s34, s31, 115840
    buffer_load_dwordx4 v6, s[12:15], s34 offen lds
    s_add_u32 s31, s31, 65536
    s_xor_b32 s30, s30, 0x10000
YF_4:
    s_mov_b32 s28, 0
    s_waitcnt vmcnt(0)
    s_barrier
    s_mov_b32 s48, 400000
WI_5:
    buffer_load_dword v11, v10, s[4:7], s3 offen sc1
    s_sub_u32 s48, s48, 1
    s_cbranch_scc1 L_abort
    s_waitcnt vmcnt(0)
    v_readfirstlane_b32 s29, v11
    s_nop 3
    s_cmp_lg_u32 s29, 0
    s_cbranch_scc1 WE_6
    s_sleep 8
    s_branch WI_5
WE_6:
    s_bfe_u32 s27, s29, 0x10008
    s_cmp_eq_u32 s61, 0
    s_cbranch_scc1 L_kv_x
L_kv_y:
    s_cmp_lg_u32 s24, 4
    s_cbranch_scc1 FA_7
    s_add_u32 s74, s28, -1
    s_atomic_smax s74, s[4:5], s51
FA_7:
    s_xor_b32 m0, s30, 0
    s_add_u32 s34, s31, 0
    buffer_load_dwordx4 v5, s[12:15], s34 offen lds
    s_xor_b32 m0, s30, 1024
    s_add_u32 s34, s31, 16384
    buffer_load_dwordx4 v6, s[12:15], s34 offen lds
    s_xor_b32 m0, s30, 2048
    s_add_u32 s34, s31, 32768
    buffer_load_dwordx4 v5, s[12:15], s34 offen lds
    s_xor_b32 m0, s30, 3072
    s_add_u32 s34, s31, 49152
    buffer_load_dwordx4 v6, s[12:15], s34 offen lds
    s_xor_b32 m0, s30, 4096
    s_add_u32 s34, s31, 128
    buffer_load_dwordx4 v5, s[12:15], s34 offen lds
    s_xor_b32 m0, s30, 5120
    s_add_u32 s34, s31, 16512
    buffer_load_dwordx4 v6, s[12:15], s34 offen lds
    s_xor_b32 m0, s30, 6144
    s_add_u32 s34, s31, 32896
    buffer_load_dwordx4 v5, s[12:15], s34 offen lds
    s_xor_b32 m0, s30, 7168
    s_add_u32 s34, s31, 49280
    buffer_load_dwordx4 v6, s[12:15], s34 offen lds
    s_xor_b32 m0, s30, 98304
    s_add_u32 s34, s31, 66560
    buffer_load_dwordx4 v5, s[12:15], s34 offen lds
    s_xor_b32 m0, s30, 99328
    s_add_u32 s34, s31, 82944
    buffer_load_dwordx4 v6, s[12:15], s34 offen lds
    s_xor_b32 m0, s30, 100352
    s_add_u32 s34, s31, 99328
    buffer_load_dwordx4 v5, s[12:15], s34 offen lds
    s_xor_b32 m0, s30, 101376
    s_add_u32 s34, s31, 115712
    buffer_load_dwordx4 v6, s[12:15], s34 offen lds
    s_xor_b32 m0, s30, 102400
    s_add_u32 s34, s31, 66688
    buffer_load_dwordx4 v5, s[12:15], s34 offen lds
    s_xor_b32 m0, s30, 103424
    s_add_u32 s34, s31, 83072
    buffer_load_dwordx4 v6, s[12:15], s34 offen lds
    s_xor_b32 m0, s30, 104448
    s_add_u32 s34, s31, 99456
    buffer_load_dwordx4 v5, s[12:15], s34 offen lds
    s_xor_b32 m0, s30, 105472
    s_add_u32 s34, s31, 115840
    buffer_load_dwordx4 v6, s[12:15], s34 offen lds
    ds_read_b128 v[40:43], v1 offset:0
    ds_read_b128 v[44:47], v2 offset:0
    ds_read_b128 v[48:51], v1 offset:4096
    ds_read_b128 v[52:55], v2 offset:4096
    ds_read_b128 v[56:59], v1 offset:8192
    ds_read_b128 v[60:63], v2 offset:8192
    ds_read_b128 v[64:67], v1 offset:12288
    s_waitcnt lgkmcnt(6)
    v_mfma_f32_16x16x32_bf16 v[16:19], v[128:131], v[40:43], 0
    ds_read_b128 v[68:71], v2 offset:12288
    v_mfma_f32_16x16x32_bf16 v[20:23], v[132:135], v[40:43], 0
    s_waitcnt lgkmcnt(6)
    v_mfma_f32_16x16x32_bf16 v[16:19], v[136:139], v[44:47], v[16:19]
    ds_read_b128 v[40:43], v1 offset:16384
    v_mfma_f32_16x16x32_bf16 v[20:23], v[140:143], v[44:47], v[20:23]
    s_waitcnt lgkmcnt(6)
    v_mfma_f32_16x16x32_bf16 v[16:19], v[144:147], v[48:51], v[16:19]
    ds_read_b128 v[44:47], v2 offset:16384
    v_mfma_f32_16x16x32_bf16 v[20:23], v[148:151], v[48:51], v[20:23]
    s_waitcnt lgkmcnt(6)
    v_mfma_f32_16x16x32_bf16 v[16:19], v[152:155], v[52:55], v[16:19]
    ds_read_b128 v[48:51], v1 offset:20480
    v_mfma_f32_16x16x32_bf16 v[20:23], v[156:159], v[52:55], v[20:23]
    s_waitcnt lgkmcnt(6)
    v_mfma_f32_16x16x32_bf16 v[16:19], v[160:163], v[56:59], v[16:19]
    ds_read_b128 v[52:55], v2 offset:20480
    v_mfma_f32_16x16x32_bf16 v[20:23], v[164:167], v[56:59], v[20:23]
    s_waitcnt lgkmcnt(6)
    v_mfma_f32_16x16x32_bf16 v[16:19], v[168:171], v[60:63], v[16:19]
    ds_read_b128 v[56:59], v1 offset:24576
    v_mfma_f32_16x16x32_bf16 v[20:23], v[172:175], v[60:63], v[20:23]
    s_waitcnt lgkmcnt(6)
    v_mfma_f32_16x16x32_bf16 v[16:19], v[176:179], v[64:67], v[16:19]
    ds_read_b128 v[60:63], v2 offset:24576
    v_mfma_f32_16x16x32_bf16 v[20:23], v[180:183], v[64:67], v[20:23]
    s_waitcnt lgkmcnt(6)
    v_mfma_f32_16x16x32_bf16 v[16:19], v[184:187], v[68:71], v[16:19]
    ds_read_b128 v[64:67], v1 offset:28672
    v_mfma_f32_16x16x32_bf16 v[20:23], v[188:191], v[68:71], v[20:23]
    s_waitcnt lgkmcnt(6)
    v_mfma_f32_16x16x32_bf16 v[16:19], v[192:195], v[40:43], v[16:19]
    ds_read_b128 v[68:71], v2 offset:28672
    v_mfma_f32_16x16x32_bf16 v[20:23], v[196:199], v[40:43], v[20:23]
    s_waitcnt lgkmcnt(6)
    v_mfma_f32_16x16x32_bf16 v[16:19], v[200:203], v[44:47], v[16:19]
    ds_read_b128 v[40:43], v1 offset:2048
    v_mfma_f32_16x16x32_bf16 v[20:23], v[204:207], v[44:47], v[20:23]
    s_waitcnt lgkmcnt(6)
    v_mfma_f32_16x16x32_bf16 v[16:19], v[208:211], v[48:51], v[16:19]
    ds_read_b128 v[44:47], v2 offset:2048
    v_mfma_f32_16x16x32_bf16 v[20:23], v[212:215], v[48:51], v[20:23]
    s_waitcnt lgkmcnt(6)
    v_mfma_f32_16x16x32_bf16 v[16:19], v[216:219], v[52:55], v[16:19]
    ds_read_b128 v[48:51], v1 offset:6144
    v_mfma_f32_16x16x32_bf16 v[20:23], v[220:223], v[52:55], v[20:23]
    s_waitcnt lgkmcnt(6)
    v_mfma_f32_16x16x32_bf16 v[16:19], v[224:227], v[56:59], v[16:19]
    ds_read_b128 v[52:55], v2 offset:6144
    v_mfma_f32_16x16x32_bf16 v[20:23], v[228:231], v[56:59], v[20:23]
    s_waitcnt lgkmcnt(6)
    v_mfma_f32_16x16x32_bf16 v[16:19], v[232:235], v[60:63], v[16:19]
    ds_read_b128 v[56:59], v1 offset:10240
    v_mfma_f32_16x16x32_bf16 v[20:23], v[236:239], v[60:63], v[20:23]
    s_waitcnt lgkmcnt(6)
    v_mfma_f32_16x16x32_bf16 v[16:19], v[240:243], v[64:67], v[16:19]
    ds_read_b128 v[60:63], v2 offset:10240
    v_mfma_f32_16x16x32_bf16 v[20:23], v[244:247], v[64:67], v[20:23]
    s_waitcnt lgkmcnt(6)
    v_mfma_f32_16x16x32_bf16 v[16:19], v[248:251], v[68:71], v[16:19]
    ds_read_b128 v[64:67], v1 offset:14336
    v_mfma_f32_16x16x32_bf16 v[20:23], v[252:255], v[68:71], v[20:23]
    s_waitcnt lgkmcnt(6)
    v_mfma_f32_16x16x32_bf16 v[24:27], v[128:131], v[40:43], 0
    ds_read_b128 v[68:71], v2 offset:14336
    v_mfma_f32_16x16x32_bf16 v[28:31], v[132:135], v[40:43], 0
    s_waitcnt lgkmcnt(6)
    v_mfma_f32_16x16x32_bf16 v[24:27], v[136:139], v[44:47], v[24:27]
    ds_read_b128 v[40:43], v1 offset:18432
    v_mfma_f32_16x16x32_bf16 v[28:31], v[140:143], v[44:47], v[28:31]
    s_waitcnt lgkmcnt(6)
    v_mfma_f32_16x16x32_bf16 v[24:27], v[144:147], v[48:51], v[24:27]
    ds_read_b128 v[44:47], v2 offset:18432
    v_mfma_f32_16x16x32_bf16 v[28:31], v[148:151], v[48:51], v[28:31]
    s_waitcnt lgkmcnt(6)
    v_mfma_f32_16x16x32_bf16 v[24:27], v[152:155], v[52:55], v[24:27]
    ds_read_b128 v[48:51], v1 offset:22528
    v_mfma_f32_16x16x32_bf16 v[28:31], v[156:159], v[52:55], v[28:31]
    ds_write_b128 v7, v[16:19] offset:0
    ds_write_b128 v7, v[20:23] offset:1024
    s_waitcnt lgkmcnt(8)
    v_mfma_f32_16x16x32_bf16 v[24:27], v[160:163], v[56:59], v[24:27]
    ds_read_b128 v[52:55], v2 offset:22528
    v_mfma_f32_16x16x32_bf16 v[28:31], v[164:167], v[56:59], v[28:31]
    s_waitcnt lgkmcnt(8)
    v_mfma_f32_16x16x32_bf16 v[24:27], v[168:171], v[60:63], v[24:27]
    ds_read_b128 v[56:59], v1 offset:26624
    v_mfma_f32_16x16x32_bf16 v[28:31], v[172:175], v[60:63], v[28:31]
    s_waitcnt lgkmcnt(8)
    v_mfma_f32_16x16x32_bf16 v[24:27], v[176:179], v[64:67], v[24:27]
    ds_read_b128 v[60:63], v2 offset:26624
    v_mfma_f32_16x16x32_bf16 v[28:31], v[180:183], v[64:67], v[28:31]
    s_waitcnt lgkmcnt(8)
    v_mfma_f32_16x16x32_bf16 v[24:27], v[184:187], v[68:71], v[24:27]
    ds_read_b128 v[64:67], v1 offset:30720
    v_mfma_f32_16x16x32_bf16 v[28:31], v[188:191], v[68:71], v[28:31]
    s_waitcnt lgkmcnt(8)
    v_mfma_f32_16x16x32_bf16 v[24:27], v[192:195], v[40:43], v[24:27]
    ds_read_b128 v[68:71], v2 offset:30720
    v_mfma_f32_16x16x32_bf16 v[28:31], v[196:199], v[40:43], v[28:31]
    s_waitcnt lgkmcnt(8)
    v_mfma_f32_16x16x32_bf16 v[24:27], v[200:203], v[44:47], v[24:27]
    v_mfma_f32_16x16x32_bf16 v[28:31], v[204:207], v[44:47], v[28:31]
    s_waitcnt lgkmcnt(7)
    v_mfma_f32_16x16x32_bf16 v[24:27], v[208:211], v[48:51], v[24:27]
    v_mfma_f32_16x16x32_bf16 v[28:31], v[212:215], v[48:51], v[28:31]
    s_waitcnt lgkmcnt(4)
    v_mfma_f32_16x16x32_bf16 v[24:27], v[216:219], v[52:55], v[24:27]
    v_mfma_f32_16x16x32_bf16 v[28:31], v[220:223], v[52:55], v[28:31]
    s_waitcnt lgkmcnt(3)
    v_mfma_f32_16x16x32_bf16 v[24:27], v[224:227], v[56:59], v[24:27]
    v_mfma_f32_16x16x32_bf16 v[28:31], v[228:231], v[56:59], v[28:31]
    s_waitcnt lgkmcnt(2)
    v_mfma_f32_16x16x32_bf16 v[24:27], v[232:235], v[60:63], v[24:27]
    v_mfma_f32_16x16x32_bf16 v[28:31], v[236:239], v[60:63], v[28:31]
    s_waitcnt lgkmcnt(1)
    v_mfma_f32_16x16x32_bf16 v[24:27], v[240:243], v[64:67], v[24:27]
    v_mfma_f32_16x16x32_bf16 v[28:31], v[244:247], v[64:67], v[28:31]
    s_waitcnt lgkmcnt(0)
    v_mfma_f32_16x16x32_bf16 v[24:27], v[248:251], v[68:71], v[24:27]
    v_mfma_f32_16x16x32_bf16 v[28:31], v[252:255], v[68:71], v[28:31]
    v_xor_b32 v1, 0x10000, v1
    v_xor_b32 v2, 0x10000, v2
    s_add_u32 s31, s31, 65536
    s_xor_b32 s30, s30, 0x10000
    s_nop 3
    ds_write_b128 v7, v[24:27] offset:2048
    ds_write_b128 v7, v[28:31] offset:3072
    v_xor_b32 v7, 0x4000, v7
    s_waitcnt vmcnt(0) lgkmcnt(0)
    s_barrier
    s_add_u32 s28, s28, 1
    s_cmp_lt_u32 s28, 64
    s_cbranch_scc1 L_kv_y
    s_cmp_lg_u32 s24, 4
    s_cbranch_scc1 FA_8
    s_add_u32 s74, s28, -1
    s_atomic_smax s74, s[4:5], s51
FA_8:
    s_barrier
    s_cmp_lg_u32 s24, 4
    s_cbranch_scc1 FA_9
    s_add_u32 s74, s28, 0
    s_atomic_smax s74, s[4:5], s51
FA_9:
    s_branch L_kv_end
L_kv_x:
    s_barrier
    ds_read_b128 v[16:19], v7 offset:0
    ds_read_b128 v[20:23], v7 offset:1024
    ds_read_b128 v[40:43], v1 offset:0
    ds_read_b128 v[44:47], v2 offset:0
    ds_read_b128 v[48:51], v1 offset:4096
    ds_read_b128 v[52:55], v2 offset:4096
    ds_read_b128 v[56:59], v1 offset:8192
    ds_read_b128 v[60:63], v2 offset:8192
    ds_read_b128 v[64:67], v1 offset:12288
    ds_read_b128 v[24:27], v7 offset:2048
    ds_read_b128 v[28:31], v7 offset:3072
    s_waitcnt lgkmcnt(8)
    v_mfma_f32_16x16x32_bf16 v[16:19], v[128:131], v[40:43], v[16:19]
    ds_read_b128 v[68:71], v2 offset:12288
    v_mfma_f32_16x16x32_bf16 v[20:23], v[132:135], v[40:43], v[20:23]
    s_lshr_b32 s47, s28, 3
    s_lshr_b32 s47, s29, s47
    s_and_b32 s47, s47, 1
    s_lshl_b32 s47, s47, 13
    s_lshl_b32 s50, s28, 18
    s_add_u32 s50, s50, s47
    s_add_u32 s50, s50, 100663296
    s_lshl_b32 s49, s28, 19
    s_add_u32 s53, s49, 4096
    s_add_u32 s55, s28, 3
    s_lshl_b32 s55, s55, 16
    s_waitcnt lgkmcnt(8)
    v_mfma_f32_16x16x32_bf16 v[16:19], v[136:139], v[44:47], v[16:19]
    ds_read_b128 v[40:43], v1 offset:16384
    v_mfma_f32_16x16x32_bf16 v[20:23], v[140:143], v[44:47], v[20:23]
    s_waitcnt lgkmcnt(8)
    v_mfma_f32_16x16x32_bf16 v[16:19], v[144:147], v[48:51], v[16:19]
    ds_read_b128 v[44:47], v2 offset:16384
    v_mfma_f32_16x16x32_bf16 v[20:23], v[148:151], v[48:51], v[20:23]
    s_waitcnt lgkmcnt(8)
    v_mfma_f32_16x16x32_bf16 v[16:19], v[152:155], v[52:55], v[16:19]
    ds_read_b128 v[48:51], v1 offset:20480
    v_mfma_f32_16x16x32_bf16 v[20:23], v[156:159], v[52:55], v[20:23]
    s_waitcnt lgkmcnt(8)
    v_mfma_f32_16x16x32_bf16 v[16:19], v[160:163], v[56:59], v[16:19]
    ds_read_b128 v[52:55], v2 offset:20480
    v_mfma_f32_16x16x32_bf16 v[20:23], v[164:167], v[56:59], v[20:23]
    s_waitcnt lgkmcnt(8)
    v_mfma_f32_16x16x32_bf16 v[16:19], v[168:171], v[60:63], v[16:19]
    ds_read_b128 v[56:59], v1 offset:24576
    v_mfma_f32_16x16x32_bf16 v[20:23], v[172:175], v[60:63], v[20:23]
    s_waitcnt lgkmcnt(8)
    v_mfma_f32_16x16x32_bf16 v[16:19], v[176:179], v[64:67], v[16:19]
    ds_read_b128 v[60:63], v2 offset:24576
    v_mfma_f32_16x16x32_bf16 v[20:23], v[180:183], v[64:67], v[20:23]
    s_waitcnt lgkmcnt(6)
    v_mfma_f32_16x16x32_bf16 v[16:19], v[184:187], v[68:71], v[16:19]
    ds_read_b128 v[64:67], v1 offset:28672
    v_mfma_f32_16x16x32_bf16 v[20:23], v[188:191], v[68:71], v[20:23]
    s_waitcnt lgkmcnt(6)
    v_mfma_f32_16x16x32_bf16 v[16:19], v[192:195], v[40:43], v[16:19]
    ds_read_b128 v[68:71], v2 offset:28672
    v_mfma_f32_16x16x32_bf16 v[20:23], v[196:199], v[40:43], v[20:23]
    s_waitcnt lgkmcnt(6)
    v_mfma_f32_16x16x32_bf16 v[16:19], v[200:203], v[44:47], v[16:19]
    ds_read_b128 v[40:43], v1 offset:2048
    v_mfma_f32_16x16x32_bf16 v[20:23], v[204:207], v[44:47], v[20:23]
    s_waitcnt lgkmcnt(6)
    v_mfma_f32_16x16x32_bf16 v[16:19], v[208:211], v[48:51], v[16:19]
    ds_read_b128 v[44:47], v2 offset:2048
    v_mfma_f32_16x16x32_bf16 v[20:23], v[212:215], v[48:51], v[20:23]
    s_waitcnt lgkmcnt(6)
    v_mfma_f32_16x16x32_bf16 v[16:19], v[216:219], v[52:55], v[16:19]
    ds_read_b128 v[48:51], v1 offset:6144
    v_mfma_f32_16x16x32_bf16 v[20:23], v[220:223], v[52:55], v[20:23]
    s_waitcnt lgkmcnt(6)
    v_mfma_f32_16x16x32_bf16 v[16:19], v[224:227], v[56:59], v[16:19]
    ds_read_b128 v[52:55], v2 offset:6144
    v_mfma_f32_16x16x32_bf16 v[20:23], v[228:231], v[56:59], v[20:23]
    s_waitcnt lgkmcnt(6)
    v_mfma_f32_16x16x32_bf16 v[16:19], v[232:235], v[60:63], v[16:19]
    ds_read_b128 v[56:59], v1 offset:10240
    v_mfma_f32_16x16x32_bf16 v[20:23], v[236:239], v[60:63], v[20:23]
    s_waitcnt lgkmcnt(6)
    v_mfma_f32_16x16x32_bf16 v[16:19], v[240:243], v[64:67], v[16:19]
    ds_read_b128 v[60:63], v2 offset:10240
    v_mfma_f32_16x16x32_bf16 v[20:23], v[244:247], v[64:67], v[20:23]
    s_waitcnt lgkmcnt(6)
    v_mfma_f32_16x16x32_bf16 v[16:19], v[248:251], v[68:71], v[16:19]
    ds_read_b128 v[64:67], v1 offset:14336
    v_mfma_f32_16x16x32_bf16 v[20:23], v[252:255], v[68:71], v[20:23]
    s_waitcnt lgkmcnt(6)
    v_mfma_f32_16x16x32_bf16 v[24:27], v[128:131], v[40:43], v[24:27]
    ds_read_b128 v[68:71], v2 offset:14336
    v_mfma_f32_16x16x32_bf16 v[28:31], v[132:135], v[40:43], v[28:31]
    s_waitcnt lgkmcnt(6)
    v_mfma_f32_16x16x32_bf16 v[24:27], v[136:139], v[44:47], v[24:27]
    ds_read_b128 v[40:43], v1 offset:18432
    v_mfma_f32_16x16x32_bf16 v[28:31], v[140:143], v[44:47], v[28:31]
    s_waitcnt lgkmcnt(6)
    v_mfma_f32_16x16x32_bf16 v[24:27], v[144:147], v[48:51], v[24:27]
    ds_read_b128 v[44:47], v2 offset:18432
    v_mfma_f32_16x16x32_bf16 v[28:31], v[148:151], v[48:51], v[28:31]
    s_waitcnt lgkmcnt(6)
    v_mfma_f32_16x16x32_bf16 v[24:27], v[152:155], v[52:55], v[24:27]
    ds_read_b128 v[48:51], v1 offset:22528
    v_mfma_f32_16x16x32_bf16 v[28:31], v[156:159], v[52:55], v[28:31]
    v_cvt_pk_bf16_f32 v76, v16, v17
    v_cvt_pk_bf16_f32 v77, v18, v19
    v_cvt_pk_bf16_f32 v78, v20, v21
    v_cvt_pk_bf16_f32 v79, v22, v23
    s_waitcnt lgkmcnt(6)
    v_mfma_f32_16x16x32_bf16 v[24:27], v[160:163], v[56:59], v[24:27]
    ds_read_b128 v[52:55], v2 offset:22528
    v_mfma_f32_16x16x32_bf16 v[28:31], v[164:167], v[56:59], v[28:31]
    s_waitcnt lgkmcnt(6)
    v_mfma_f32_16x16x32_bf16 v[24:27], v[168:171], v[60:63], v[24:27]
    ds_read_b128 v[56:59], v1 offset:26624
    v_mfma_f32_16x16x32_bf16 v[28:31], v[172:175], v[60:63], v[28:31]
    s_waitcnt lgkmcnt(6)
    v_mfma_f32_16x16x32_bf16 v[24:27], v[176:179], v[64:67], v[24:27]
    ds_read_b128 v[60:63], v2 offset:26624
    v_mfma_f32_16x16x32_bf16 v[28:31], v[180:183], v[64:67], v[28:31]
    s_waitcnt lgkmcnt(6)
    v_mfma_f32_16x16x32_bf16 v[24:27], v[184:187], v[68:71], v[24:27]
    ds_read_b128 v[64:67], v1 offset:30720
    v_mfma_f32_16x16x32_bf16 v[28:31], v[188:191], v[68:71], v[28:31]
    s_waitcnt lgkmcnt(6)
    v_mfma_f32_16x16x32_bf16 v[24:27], v[192:195], v[40:43], v[24:27]
    ds_read_b128 v[68:71], v2 offset:30720
    v_mfma_f32_16x16x32_bf16 v[28:31], v[196:199], v[40:43], v[28:31]
    s_waitcnt lgkmcnt(6)
    v_mfma_f32_16x16x32_bf16 v[24:27], v[200:203], v[44:47], v[24:27]
    v_mfma_f32_16x16x32_bf16 v[28:31], v[204:207], v[44:47], v[28:31]
    s_waitcnt lgkmcnt(5)
    v_mfma_f32_16x16x32_bf16 v[24:27], v[208:211], v[48:51], v[24:27]
    v_mfma_f32_16x16x32_bf16 v[28:31], v[212:215], v[48:51], v[28:31]
    s_waitcnt lgkmcnt(4)
    v_mfma_f32_16x16x32_bf16 v[24:27], v[216:219], v[52:55], v[24:27]
    v_mfma_f32_16x16x32_bf16 v[28:31], v[220:223], v[52:55], v[28:31]
    s_waitcnt lgkmcnt(3)
    v_mfma_f32_16x16x32_bf16 v[24:27], v[224:227], v[56:59], v[24:27]
    v_mfma_f32_16x16x32_bf16 v[28:31], v[228:231], v[56:59], v[28:31]
    s_waitcnt lgkmcnt(2)
    v_mfma_f32_16x16x32_bf16 v[24:27], v[232:235], v[60:63], v[24:27]
    v_mfma_f32_16x16x32_bf16 v[28:31], v[236:239], v[60:63], v[28:31]
    s_waitcnt lgkmcnt(1)
    v_mfma_f32_16x16x32_bf16 v[24:27], v[240:243], v[64:67], v[24:27]
    v_mfma_f32_16x16x32_bf16 v[28:31], v[244:247], v[64:67], v[28:31]
    s_waitcnt lgkmcnt(0)
    v_mfma_f32_16x16x32_bf16 v[24:27], v[248:251], v[68:71], v[24:27]
    v_mfma_f32_16x16x32_bf16 v[28:31], v[252:255], v[68:71], v[28:31]
    v_xor_b32 v1, 0x10000, v1
    v_xor_b32 v2, 0x10000, v2
    v_xor_b32 v7, 0x4000, v7
    s_nop 4
    v_cvt_pk_bf16_f32 v80, v24, v25
    v_cvt_pk_bf16_f32 v81, v26, v27
    v_cvt_pk_bf16_f32 v82, v28, v29
    v_cvt_pk_bf16_f32 v83, v30, v31
    s_mov_b64 exec, 0xff
    buffer_load_dword v11, v13, s[12:15], s55 offen
    s_mov_b64 exec, -1
    buffer_store_dwordx4 v[76:79], v9, s[4:7], s49 offen sc1
    buffer_store_dwordx4 v[80:83], v9, s[4:7], s53 offen sc1
    buffer_store_dwordx2 v[72:73], v14, s[4:7], s50 offen sc1
    s_waitcnt vmcnt(0)
    s_add_u32 s28, s28, 1
    s_cmp_lt_u32 s28, 64
    s_cbranch_scc1 L_kv_x
    s_barrier
L_kv_end:
L_b:
    s_barrier
    s_load_dwordx4 s[40:43], s[0:1], 64
    s_load_dwordx2 s[44:45], s[0:1], 80
    v_mbcnt_lo_u32_b32 v1, -1, 0
    v_mbcnt_hi_u32_b32 v1, -1, v1
    s_mul_i32 s32, s24, 524288
    s_mul_i32 s47, s62, 32
    s_add_u32 s32, s32, s47
    v_lshrrev_b32 v2, 1, v1
    v_lshlrev_b32 v4, 14, v2
    v_and_b32 v2, 1, v1
    v_lshl_add_u32 v4, v2, 4, v4
    v_add_u32 v4, s32, v4
    s_mul_i32 s32, s24, -512
    s_add_u32 s32, s32, 4080
    v_and_b32 v2, 1, v1
    v_mul_u32_u24 v2, 37056, v2
    v_mov_b32 v5, v2
    v_lshrrev_b32 v2, 1, v1
    v_mul_u32_u24 v2, 16, v2
    v_sub_u32 v5, v5, v2
    v_add_u32 v5, s32, v5
    s_waitcnt lgkmcnt(0)
    s_mov_b32 s8, s40
    s_and_b32 s9, s41, 0xffff
    s_mov_b32 s10, 4194304
    s_mov_b32 s11, 0x20000
    s_mov_b32 s12, s42
    s_and_b32 s13, s43, 0xffff
    s_mov_b32 s14, 4194304
    s_mov_b32 s15, 0x20000
    s_mov_b32 s16, s44
    s_and_b32 s17, s45, 0xffff
    s_mov_b32 s18, 8192
    s_mov_b32 s19, 0x20000
    s_lshr_b32 s47, s62, 4
    s_mul_i32 s32, s47, 512
    s_bfe_u32 s47, s62, 0x40000
    s_mul_i32 s47, s47, 262144
    s_add_u32 s32, s32, s47
    s_mul_i32 s47, s24, 32768
    s_add_u32 s32, s32, s47
    v_lshrrev_b32 v2, 2, v1
    v_lshlrev_b32 v15, 11, v2
    v_and_b32 v2, 3, v1
    v_lshl_add_u32 v15, v2, 7, v15
    v_add_u32 v15, s32, v15
    buffer_load_dword v16, v15, s[8:11], 0 offen
    buffer_load_dword v16, v15, s[12:15], 0 offen
    s_waitcnt vmcnt(0)
    s_barrier
    s_mul_i32 s32, s62, 128
    v_and_b32 v2, 1, v1
    v_lshlrev_b32 v3, 6, v2
    v_add_u32 v3, s32, v3
    buffer_load_dwordx4 v[192:195], v3, s[16:19], 0 offen offset:0
    buffer_load_dwordx4 v[196:199], v3, s[16:19], 0 offen offset:16
    buffer_load_dwordx4 v[200:203], v3, s[16:19], 0 offen offset:32
    buffer_load_dwordx4 v[204:207], v3, s[16:19], 0 offen offset:48
    v_subrev_u32 v3, 6144, v4
    v_cmp_gt_u32 vcc, 6144, v4
    v_mov_b32 v2, 2147483632
    s_nop 0
    v_cndmask_b32 v3, v3, v2, vcc
    s_mov_b32 s32, 0
    buffer_load_dwordx4 v[16:19], v3, s[8:11], s32 offen
    s_mov_b32 s32, 2048
    buffer_load_dwordx4 v[20:23], v3, s[8:11], s32 offen
    s_mov_b32 s32, 4096
    buffer_load_dwordx4 v[24:27], v3, s[8:11], s32 offen
    s_mov_b32 s32, 0
    buffer_load_dwordx4 v[28:31], v4, s[8:11], s32 offen
    s_mov_b32 s32, 2048
    buffer_load_dwordx4 v[32:35], v4, s[8:11], s32 offen
    s_mov_b32 s32, 4096
    buffer_load_dwordx4 v[36:39], v4, s[8:11], s32 offen
    s_mov_b32 s32, 6144
    buffer_load_dwordx4 v[40:43], v4, s[8:11], s32 offen
    s_mov_b32 s32, 8192
    buffer_load_dwordx4 v[44:47], v4, s[8:11], s32 offen
    s_mov_b32 s32, 10240
    buffer_load_dwordx4 v[48:51], v4, s[8:11], s32 offen
    s_mov_b32 s32, 12288
    buffer_load_dwordx4 v[52:55], v4, s[8:11], s32 offen
    s_mov_b32 s32, 14336
    buffer_load_dwordx4 v[56:59], v4, s[8:11], s32 offen
    s_mov_b32 s32, 0
    buffer_load_dwordx4 v[64:67], v4, s[12:15], s32 offen
    s_mov_b32 s32, 2048
    buffer_load_dwordx4 v[68:71], v4, s[12:15], s32 offen
    s_mov_b32 s32, 4096
    buffer_load_dwordx4 v[72:75], v4, s[12:15], s32 offen
    s_mov_b32 s32, 6144
    buffer_load_dwordx4 v[76:79], v4, s[12:15], s32 offen
    s_mov_b32 s32, 8192
    buffer_load_dwordx4 v[80:83], v4, s[12:15], s32 offen
    s_mov_b32 s32, 10240
    buffer_load_dwordx4 v[84:87], v4, s[12:15], s32 offen
    s_mov_b32 s32, 12288
    buffer_load_dwordx4 v[88:91], v4, s[12:15], s32 offen
    s_mov_b32 s32, 14336
    buffer_load_dwordx4 v[92:95], v4, s[12:15], s32 offen
    v_mov_b32 v8, 0
    v_mov_b32 v9, 0
    v_mov_b32 v10, 0
    v_mov_b32 v11, 0
    s_mul_i32 s32, s24, 9248
    s_bfe_u32 s47, s24, 0x10002
    s_mul_i32 s47, s47, 64
    s_add_u32 s32, s32, s47
    s_add_u32 s32, s32, 4096
    v_bfe_u32 v2, v1, 5, 1
    v_mul_u32_u24 v2, 4624, v2
    v_mov_b32 v3, v2
    v_and_b32 v2, 31, v1
    v_lshl_add_u32 v3, v2, 4, v3
    v_add_u32 v3, s32, v3
    ds_write_b128 v3, v[8:11]
    s_mul_i32 s32, s24, 8320
    s_add_u32 s32, s32, 74112
    v_bfe_u32 v2, v1, 1, 1
    v_mul_u32_u24 v2, 4160, v2
    v_mov_b32 v3, v2
    v_and_b32 v2, 1, v1
    v_lshl_add_u32 v3, v2, 4, v3
    v_add_u32 v3, s32, v3
    ds_write_b128 v3, v[8:11]
    s_waitcnt vmcnt(19)
    v_lshlrev_b32 v96, 16, v192
    v_and_b32 v97, 0xffff0000, v192
    v_lshlrev_b32 v98, 16, v193
    v_and_b32 v99, 0xffff0000, v193
    v_lshlrev_b32 v100, 16, v194
    v_and_b32 v101, 0xffff0000, v194
    v_lshlrev_b32 v102, 16, v195
    v_and_b32 v103, 0xffff0000, v195
    v_lshlrev_b32 v104, 16, v196
    v_and_b32 v105, 0xffff0000, v196
    v_lshlrev_b32 v106, 16, v197
    v_and_b32 v107, 0xffff0000, v197
    v_lshlrev_b32 v108, 16, v198
    v_and_b32 v109, 0xffff0000, v198
    v_lshlrev_b32 v110, 16, v199
    v_and_b32 v111, 0xffff0000, v199
    v_lshlrev_b32 v112, 16, v200
    v_and_b32 v113, 0xffff0000, v200
    v_lshlrev_b32 v114, 16, v201
    v_and_b32 v115, 0xffff0000, v201
    v_lshlrev_b32 v116, 16, v202
    v_and_b32 v117, 0xffff0000, v202
    v_lshlrev_b32 v118, 16, v203
    v_and_b32 v119, 0xffff0000, v203
    v_lshlrev_b32 v120, 16, v204
    v_and_b32 v121, 0xffff0000, v204
    v_lshlrev_b32 v122, 16, v205
    v_and_b32 v123, 0xffff0000, v205
    v_lshlrev_b32 v124, 16, v206
    v_and_b32 v125, 0xffff0000, v206
    v_lshlrev_b32 v126, 16, v207
    v_and_b32 v127, 0xffff0000, v207
    s_waitcnt vmcnt(0)
    s_load_dwordx4 s[40:43], s[0:1], 88
    s_load_dwordx2 s[44:45], s[0:1], 56
    s_waitcnt lgkmcnt(0)
    s_mov_b32 s8, s40
    s_and_b32 s9, s41, 0xffff
    s_mov_b32 s10, 4194304
    s_mov_b32 s11, 0x20000
    s_mov_b32 s16, s42
    s_and_b32 s17, s43, 0xffff
    s_mov_b32 s18, 2048
    s_mov_b32 s19, 0x20000
    s_mov_b32 s12, s44
    s_and_b32 s13, s45, 0xffff
    s_mov_b32 s14, 4194304
    s_mov_b32 s15, 0x20000
    s_mul_i32 s32, s62, 65536
    s_mul_i32 s47, s24, 8192
    s_add_u32 s32, s32, s47
    v_lshlrev_b32 v3, 7, v1
    v_add_u32 v3, s32, v3
    buffer_load_dword v7, v3, s[8:11], 0 offen
    buffer_load_dword v6, v15, s[12:15], 0 offen
    v_lshlrev_b32 v192, 16, v16
    v_lshlrev_b32 v193, 16, v20
    v_lshlrev_b32 v194, 16, v24
    v_lshlrev_b32 v195, 16, v28
    v_lshlrev_b32 v196, 16, v32
    v_lshlrev_b32 v197, 16, v36
    v_lshlrev_b32 v198, 16, v40
    v_lshlrev_b32 v199, 16, v44
    v_lshlrev_b32 v200, 16, v48
    v_lshlrev_b32 v201, 16, v52
    v_lshlrev_b32 v202, 16, v56
    v_lshlrev_b32 v212, 16, v64
    v_mul_f32 v204, v192, v99
    v_fmac_f32 v204, v193, v98
    v_fmac_f32 v204, v194, v97
    v_fmac_f32 v204, v195, v96
    v_mul_f32 v204, v204, v212
    v_lshlrev_b32 v213, 16, v68
    v_mul_f32 v205, v193, v99
    v_fmac_f32 v205, v194, v98
    v_fmac_f32 v205, v195, v97
    v_fmac_f32 v205, v196, v96
    v_mul_f32 v205, v205, v213
    v_lshlrev_b32 v214, 16, v72
    v_mul_f32 v206, v194, v99
    v_fmac_f32 v206, v195, v98
    v_fmac_f32 v206, v196, v97
    v_fmac_f32 v206, v197, v96
    v_mul_f32 v206, v206, v214
    v_lshlrev_b32 v215, 16, v76
    v_mul_f32 v207, v195, v99
    v_fmac_f32 v207, v196, v98
    v_fmac_f32 v207, v197, v97
    v_fmac_f32 v207, v198, v96
    v_mul_f32 v207, v207, v215
    v_lshlrev_b32 v216, 16, v80
    v_mul_f32 v208, v196, v99
    v_fmac_f32 v208, v197, v98
    v_fmac_f32 v208, v198, v97
    v_fmac_f32 v208, v199, v96
    v_mul_f32 v208, v208, v216
    v_lshlrev_b32 v217, 16, v84
    v_mul_f32 v209, v197, v99
    v_fmac_f32 v209, v198, v98
    v_fmac_f32 v209, v199, v97
    v_fmac_f32 v209, v200, v96
    v_mul_f32 v209, v209, v217
    v_lshlrev_b32 v218, 16, v88
    v_mul_f32 v210, v198, v99
    v_fmac_f32 v210, v199, v98
    v_fmac_f32 v210, v200, v97
    v_fmac_f32 v210, v201, v96
    v_mul_f32 v210, v210, v218
    v_lshlrev_b32 v219, 16, v92
    v_mul_f32 v211, v199, v99
    v_fmac_f32 v211, v200, v98
    v_fmac_f32 v211, v201, v97
    v_fmac_f32 v211, v202, v96
    v_mul_f32 v211, v211, v219
    v_cvt_pk_bf16_f32 v128, v211, v210
    v_cvt_pk_bf16_f32 v129, v209, v208
    v_cvt_pk_bf16_f32 v130, v207, v206
    v_cvt_pk_bf16_f32 v131, v205, v204
    ds_write_b128 v5, v[128:131] offset:0
    v_and_b32 v192, 0xffff0000, v16
    v_and_b32 v193, 0xffff0000, v20
    v_and_b32 v194, 0xffff0000, v24
    v_and_b32 v195, 0xffff0000, v28
    v_and_b32 v196, 0xffff0000, v32
    v_and_b32 v197, 0xffff0000, v36
    v_and_b32 v198, 0xffff0000, v40
    v_and_b32 v199, 0xffff0000, v44
    v_and_b32 v200, 0xffff0000, v48
    v_and_b32 v201, 0xffff0000, v52
    v_and_b32 v202, 0xffff0000, v56
    v_and_b32 v212, 0xffff0000, v64
    v_mul_f32 v204, v192, v103
    v_fmac_f32 v204, v193, v102
    v_fmac_f32 v204, v194, v101
    v_fmac_f32 v204, v195, v100
    v_mul_f32 v204, v204, v212
    v_and_b32 v213, 0xffff0000, v68
    v_mul_f32 v205, v193, v103
    v_fmac_f32 v205, v194, v102
    v_fmac_f32 v205, v195, v101
    v_fmac_f32 v205, v196, v100
    v_mul_f32 v205, v205, v213
    v_and_b32 v214, 0xffff0000, v72
    v_mul_f32 v206, v194, v103
    v_fmac_f32 v206, v195, v102
    v_fmac_f32 v206, v196, v101
    v_fmac_f32 v206, v197, v100
    v_mul_f32 v206, v206, v214
    v_and_b32 v215, 0xffff0000, v76
    v_mul_f32 v207, v195, v103
    v_fmac_f32 v207, v196, v102
    v_fmac_f32 v207, v197, v101
    v_fmac_f32 v207, v198, v100
    v_mul_f32 v207, v207, v215
    v_and_b32 v216, 0xffff0000, v80
    v_mul_f32 v208, v196, v103
    v_fmac_f32 v208, v197, v102
    v_fmac_f32 v208, v198, v101
    v_fmac_f32 v208, v199, v100
    v_mul_f32 v208, v208, v216
    v_and_b32 v217, 0xffff0000, v84
    v_mul_f32 v209, v197, v103
    v_fmac_f32 v209, v198, v102
    v_fmac_f32 v209, v199, v101
    v_fmac_f32 v209, v200, v100
    v_mul_f32 v209, v209, v217
    v_and_b32 v218, 0xffff0000, v88
    v_mul_f32 v210, v198, v103
    v_fmac_f32 v210, v199, v102
    v_fmac_f32 v210, v200, v101
    v_fmac_f32 v210, v201, v100
    v_mul_f32 v210, v210, v218
    v_and_b32 v219, 0xffff0000, v92
    v_mul_f32 v211, v199, v103
    v_fmac_f32 v211, v200, v102
    v_fmac_f32 v211, v201, v101
    v_fmac_f32 v211, v202, v100
    v_mul_f32 v211, v211, v219
    v_cvt_pk_bf16_f32 v132, v211, v210
    v_cvt_pk_bf16_f32 v133, v209, v208
    v_cvt_pk_bf16_f32 v134, v207, v206
    v_cvt_pk_bf16_f32 v135, v205, v204
    ds_write_b128 v5, v[132:135] offset:4624
    v_lshlrev_b32 v192, 16, v17
    v_lshlrev_b32 v193, 16, v21
    v_lshlrev_b32 v194, 16, v25
    v_lshlrev_b32 v195, 16, v29
    v_lshlrev_b32 v196, 16, v33
    v_lshlrev_b32 v197, 16, v37
    v_lshlrev_b32 v198, 16, v41
    v_lshlrev_b32 v199, 16, v45
    v_lshlrev_b32 v200, 16, v49
    v_lshlrev_b32 v201, 16, v53
    v_lshlrev_b32 v202, 16, v57
    v_lshlrev_b32 v212, 16, v65
    v_mul_f32 v204, v192, v107
    v_fmac_f32 v204, v193, v106
    v_fmac_f32 v204, v194, v105
    v_fmac_f32 v204, v195, v104
    v_mul_f32 v204, v204, v212
    v_lshlrev_b32 v213, 16, v69
    v_mul_f32 v205, v193, v107
    v_fmac_f32 v205, v194, v106
    v_fmac_f32 v205, v195, v105
    v_fmac_f32 v205, v196, v104
    v_mul_f32 v205, v205, v213
    v_lshlrev_b32 v214, 16, v73
    v_mul_f32 v206, v194, v107
    v_fmac_f32 v206, v195, v106
    v_fmac_f32 v206, v196, v105
    v_fmac_f32 v206, v197, v104
    v_mul_f32 v206, v206, v214
    v_lshlrev_b32 v215, 16, v77
    v_mul_f32 v207, v195, v107
    v_fmac_f32 v207, v196, v106
    v_fmac_f32 v207, v197, v105
    v_fmac_f32 v207, v198, v104
    v_mul_f32 v207, v207, v215
    v_lshlrev_b32 v216, 16, v81
    v_mul_f32 v208, v196, v107
    v_fmac_f32 v208, v197, v106
    v_fmac_f32 v208, v198, v105
    v_fmac_f32 v208, v199, v104
    v_mul_f32 v208, v208, v216
    v_lshlrev_b32 v217, 16, v85
    v_mul_f32 v209, v197, v107
    v_fmac_f32 v209, v198, v106
    v_fmac_f32 v209, v199, v105
    v_fmac_f32 v209, v200, v104
    v_mul_f32 v209, v209, v217
    v_lshlrev_b32 v218, 16, v89
    v_mul_f32 v210, v198, v107
    v_fmac_f32 v210, v199, v106
    v_fmac_f32 v210, v200, v105
    v_fmac_f32 v210, v201, v104
    v_mul_f32 v210, v210, v218
    v_lshlrev_b32 v219, 16, v93
    v_mul_f32 v211, v199, v107
    v_fmac_f32 v211, v200, v106
    v_fmac_f32 v211, v201, v105
    v_fmac_f32 v211, v202, v104
    v_mul_f32 v211, v211, v219
    v_cvt_pk_bf16_f32 v128, v211, v210
    v_cvt_pk_bf16_f32 v129, v209, v208
    v_cvt_pk_bf16_f32 v130, v207, v206
    v_cvt_pk_bf16_f32 v131, v205, v204
    ds_write_b128 v5, v[128:131] offset:9248
    v_and_b32 v192, 0xffff0000, v17
    v_and_b32 v193, 0xffff0000, v21
    v_and_b32 v194, 0xffff0000, v25
    v_and_b32 v195, 0xffff0000, v29
    v_and_b32 v196, 0xffff0000, v33
    v_and_b32 v197, 0xffff0000, v37
    v_and_b32 v198, 0xffff0000, v41
    v_and_b32 v199, 0xffff0000, v45
    v_and_b32 v200, 0xffff0000, v49
    v_and_b32 v201, 0xffff0000, v53
    v_and_b32 v202, 0xffff0000, v57
    v_and_b32 v212, 0xffff0000, v65
    v_mul_f32 v204, v192, v111
    v_fmac_f32 v204, v193, v110
    v_fmac_f32 v204, v194, v109
    v_fmac_f32 v204, v195, v108
    v_mul_f32 v204, v204, v212
    v_and_b32 v213, 0xffff0000, v69
    v_mul_f32 v205, v193, v111
    v_fmac_f32 v205, v194, v110
    v_fmac_f32 v205, v195, v109
    v_fmac_f32 v205, v196, v108
    v_mul_f32 v205, v205, v213
    v_and_b32 v214, 0xffff0000, v73
    v_mul_f32 v206, v194, v111
    v_fmac_f32 v206, v195, v110
    v_fmac_f32 v206, v196, v109
    v_fmac_f32 v206, v197, v108
    v_mul_f32 v206, v206, v214
    v_and_b32 v215, 0xffff0000, v77
    v_mul_f32 v207, v195, v111
    v_fmac_f32 v207, v196, v110
    v_fmac_f32 v207, v197, v109
    v_fmac_f32 v207, v198, v108
    v_mul_f32 v207, v207, v215
    v_and_b32 v216, 0xffff0000, v81
    v_mul_f32 v208, v196, v111
    v_fmac_f32 v208, v197, v110
    v_fmac_f32 v208, v198, v109
    v_fmac_f32 v208, v199, v108
    v_mul_f32 v208, v208, v216
    v_and_b32 v217, 0xffff0000, v85
    v_mul_f32 v209, v197, v111
    v_fmac_f32 v209, v198, v110
    v_fmac_f32 v209, v199, v109
    v_fmac_f32 v209, v200, v108
    v_mul_f32 v209, v209, v217
    v_and_b32 v218, 0xffff0000, v89
    v_mul_f32 v210, v198, v111
    v_fmac_f32 v210, v199, v110
    v_fmac_f32 v210, v200, v109
    v_fmac_f32 v210, v201, v108
    v_mul_f32 v210, v210, v218
    v_and_b32 v219, 0xffff0000, v93
    v_mul_f32 v211, v199, v111
    v_fmac_f32 v211, v200, v110
    v_fmac_f32 v211, v201, v109
    v_fmac_f32 v211, v202, v108
    v_mul_f32 v211, v211, v219
    v_cvt_pk_bf16_f32 v132, v211, v210
    v_cvt_pk_bf16_f32 v133, v209, v208
    v_cvt_pk_bf16_f32 v134, v207, v206
    v_cvt_pk_bf16_f32 v135, v205, v204
    ds_write_b128 v5, v[132:135] offset:13872
    v_lshlrev_b32 v192, 16, v18
    v_lshlrev_b32 v193, 16, v22
    v_lshlrev_b32 v194, 16, v26
    v_lshlrev_b32 v195, 16, v30
    v_lshlrev_b32 v196, 16, v34
    v_lshlrev_b32 v197, 16, v38
    v_lshlrev_b32 v198, 16, v42
    v_lshlrev_b32 v199, 16, v46
    v_lshlrev_b32 v200, 16, v50
    v_lshlrev_b32 v201, 16, v54
    v_lshlrev_b32 v202, 16, v58
    v_lshlrev_b32 v212, 16, v66
    v_mul_f32 v204, v192, v115
    v_fmac_f32 v204, v193, v114
    v_fmac_f32 v204, v194, v113
    v_fmac_f32 v204, v195, v112
    v_mul_f32 v204, v204, v212
    v_lshlrev_b32 v213, 16, v70
    v_mul_f32 v205, v193, v115
    v_fmac_f32 v205, v194, v114
    v_fmac_f32 v205, v195, v113
    v_fmac_f32 v205, v196, v112
    v_mul_f32 v205, v205, v213
    v_lshlrev_b32 v214, 16, v74
    v_mul_f32 v206, v194, v115
    v_fmac_f32 v206, v195, v114
    v_fmac_f32 v206, v196, v113
    v_fmac_f32 v206, v197, v112
    v_mul_f32 v206, v206, v214
    v_lshlrev_b32 v215, 16, v78
    v_mul_f32 v207, v195, v115
    v_fmac_f32 v207, v196, v114
    v_fmac_f32 v207, v197, v113
    v_fmac_f32 v207, v198, v112
    v_mul_f32 v207, v207, v215
    v_lshlrev_b32 v216, 16, v82
    v_mul_f32 v208, v196, v115
    v_fmac_f32 v208, v197, v114
    v_fmac_f32 v208, v198, v113
    v_fmac_f32 v208, v199, v112
    v_mul_f32 v208, v208, v216
    v_lshlrev_b32 v217, 16, v86
    v_mul_f32 v209, v197, v115
    v_fmac_f32 v209, v198, v114
    v_fmac_f32 v209, v199, v113
    v_fmac_f32 v209, v200, v112
    v_mul_f32 v209, v209, v217
    v_lshlrev_b32 v218, 16, v90
    v_mul_f32 v210, v198, v115
    v_fmac_f32 v210, v199, v114
    v_fmac_f32 v210, v200, v113
    v_fmac_f32 v210, v201, v112
    v_mul_f32 v210, v210, v218
    v_lshlrev_b32 v219, 16, v94
    v_mul_f32 v211, v199, v115
    v_fmac_f32 v211, v200, v114
    v_fmac_f32 v211, v201, v113
    v_fmac_f32 v211, v202, v112
    v_mul_f32 v211, v211, v219
    v_cvt_pk_bf16_f32 v128, v211, v210
    v_cvt_pk_bf16_f32 v129, v209, v208
    v_cvt_pk_bf16_f32 v130, v207, v206
    v_cvt_pk_bf16_f32 v131, v205, v204
    ds_write_b128 v5, v[128:131] offset:18496
    v_and_b32 v192, 0xffff0000, v18
    v_and_b32 v193, 0xffff0000, v22
    v_and_b32 v194, 0xffff0000, v26
    v_and_b32 v195, 0xffff0000, v30
    v_and_b32 v196, 0xffff0000, v34
    v_and_b32 v197, 0xffff0000, v38
    v_and_b32 v198, 0xffff0000, v42
    v_and_b32 v199, 0xffff0000, v46
    v_and_b32 v200, 0xffff0000, v50
    v_and_b32 v201, 0xffff0000, v54
    v_and_b32 v202, 0xffff0000, v58
    v_and_b32 v212, 0xffff0000, v66
    v_mul_f32 v204, v192, v119
    v_fmac_f32 v204, v193, v118
    v_fmac_f32 v204, v194, v117
    v_fmac_f32 v204, v195, v116
    v_mul_f32 v204, v204, v212
    v_and_b32 v213, 0xffff0000, v70
    v_mul_f32 v205, v193, v119
    v_fmac_f32 v205, v194, v118
    v_fmac_f32 v205, v195, v117
    v_fmac_f32 v205, v196, v116
    v_mul_f32 v205, v205, v213
    v_and_b32 v214, 0xffff0000, v74
    v_mul_f32 v206, v194, v119
    v_fmac_f32 v206, v195, v118
    v_fmac_f32 v206, v196, v117
    v_fmac_f32 v206, v197, v116
    v_mul_f32 v206, v206, v214
    v_and_b32 v215, 0xffff0000, v78
    v_mul_f32 v207, v195, v119
    v_fmac_f32 v207, v196, v118
    v_fmac_f32 v207, v197, v117
    v_fmac_f32 v207, v198, v116
    v_mul_f32 v207, v207, v215
    v_and_b32 v216, 0xffff0000, v82
    v_mul_f32 v208, v196, v119
    v_fmac_f32 v208, v197, v118
    v_fmac_f32 v208, v198, v117
    v_fmac_f32 v208, v199, v116
    v_mul_f32 v208, v208, v216
    v_and_b32 v217, 0xffff0000, v86
    v_mul_f32 v209, v197, v119
    v_fmac_f32 v209, v198, v118
    v_fmac_f32 v209, v199, v117
    v_fmac_f32 v209, v200, v116
    v_mul_f32 v209, v209, v217
    v_and_b32 v218, 0xffff0000, v90
    v_mul_f32 v210, v198, v119
    v_fmac_f32 v210, v199, v118
    v_fmac_f32 v210, v200, v117
    v_fmac_f32 v210, v201, v116
    v_mul_f32 v210, v210, v218
    v_and_b32 v219, 0xffff0000, v94
    v_mul_f32 v211, v199, v119
    v_fmac_f32 v211, v200, v118
    v_fmac_f32 v211, v201, v117
    v_fmac_f32 v211, v202, v116
    v_mul_f32 v211, v211, v219
    v_cvt_pk_bf16_f32 v132, v211, v210
    v_cvt_pk_bf16_f32 v133, v209, v208
    v_cvt_pk_bf16_f32 v134, v207, v206
    v_cvt_pk_bf16_f32 v135, v205, v204
    ds_write_b128 v5, v[132:135] offset:23120
    v_lshlrev_b32 v192, 16, v19
    v_lshlrev_b32 v193, 16, v23
    v_lshlrev_b32 v194, 16, v27
    v_lshlrev_b32 v195, 16, v31
    v_lshlrev_b32 v196, 16, v35
    v_lshlrev_b32 v197, 16, v39
    v_lshlrev_b32 v198, 16, v43
    v_lshlrev_b32 v199, 16, v47
    v_lshlrev_b32 v200, 16, v51
    v_lshlrev_b32 v201, 16, v55
    v_lshlrev_b32 v202, 16, v59
    v_lshlrev_b32 v212, 16, v67
    v_mul_f32 v204, v192, v123
    v_fmac_f32 v204, v193, v122
    v_fmac_f32 v204, v194, v121
    v_fmac_f32 v204, v195, v120
    v_mul_f32 v204, v204, v212
    v_lshlrev_b32 v213, 16, v71
    v_mul_f32 v205, v193, v123
    v_fmac_f32 v205, v194, v122
    v_fmac_f32 v205, v195, v121
    v_fmac_f32 v205, v196, v120
    v_mul_f32 v205, v205, v213
    v_lshlrev_b32 v214, 16, v75
    v_mul_f32 v206, v194, v123
    v_fmac_f32 v206, v195, v122
    v_fmac_f32 v206, v196, v121
    v_fmac_f32 v206, v197, v120
    v_mul_f32 v206, v206, v214
    v_lshlrev_b32 v215, 16, v79
    v_mul_f32 v207, v195, v123
    v_fmac_f32 v207, v196, v122
    v_fmac_f32 v207, v197, v121
    v_fmac_f32 v207, v198, v120
    v_mul_f32 v207, v207, v215
    v_lshlrev_b32 v216, 16, v83
    v_mul_f32 v208, v196, v123
    v_fmac_f32 v208, v197, v122
    v_fmac_f32 v208, v198, v121
    v_fmac_f32 v208, v199, v120
    v_mul_f32 v208, v208, v216
    v_lshlrev_b32 v217, 16, v87
    v_mul_f32 v209, v197, v123
    v_fmac_f32 v209, v198, v122
    v_fmac_f32 v209, v199, v121
    v_fmac_f32 v209, v200, v120
    v_mul_f32 v209, v209, v217
    v_lshlrev_b32 v218, 16, v91
    v_mul_f32 v210, v198, v123
    v_fmac_f32 v210, v199, v122
    v_fmac_f32 v210, v200, v121
    v_fmac_f32 v210, v201, v120
    v_mul_f32 v210, v210, v218
    v_lshlrev_b32 v219, 16, v95
    v_mul_f32 v211, v199, v123
    v_fmac_f32 v211, v200, v122
    v_fmac_f32 v211, v201, v121
    v_fmac_f32 v211, v202, v120
    v_mul_f32 v211, v211, v219
    v_cvt_pk_bf16_f32 v128, v211, v210
    v_cvt_pk_bf16_f32 v129, v209, v208
    v_cvt_pk_bf16_f32 v130, v207, v206
    v_cvt_pk_bf16_f32 v131, v205, v204
    ds_write_b128 v5, v[128:131] offset:27744
    v_and_b32 v192, 0xffff0000, v19
    v_and_b32 v193, 0xffff0000, v23
    v_and_b32 v194, 0xffff0000, v27
    v_and_b32 v195, 0xffff0000, v31
    v_and_b32 v196, 0xffff0000, v35
    v_and_b32 v197, 0xffff0000, v39
    v_and_b32 v198, 0xffff0000, v43
    v_and_b32 v199, 0xffff0000, v47
    v_and_b32 v200, 0xffff0000, v51
    v_and_b32 v201, 0xffff0000, v55
    v_and_b32 v202, 0xffff0000, v59
    v_and_b32 v212, 0xffff0000, v67
    v_mul_f32 v204, v192, v127
    v_fmac_f32 v204, v193, v126
    v_fmac_f32 v204, v194, v125
    v_fmac_f32 v204, v195, v124
    v_mul_f32 v204, v204, v212
    v_and_b32 v213, 0xffff0000, v71
    v_mul_f32 v205, v193, v127
    v_fmac_f32 v205, v194, v126
    v_fmac_f32 v205, v195, v125
    v_fmac_f32 v205, v196, v124
    v_mul_f32 v205, v205, v213
    v_and_b32 v214, 0xffff0000, v75
    v_mul_f32 v206, v194, v127
    v_fmac_f32 v206, v195, v126
    v_fmac_f32 v206, v196, v125
    v_fmac_f32 v206, v197, v124
    v_mul_f32 v206, v206, v214
    v_and_b32 v215, 0xffff0000, v79
    v_mul_f32 v207, v195, v127
    v_fmac_f32 v207, v196, v126
    v_fmac_f32 v207, v197, v125
    v_fmac_f32 v207, v198, v124
    v_mul_f32 v207, v207, v215
    v_and_b32 v216, 0xffff0000, v83
    v_mul_f32 v208, v196, v127
    v_fmac_f32 v208, v197, v126
    v_fmac_f32 v208, v198, v125
    v_fmac_f32 v208, v199, v124
    v_mul_f32 v208, v208, v216
    v_and_b32 v217, 0xffff0000, v87
    v_mul_f32 v209, v197, v127
    v_fmac_f32 v209, v198, v126
    v_fmac_f32 v209, v199, v125
    v_fmac_f32 v209, v200, v124
    v_mul_f32 v209, v209, v217
    v_and_b32 v218, 0xffff0000, v91
    v_mul_f32 v210, v198, v127
    v_fmac_f32 v210, v199, v126
    v_fmac_f32 v210, v200, v125
    v_fmac_f32 v210, v201, v124
    v_mul_f32 v210, v210, v218
    v_and_b32 v219, 0xffff0000, v95
    v_mul_f32 v211, v199, v127
    v_fmac_f32 v211, v200, v126
    v_fmac_f32 v211, v201, v125
    v_fmac_f32 v211, v202, v124
    v_mul_f32 v211, v211, v219
    v_cvt_pk_bf16_f32 v132, v211, v210
    v_cvt_pk_bf16_f32 v133, v209, v208
    v_cvt_pk_bf16_f32 v134, v207, v206
    v_cvt_pk_bf16_f32 v135, v205, v204
    ds_write_b128 v5, v[132:135] offset:32368
    s_mul_i32 s32, s62, 32
    s_mul_i32 s47, s24, 4
    s_add_u32 s32, s32, s47
    s_buffer_load_dword s64, s[16:19], s32
    s_waitcnt vmcnt(1)
    s_mul_i32 s32, s62, 65536
    s_mul_i32 s47, s24, 8192
    s_add_u32 s32, s32, s47
    v_lshlrev_b32 v7, 4, v1
    v_add_u32 v7, s32, v7
    s_mul_i32 s32, s24, 8320
    s_add_u32 s32, s32, 74144
    v_lshlrev_b32 v8, 4, v1
    v_add_u32 v8, s32, v8
    v_and_b32 v2, 15, v1
    v_lshlrev_b32 v3, 0, v2
    v_add_u32 v3, 1, v3
    s_mul_i32 s32, s24, 8320
    s_add_u32 s32, s32, 74112
    v_and_b32 v2, 1, v3
    v_mul_u32_u24 v2, 4160, v2
    v_mov_b32 v9, v2
    v_lshrrev_b32 v2, 1, v3
    v_lshl_add_u32 v9, v2, 2, v9
    v_bfe_u32 v2, v1, 4, 2
    v_lshl_add_u32 v9, v2, 4, v9
    v_add_u32 v9, s32, v9
    v_add_u32 v10, 1024, v9
    v_add_u32 v11, 2048, v9
    v_add_u32 v12, 3072, v9
    s_mul_i32 s32, s24, 9248
    s_bfe_u32 s47, s24, 0x10002
    s_mul_i32 s47, s47, 64
    s_add_u32 s32, s32, s47
    s_add_u32 s32, s32, 480
    v_bfe_u32 v2, v1, 4, 2
    v_lshlrev_b32 v13, 4, v2
    v_and_b32 v2, 15, v1
    v_mul_u32_u24 v2, 32, v2
    v_sub_u32 v13, v13, v2
    v_add_u32 v13, s32, v13
    s_mul_i32 s32, s24, 9248
    s_bfe_u32 s47, s24, 0x10002
    s_mul_i32 s47, s47, 64
    s_add_u32 s32, s32, s47
    s_add_u32 s32, s32, 504
    v_bfe_u32 v2, v1, 4, 2
    v_mul_u32_u24 v2, 8, v2
    v_sub_u32 v14, 0, v2
    v_and_b32 v2, 15, v1
    v_mul_u32_u24 v2, 32, v2
    v_sub_u32 v14, v14, v2
    v_add_u32 v14, s32, v14
    s_mov_b32 s28, 0
    s_waitcnt lgkmcnt(0)
    s_barrier
L_b_ch:
    s_lshl_b32 s32, s28, 12
    buffer_load_dwordx4 v[176:179], v7, s[8:11], s32 offen offset:0
    buffer_load_dword v180, v7, s[8:11], s32 offen offset:16
    buffer_load_dwordx4 v[184:187], v7, s[8:11], s32 offen offset:1024
    buffer_load_dword v188, v7, s[8:11], s32 offen offset:1040
    buffer_load_dwordx4 v[192:195], v7, s[8:11], s32 offen offset:2048
    buffer_load_dword v196, v7, s[8:11], s32 offen offset:2064
    buffer_load_dwordx4 v[200:203], v7, s[8:11], s32 offen offset:3072
    buffer_load_dword v204, v7, s[8:11], s32 offen offset:3088
    s_waitcnt vmcnt(6)
    ds_write_b128 v8, v[176:179] offset:0
    s_mov_b64 exec, 1
    v_lshlrev_b32 v2, 16, v176
    ds_write_b32 v8, v2 offset:4156
    s_mov_b64 exec, -1
    v_alignbit_b32 v208, v177, v176, 16
    v_alignbit_b32 v209, v178, v177, 16
    v_alignbit_b32 v210, v179, v178, 16
    v_alignbit_b32 v211, v180, v179, 16
    ds_write_b128 v8, v[208:211] offset:4160
    s_waitcnt vmcnt(4)
    ds_write_b128 v8, v[184:187] offset:1024
    v_alignbit_b32 v212, v185, v184, 16
    v_alignbit_b32 v213, v186, v185, 16
    v_alignbit_b32 v214, v187, v186, 16
    v_alignbit_b32 v215, v188, v187, 16
    ds_write_b128 v8, v[212:215] offset:5184
    s_waitcnt vmcnt(2)
    ds_write_b128 v8, v[192:195] offset:2048
    v_alignbit_b32 v216, v193, v192, 16
    v_alignbit_b32 v217, v194, v193, 16
    v_alignbit_b32 v218, v195, v194, 16
    v_alignbit_b32 v219, v196, v195, 16
    ds_write_b128 v8, v[216:219] offset:6208
    s_waitcnt vmcnt(0)
    ds_write_b128 v8, v[200:203] offset:3072
    v_alignbit_b32 v220, v201, v200, 16
    v_alignbit_b32 v221, v202, v201, 16
    v_alignbit_b32 v222, v203, v202, 16
    v_alignbit_b32 v223, v204, v203, 16
    ds_write_b128 v8, v[220:223] offset:7232
    ds_read2_b32 v[16:17], v9 offset0:0 offset1:1
    ds_read2_b32 v[18:19], v9 offset0:2 offset1:3
    ds_read_b128 v[48:51], v13 offset:3584
    ds_read2_b32 v[20:21], v9 offset0:128 offset1:129
    ds_read2_b32 v[22:23], v9 offset0:130 offset1:131
    ds_read_b128 v[52:55], v13 offset:3072
    ds_read2_b32 v[24:25], v10 offset0:0 offset1:1
    ds_read2_b32 v[26:27], v10 offset0:2 offset1:3
    ds_read_b128 v[56:59], v13 offset:2560
    ds_read2_b32 v[28:29], v10 offset0:128 offset1:129
    ds_read2_b32 v[30:31], v10 offset0:130 offset1:131
    ds_read_b128 v[60:63], v13 offset:2048
    ds_read2_b32 v[32:33], v11 offset0:0 offset1:1
    ds_read2_b32 v[34:35], v11 offset0:2 offset1:3
    ds_read_b128 v[64:67], v13 offset:1536
    ds_read2_b32 v[36:37], v11 offset0:128 offset1:129
    ds_read2_b32 v[38:39], v11 offset0:130 offset1:131
    ds_read_b128 v[68:71], v13 offset:1024
    ds_read2_b32 v[40:41], v12 offset0:0 offset1:1
    ds_read2_b32 v[42:43], v12 offset0:2 offset1:3
    ds_read_b128 v[72:75], v13 offset:512
    ds_read2_b32 v[44:45], v12 offset0:128 offset1:129
    ds_read2_b32 v[46:47], v12 offset0:130 offset1:131
    ds_read_b128 v[76:79], v13 offset:0
    s_waitcnt lgkmcnt(0)
    v_mfma_f32_16x16x32_bf16 v[144:147], v[16:19], v[48:51], 0
    ds_read2_b32 v[80:81], v9 offset0:16 offset1:17
    v_mfma_f32_16x16x32_bf16 v[148:151], v[16:19], v[52:55], 0
    ds_read2_b32 v[82:83], v9 offset0:18 offset1:19
    v_mfma_f32_16x16x32_bf16 v[152:155], v[16:19], v[56:59], 0
    ds_read_b128 v[112:115], v13 offset:3648
    v_mfma_f32_16x16x32_bf16 v[156:159], v[16:19], v[60:63], 0
    ds_read2_b32 v[84:85], v9 offset0:144 offset1:145
    v_mfma_f32_16x16x32_bf16 v[160:163], v[16:19], v[64:67], 0
    ds_read2_b32 v[86:87], v9 offset0:146 offset1:147
    v_mfma_f32_16x16x32_bf16 v[164:167], v[16:19], v[68:71], 0
    ds_read_b128 v[116:119], v13 offset:3136
    v_mfma_f32_16x16x32_bf16 v[168:171], v[16:19], v[72:75], 0
    ds_read2_b32 v[88:89], v10 offset0:16 offset1:17
    v_mfma_f32_16x16x32_bf16 v[172:175], v[16:19], v[76:79], 0
    ds_read2_b32 v[90:91], v10 offset0:18 offset1:19
    v_mfma_f32_16x16x32_bf16 v[148:151], v[20:23], v[48:51], v[148:151]
    ds_read_b128 v[120:123], v13 offset:2624
    v_mfma_f32_16x16x32_bf16 v[152:155], v[20:23], v[52:55], v[152:155]
    ds_read2_b32 v[92:93], v10 offset0:144 offset1:145
    v_mfma_f32_16x16x32_bf16 v[156:159], v[20:23], v[56:59], v[156:159]
    ds_read2_b32 v[94:95], v10 offset0:146 offset1:147
    v_mfma_f32_16x16x32_bf16 v[160:163], v[20:23], v[60:63], v[160:163]
    ds_read_b128 v[124:127], v13 offset:2112
    v_mfma_f32_16x16x32_bf16 v[164:167], v[20:23], v[64:67], v[164:167]
    ds_read2_b32 v[96:97], v11 offset0:16 offset1:17
    v_mfma_f32_16x16x32_bf16 v[168:171], v[20:23], v[68:71], v[168:171]
    ds_read2_b32 v[98:99], v11 offset0:18 offset1:19
    v_mfma_f32_16x16x32_bf16 v[172:175], v[20:23], v[72:75], v[172:175]
    ds_read_b128 v[128:131], v13 offset:1600
    v_mfma_f32_16x16x32_bf16 v[152:155], v[24:27], v[48:51], v[152:155]
    ds_read2_b32 v[100:101], v11 offset0:144 offset1:145
    v_mfma_f32_16x16x32_bf16 v[156:159], v[24:27], v[52:55], v[156:159]
    ds_read2_b32 v[102:103], v11 offset0:146 offset1:147
    v_mfma_f32_16x16x32_bf16 v[160:163], v[24:27], v[56:59], v[160:163]
    ds_read_b128 v[132:135], v13 offset:1088
    v_mfma_f32_16x16x32_bf16 v[164:167], v[24:27], v[60:63], v[164:167]
    ds_read2_b32 v[104:105], v12 offset0:16 offset1:17
    v_mfma_f32_16x16x32_bf16 v[168:171], v[24:27], v[64:67], v[168:171]
    ds_read2_b32 v[106:107], v12 offset0:18 offset1:19
    v_mfma_f32_16x16x32_bf16 v[172:175], v[24:27], v[68:71], v[172:175]
    ds_read_b128 v[136:139], v13 offset:576
    v_mfma_f32_16x16x32_bf16 v[156:159], v[28:31], v[48:51], v[156:159]
    ds_read2_b32 v[108:109], v12 offset0:144 offset1:145
    v_mfma_f32_16x16x32_bf16 v[160:163], v[28:31], v[52:55], v[160:163]
    ds_read2_b32 v[110:111], v12 offset0:146 offset1:147
    v_mfma_f32_16x16x32_bf16 v[164:167], v[28:31], v[56:59], v[164:167]
    ds_read_b128 v[140:143], v13 offset:64
    v_mfma_f32_16x16x32_bf16 v[168:171], v[28:31], v[60:63], v[168:171]
    v_mfma_f32_16x16x32_bf16 v[172:175], v[28:31], v[64:67], v[172:175]
    v_mfma_f32_16x16x32_bf16 v[160:163], v[32:35], v[48:51], v[160:163]
    v_mfma_f32_16x16x32_bf16 v[164:167], v[32:35], v[52:55], v[164:167]
    v_mfma_f32_16x16x32_bf16 v[168:171], v[32:35], v[56:59], v[168:171]
    v_mfma_f32_16x16x32_bf16 v[172:175], v[32:35], v[60:63], v[172:175]
    v_mfma_f32_16x16x32_bf16 v[164:167], v[36:39], v[48:51], v[164:167]
    v_mfma_f32_16x16x32_bf16 v[168:171], v[36:39], v[52:55], v[168:171]
    v_mfma_f32_16x16x32_bf16 v[172:175], v[36:39], v[56:59], v[172:175]
    v_mfma_f32_16x16x32_bf16 v[168:171], v[40:43], v[48:51], v[168:171]
    v_mfma_f32_16x16x32_bf16 v[172:175], v[40:43], v[52:55], v[172:175]
    v_mfma_f32_16x16x32_bf16 v[172:175], v[44:47], v[48:51], v[172:175]
    s_waitcnt lgkmcnt(0)
    v_mfma_f32_16x16x32_bf16 v[144:147], v[80:83], v[112:115], v[144:147]
    ds_read2_b32 v[16:17], v9 offset0:32 offset1:33
    v_mfma_f32_16x16x32_bf16 v[148:151], v[80:83], v[116:119], v[148:151]
    ds_read2_b32 v[18:19], v9 offset0:34 offset1:35
    v_mfma_f32_16x16x32_bf16 v[152:155], v[80:83], v[120:123], v[152:155]
    ds_read_b128 v[48:51], v13 offset:3712
    v_mfma_f32_16x16x32_bf16 v[156:159], v[80:83], v[124:127], v[156:159]
    ds_read2_b32 v[20:21], v9 offset0:160 offset1:161
    v_mfma_f32_16x16x32_bf16 v[160:163], v[80:83], v[128:131], v[160:163]
    ds_read2_b32 v[22:23], v9 offset0:162 offset1:163
    v_mfma_f32_16x16x32_bf16 v[164:167], v[80:83], v[132:135], v[164:167]
    ds_read_b128 v[52:55], v13 offset:3200
    v_mfma_f32_16x16x32_bf16 v[168:171], v[80:83], v[136:139], v[168:171]
    ds_read2_b32 v[24:25], v10 offset0:32 offset1:33
    v_mfma_f32_16x16x32_bf16 v[172:175], v[80:83], v[140:143], v[172:175]
    ds_read2_b32 v[26:27], v10 offset0:34 offset1:35
    v_mfma_f32_16x16x32_bf16 v[148:151], v[84:87], v[112:115], v[148:151]
    ds_read_b128 v[56:59], v13 offset:2688
    v_mfma_f32_16x16x32_bf16 v[152:155], v[84:87], v[116:119], v[152:155]
    ds_read2_b32 v[28:29], v10 offset0:160 offset1:161
    v_mfma_f32_16x16x32_bf16 v[156:159], v[84:87], v[120:123], v[156:159]
    ds_read2_b32 v[30:31], v10 offset0:162 offset1:163
    v_mfma_f32_16x16x32_bf16 v[160:163], v[84:87], v[124:127], v[160:163]
    ds_read_b128 v[60:63], v13 offset:2176
    v_mfma_f32_16x16x32_bf16 v[164:167], v[84:87], v[128:131], v[164:167]
    ds_read2_b32 v[32:33], v11 offset0:32 offset1:33
    v_mfma_f32_16x16x32_bf16 v[168:171], v[84:87], v[132:135], v[168:171]
    ds_read2_b32 v[34:35], v11 offset0:34 offset1:35
    v_mfma_f32_16x16x32_bf16 v[172:175], v[84:87], v[136:139], v[172:175]
    ds_read_b128 v[64:67], v13 offset:1664
    v_mfma_f32_16x16x32_bf16 v[152:155], v[88:91], v[112:115], v[152:155]
    ds_read2_b32 v[36:37], v11 offset0:160 offset1:161
    v_mfma_f32_16x16x32_bf16 v[156:159], v[88:91], v[116:119], v[156:159]
    ds_read2_b32 v[38:39], v11 offset0:162 offset1:163
    v_mfma_f32_16x16x32_bf16 v[160:163], v[88:91], v[120:123], v[160:163]
    ds_read_b128 v[68:71], v13 offset:1152
    v_mfma_f32_16x16x32_bf16 v[164:167], v[88:91], v[124:127], v[164:167]
    ds_read2_b32 v[40:41], v12 offset0:32 offset1:33
    v_mfma_f32_16x16x32_bf16 v[168:171], v[88:91], v[128:131], v[168:171]
    ds_read2_b32 v[42:43], v12 offset0:34 offset1:35
    v_mfma_f32_16x16x32_bf16 v[172:175], v[88:91], v[132:135], v[172:175]
    ds_read_b128 v[72:75], v13 offset:640
    v_mfma_f32_16x16x32_bf16 v[156:159], v[92:95], v[112:115], v[156:159]
    ds_read2_b32 v[44:45], v12 offset0:160 offset1:161
    v_mfma_f32_16x16x32_bf16 v[160:163], v[92:95], v[116:119], v[160:163]
    ds_read2_b32 v[46:47], v12 offset0:162 offset1:163
    v_mfma_f32_16x16x32_bf16 v[164:167], v[92:95], v[120:123], v[164:167]
    ds_read_b128 v[76:79], v13 offset:128
    v_mfma_f32_16x16x32_bf16 v[168:171], v[92:95], v[124:127], v[168:171]
    v_mfma_f32_16x16x32_bf16 v[172:175], v[92:95], v[128:131], v[172:175]
    v_mfma_f32_16x16x32_bf16 v[160:163], v[96:99], v[112:115], v[160:163]
    v_mfma_f32_16x16x32_bf16 v[164:167], v[96:99], v[116:119], v[164:167]
    v_mfma_f32_16x16x32_bf16 v[168:171], v[96:99], v[120:123], v[168:171]
    v_mfma_f32_16x16x32_bf16 v[172:175], v[96:99], v[124:127], v[172:175]
    v_mfma_f32_16x16x32_bf16 v[164:167], v[100:103], v[112:115], v[164:167]
    v_mfma_f32_16x16x32_bf16 v[168:171], v[100:103], v[116:119], v[168:171]
    v_mfma_f32_16x16x32_bf16 v[172:175], v[100:103], v[120:123], v[172:175]
    v_mfma_f32_16x16x32_bf16 v[168:171], v[104:107], v[112:115], v[168:171]
    v_mfma_f32_16x16x32_bf16 v[172:175], v[104:107], v[116:119], v[172:175]
    v_mfma_f32_16x16x32_bf16 v[172:175], v[108:111], v[112:115], v[172:175]
    s_waitcnt lgkmcnt(0)
    v_mfma_f32_16x16x32_bf16 v[144:147], v[16:19], v[48:51], v[144:147]
    ds_read2_b32 v[80:81], v9 offset0:48 offset1:49
    v_mfma_f32_16x16x32_bf16 v[148:151], v[16:19], v[52:55], v[148:151]
    ds_read2_b32 v[82:83], v9 offset0:50 offset1:51
    v_mfma_f32_16x16x32_bf16 v[152:155], v[16:19], v[56:59], v[152:155]
    ds_read_b128 v[112:115], v13 offset:3776
    v_mfma_f32_16x16x32_bf16 v[156:159], v[16:19], v[60:63], v[156:159]
    ds_read2_b32 v[84:85], v9 offset0:176 offset1:177
    v_mfma_f32_16x16x32_bf16 v[160:163], v[16:19], v[64:67], v[160:163]
    ds_read2_b32 v[86:87], v9 offset0:178 offset1:179
    v_mfma_f32_16x16x32_bf16 v[164:167], v[16:19], v[68:71], v[164:167]
    ds_read_b128 v[116:119], v13 offset:3264
    v_mfma_f32_16x16x32_bf16 v[168:171], v[16:19], v[72:75], v[168:171]
    ds_read2_b32 v[88:89], v10 offset0:48 offset1:49
    v_mfma_f32_16x16x32_bf16 v[172:175], v[16:19], v[76:79], v[172:175]
    ds_read2_b32 v[90:91], v10 offset0:50 offset1:51
    v_mfma_f32_16x16x32_bf16 v[148:151], v[20:23], v[48:51], v[148:151]
    ds_read_b128 v[120:123], v13 offset:2752
    v_mfma_f32_16x16x32_bf16 v[152:155], v[20:23], v[52:55], v[152:155]
    ds_read2_b32 v[92:93], v10 offset0:176 offset1:177
    v_mfma_f32_16x16x32_bf16 v[156:159], v[20:23], v[56:59], v[156:159]
    ds_read2_b32 v[94:95], v10 offset0:178 offset1:179
    v_mfma_f32_16x16x32_bf16 v[160:163], v[20:23], v[60:63], v[160:163]
    ds_read_b128 v[124:127], v13 offset:2240
    v_mfma_f32_16x16x32_bf16 v[164:167], v[20:23], v[64:67], v[164:167]
    ds_read2_b32 v[96:97], v11 offset0:48 offset1:49
    v_mfma_f32_16x16x32_bf16 v[168:171], v[20:23], v[68:71], v[168:171]
    ds_read2_b32 v[98:99], v11 offset0:50 offset1:51
    v_mfma_f32_16x16x32_bf16 v[172:175], v[20:23], v[72:75], v[172:175]
    ds_read_b128 v[128:131], v13 offset:1728
    v_mfma_f32_16x16x32_bf16 v[152:155], v[24:27], v[48:51], v[152:155]
    ds_read2_b32 v[100:101], v11 offset0:176 offset1:177
    v_mfma_f32_16x16x32_bf16 v[156:159], v[24:27], v[52:55], v[156:159]
    ds_read2_b32 v[102:103], v11 offset0:178 offset1:179
    v_mfma_f32_16x16x32_bf16 v[160:163], v[24:27], v[56:59], v[160:163]
    ds_read_b128 v[132:135], v13 offset:1216
    v_mfma_f32_16x16x32_bf16 v[164:167], v[24:27], v[60:63], v[164:167]
    ds_read2_b32 v[104:105], v12 offset0:48 offset1:49
    v_mfma_f32_16x16x32_bf16 v[168:171], v[24:27], v[64:67], v[168:171]
    ds_read2_b32 v[106:107], v12 offset0:50 offset1:51
    v_mfma_f32_16x16x32_bf16 v[172:175], v[24:27], v[68:71], v[172:175]
    ds_read_b128 v[136:139], v13 offset:704
    v_mfma_f32_16x16x32_bf16 v[156:159], v[28:31], v[48:51], v[156:159]
    ds_read2_b32 v[108:109], v12 offset0:176 offset1:177
    v_mfma_f32_16x16x32_bf16 v[160:163], v[28:31], v[52:55], v[160:163]
    ds_read2_b32 v[110:111], v12 offset0:178 offset1:179
    v_mfma_f32_16x16x32_bf16 v[164:167], v[28:31], v[56:59], v[164:167]
    ds_read_b128 v[140:143], v13 offset:192
    v_mfma_f32_16x16x32_bf16 v[168:171], v[28:31], v[60:63], v[168:171]
    v_mfma_f32_16x16x32_bf16 v[172:175], v[28:31], v[64:67], v[172:175]
    v_mfma_f32_16x16x32_bf16 v[160:163], v[32:35], v[48:51], v[160:163]
    v_mfma_f32_16x16x32_bf16 v[164:167], v[32:35], v[52:55], v[164:167]
    v_mfma_f32_16x16x32_bf16 v[168:171], v[32:35], v[56:59], v[168:171]
    v_mfma_f32_16x16x32_bf16 v[172:175], v[32:35], v[60:63], v[172:175]
    v_mfma_f32_16x16x32_bf16 v[164:167], v[36:39], v[48:51], v[164:167]
    v_mfma_f32_16x16x32_bf16 v[168:171], v[36:39], v[52:55], v[168:171]
    v_mfma_f32_16x16x32_bf16 v[172:175], v[36:39], v[56:59], v[172:175]
    v_mfma_f32_16x16x32_bf16 v[168:171], v[40:43], v[48:51], v[168:171]
    v_mfma_f32_16x16x32_bf16 v[172:175], v[40:43], v[52:55], v[172:175]
    v_mfma_f32_16x16x32_bf16 v[172:175], v[44:47], v[48:51], v[172:175]
    s_waitcnt lgkmcnt(0)
    v_mfma_f32_16x16x32_bf16 v[144:147], v[80:83], v[112:115], v[144:147]
    ds_read2_b32 v[16:17], v9 offset0:64 offset1:65
    v_mfma_f32_16x16x32_bf16 v[148:151], v[80:83], v[116:119], v[148:151]
    ds_read2_b32 v[18:19], v9 offset0:66 offset1:67
    v_mfma_f32_16x16x32_bf16 v[152:155], v[80:83], v[120:123], v[152:155]
    ds_read_b128 v[48:51], v13 offset:3840
    v_mfma_f32_16x16x32_bf16 v[156:159], v[80:83], v[124:127], v[156:159]
    ds_read2_b32 v[20:21], v9 offset0:192 offset1:193
    v_mfma_f32_16x16x32_bf16 v[160:163], v[80:83], v[128:131], v[160:163]
    ds_read2_b32 v[22:23], v9 offset0:194 offset1:195
    v_mfma_f32_16x16x32_bf16 v[164:167], v[80:83], v[132:135], v[164:167]
    ds_read_b128 v[52:55], v13 offset:3328
    v_mfma_f32_16x16x32_bf16 v[168:171], v[80:83], v[136:139], v[168:171]
    ds_read2_b32 v[24:25], v10 offset0:64 offset1:65
    v_mfma_f32_16x16x32_bf16 v[172:175], v[80:83], v[140:143], v[172:175]
    ds_read2_b32 v[26:27], v10 offset0:66 offset1:67
    v_mfma_f32_16x16x32_bf16 v[148:151], v[84:87], v[112:115], v[148:151]
    ds_read_b128 v[56:59], v13 offset:2816
    v_mfma_f32_16x16x32_bf16 v[152:155], v[84:87], v[116:119], v[152:155]
    ds_read2_b32 v[28:29], v10 offset0:192 offset1:193
    v_mfma_f32_16x16x32_bf16 v[156:159], v[84:87], v[120:123], v[156:159]
    ds_read2_b32 v[30:31], v10 offset0:194 offset1:195
    v_mfma_f32_16x16x32_bf16 v[160:163], v[84:87], v[124:127], v[160:163]
    ds_read_b128 v[60:63], v13 offset:2304
    v_mfma_f32_16x16x32_bf16 v[164:167], v[84:87], v[128:131], v[164:167]
    ds_read2_b32 v[32:33], v11 offset0:64 offset1:65
    v_mfma_f32_16x16x32_bf16 v[168:171], v[84:87], v[132:135], v[168:171]
    ds_read2_b32 v[34:35], v11 offset0:66 offset1:67
    v_mfma_f32_16x16x32_bf16 v[172:175], v[84:87], v[136:139], v[172:175]
    ds_read_b128 v[64:67], v13 offset:1792
    v_mfma_f32_16x16x32_bf16 v[152:155], v[88:91], v[112:115], v[152:155]
    ds_read2_b32 v[36:37], v11 offset0:192 offset1:193
    v_mfma_f32_16x16x32_bf16 v[156:159], v[88:91], v[116:119], v[156:159]
    ds_read2_b32 v[38:39], v11 offset0:194 offset1:195
    v_mfma_f32_16x16x32_bf16 v[160:163], v[88:91], v[120:123], v[160:163]
    ds_read_b128 v[68:71], v13 offset:1280
    v_mfma_f32_16x16x32_bf16 v[164:167], v[88:91], v[124:127], v[164:167]
    ds_read2_b32 v[40:41], v12 offset0:64 offset1:65
    v_mfma_f32_16x16x32_bf16 v[168:171], v[88:91], v[128:131], v[168:171]
    ds_read2_b32 v[42:43], v12 offset0:66 offset1:67
    v_mfma_f32_16x16x32_bf16 v[172:175], v[88:91], v[132:135], v[172:175]
    ds_read_b128 v[72:75], v13 offset:768
    v_mfma_f32_16x16x32_bf16 v[156:159], v[92:95], v[112:115], v[156:159]
    ds_read2_b32 v[44:45], v12 offset0:192 offset1:193
    v_mfma_f32_16x16x32_bf16 v[160:163], v[92:95], v[116:119], v[160:163]
    ds_read2_b32 v[46:47], v12 offset0:194 offset1:195
    v_mfma_f32_16x16x32_bf16 v[164:167], v[92:95], v[120:123], v[164:167]
    ds_read_b128 v[76:79], v13 offset:256
    v_mfma_f32_16x16x32_bf16 v[168:171], v[92:95], v[124:127], v[168:171]
    v_mfma_f32_16x16x32_bf16 v[172:175], v[92:95], v[128:131], v[172:175]
    v_mfma_f32_16x16x32_bf16 v[160:163], v[96:99], v[112:115], v[160:163]
    v_mfma_f32_16x16x32_bf16 v[164:167], v[96:99], v[116:119], v[164:167]
    v_mfma_f32_16x16x32_bf16 v[168:171], v[96:99], v[120:123], v[168:171]
    v_mfma_f32_16x16x32_bf16 v[172:175], v[96:99], v[124:127], v[172:175]
    v_mfma_f32_16x16x32_bf16 v[164:167], v[100:103], v[112:115], v[164:167]
    v_mfma_f32_16x16x32_bf16 v[168:171], v[100:103], v[116:119], v[168:171]
    v_mfma_f32_16x16x32_bf16 v[172:175], v[100:103], v[120:123], v[172:175]
    v_mfma_f32_16x16x32_bf16 v[168:171], v[104:107], v[112:115], v[168:171]
    v_mfma_f32_16x16x32_bf16 v[172:175], v[104:107], v[116:119], v[172:175]
    v_mfma_f32_16x16x32_bf16 v[172:175], v[108:111], v[112:115], v[172:175]
    s_waitcnt lgkmcnt(0)
    v_mfma_f32_16x16x32_bf16 v[144:147], v[16:19], v[48:51], v[144:147]
    ds_read2_b32 v[80:81], v9 offset0:80 offset1:81
    v_mfma_f32_16x16x32_bf16 v[148:151], v[16:19], v[52:55], v[148:151]
    ds_read2_b32 v[82:83], v9 offset0:82 offset1:83
    v_mfma_f32_16x16x32_bf16 v[152:155], v[16:19], v[56:59], v[152:155]
    ds_read_b128 v[112:115], v13 offset:3904
    v_mfma_f32_16x16x32_bf16 v[156:159], v[16:19], v[60:63], v[156:159]
    ds_read2_b32 v[84:85], v9 offset0:208 offset1:209
    v_mfma_f32_16x16x32_bf16 v[160:163], v[16:19], v[64:67], v[160:163]
    ds_read2_b32 v[86:87], v9 offset0:210 offset1:211
    v_mfma_f32_16x16x32_bf16 v[164:167], v[16:19], v[68:71], v[164:167]
    ds_read_b128 v[116:119], v13 offset:3392
    v_mfma_f32_16x16x32_bf16 v[168:171], v[16:19], v[72:75], v[168:171]
    ds_read2_b32 v[88:89], v10 offset0:80 offset1:81
    v_mfma_f32_16x16x32_bf16 v[172:175], v[16:19], v[76:79], v[172:175]
    ds_read2_b32 v[90:91], v10 offset0:82 offset1:83
    v_mfma_f32_16x16x32_bf16 v[148:151], v[20:23], v[48:51], v[148:151]
    ds_read_b128 v[120:123], v13 offset:2880
    v_mfma_f32_16x16x32_bf16 v[152:155], v[20:23], v[52:55], v[152:155]
    ds_read2_b32 v[92:93], v10 offset0:208 offset1:209
    v_mfma_f32_16x16x32_bf16 v[156:159], v[20:23], v[56:59], v[156:159]
    ds_read2_b32 v[94:95], v10 offset0:210 offset1:211
    v_mfma_f32_16x16x32_bf16 v[160:163], v[20:23], v[60:63], v[160:163]
    ds_read_b128 v[124:127], v13 offset:2368
    v_mfma_f32_16x16x32_bf16 v[164:167], v[20:23], v[64:67], v[164:167]
    ds_read2_b32 v[96:97], v11 offset0:80 offset1:81
    v_mfma_f32_16x16x32_bf16 v[168:171], v[20:23], v[68:71], v[168:171]
    ds_read2_b32 v[98:99], v11 offset0:82 offset1:83
    v_mfma_f32_16x16x32_bf16 v[172:175], v[20:23], v[72:75], v[172:175]
    ds_read_b128 v[128:131], v13 offset:1856
    v_mfma_f32_16x16x32_bf16 v[152:155], v[24:27], v[48:51], v[152:155]
    ds_read2_b32 v[100:101], v11 offset0:208 offset1:209
    v_mfma_f32_16x16x32_bf16 v[156:159], v[24:27], v[52:55], v[156:159]
    ds_read2_b32 v[102:103], v11 offset0:210 offset1:211
    v_mfma_f32_16x16x32_bf16 v[160:163], v[24:27], v[56:59], v[160:163]
    ds_read_b128 v[132:135], v13 offset:1344
    v_mfma_f32_16x16x32_bf16 v[164:167], v[24:27], v[60:63], v[164:167]
    ds_read2_b32 v[104:105], v12 offset0:80 offset1:81
    v_mfma_f32_16x16x32_bf16 v[168:171], v[24:27], v[64:67], v[168:171]
    ds_read2_b32 v[106:107], v12 offset0:82 offset1:83
    v_mfma_f32_16x16x32_bf16 v[172:175], v[24:27], v[68:71], v[172:175]
    ds_read_b128 v[136:139], v13 offset:832
    v_mfma_f32_16x16x32_bf16 v[156:159], v[28:31], v[48:51], v[156:159]
    ds_read2_b32 v[108:109], v12 offset0:208 offset1:209
    v_mfma_f32_16x16x32_bf16 v[160:163], v[28:31], v[52:55], v[160:163]
    ds_read2_b32 v[110:111], v12 offset0:210 offset1:211
    v_mfma_f32_16x16x32_bf16 v[164:167], v[28:31], v[56:59], v[164:167]
    ds_read_b128 v[140:143], v13 offset:320
    v_mfma_f32_16x16x32_bf16 v[168:171], v[28:31], v[60:63], v[168:171]
    v_mfma_f32_16x16x32_bf16 v[172:175], v[28:31], v[64:67], v[172:175]
    v_mfma_f32_16x16x32_bf16 v[160:163], v[32:35], v[48:51], v[160:163]
    v_mfma_f32_16x16x32_bf16 v[164:167], v[32:35], v[52:55], v[164:167]
    v_mfma_f32_16x16x32_bf16 v[168:171], v[32:35], v[56:59], v[168:171]
    v_mfma_f32_16x16x32_bf16 v[172:175], v[32:35], v[60:63], v[172:175]
    v_mfma_f32_16x16x32_bf16 v[164:167], v[36:39], v[48:51], v[164:167]
    v_mfma_f32_16x16x32_bf16 v[168:171], v[36:39], v[52:55], v[168:171]
    v_mfma_f32_16x16x32_bf16 v[172:175], v[36:39], v[56:59], v[172:175]
    v_mfma_f32_16x16x32_bf16 v[168:171], v[40:43], v[48:51], v[168:171]
    v_mfma_f32_16x16x32_bf16 v[172:175], v[40:43], v[52:55], v[172:175]
    v_mfma_f32_16x16x32_bf16 v[172:175], v[44:47], v[48:51], v[172:175]
    s_waitcnt lgkmcnt(0)
    v_mfma_f32_16x16x32_bf16 v[144:147], v[80:83], v[112:115], v[144:147]
    ds_read2_b32 v[16:17], v9 offset0:96 offset1:97
    v_mfma_f32_16x16x32_bf16 v[148:151], v[80:83], v[116:119], v[148:151]
    ds_read2_b32 v[18:19], v9 offset0:98 offset1:99
    v_mfma_f32_16x16x32_bf16 v[152:155], v[80:83], v[120:123], v[152:155]
    ds_read_b128 v[48:51], v13 offset:3968
    v_mfma_f32_16x16x32_bf16 v[156:159], v[80:83], v[124:127], v[156:159]
    ds_read2_b32 v[20:21], v9 offset0:224 offset1:225
    v_mfma_f32_16x16x32_bf16 v[160:163], v[80:83], v[128:131], v[160:163]
    ds_read2_b32 v[22:23], v9 offset0:226 offset1:227
    v_mfma_f32_16x16x32_bf16 v[164:167], v[80:83], v[132:135], v[164:167]
    ds_read_b128 v[52:55], v13 offset:3456
    v_mfma_f32_16x16x32_bf16 v[168:171], v[80:83], v[136:139], v[168:171]
    ds_read2_b32 v[24:25], v10 offset0:96 offset1:97
    v_mfma_f32_16x16x32_bf16 v[172:175], v[80:83], v[140:143], v[172:175]
    ds_read2_b32 v[26:27], v10 offset0:98 offset1:99
    v_mfma_f32_16x16x32_bf16 v[148:151], v[84:87], v[112:115], v[148:151]
    ds_read_b128 v[56:59], v13 offset:2944
    v_mfma_f32_16x16x32_bf16 v[152:155], v[84:87], v[116:119], v[152:155]
    ds_read2_b32 v[28:29], v10 offset0:224 offset1:225
    v_mfma_f32_16x16x32_bf16 v[156:159], v[84:87], v[120:123], v[156:159]
    ds_read2_b32 v[30:31], v10 offset0:226 offset1:227
    v_mfma_f32_16x16x32_bf16 v[160:163], v[84:87], v[124:127], v[160:163]
    ds_read_b128 v[60:63], v13 offset:2432
    v_mfma_f32_16x16x32_bf16 v[164:167], v[84:87], v[128:131], v[164:167]
    ds_read2_b32 v[32:33], v11 offset0:96 offset1:97
    v_mfma_f32_16x16x32_bf16 v[168:171], v[84:87], v[132:135], v[168:171]
    ds_read2_b32 v[34:35], v11 offset0:98 offset1:99
    v_mfma_f32_16x16x32_bf16 v[172:175], v[84:87], v[136:139], v[172:175]
    ds_read_b128 v[64:67], v13 offset:1920
    v_mfma_f32_16x16x32_bf16 v[152:155], v[88:91], v[112:115], v[152:155]
    ds_read2_b32 v[36:37], v11 offset0:224 offset1:225
    v_mfma_f32_16x16x32_bf16 v[156:159], v[88:91], v[116:119], v[156:159]
    ds_read2_b32 v[38:39], v11 offset0:226 offset1:227
    v_mfma_f32_16x16x32_bf16 v[160:163], v[88:91], v[120:123], v[160:163]
    ds_read_b128 v[68:71], v13 offset:1408
    v_mfma_f32_16x16x32_bf16 v[164:167], v[88:91], v[124:127], v[164:167]
    ds_read2_b32 v[40:41], v12 offset0:96 offset1:97
    v_mfma_f32_16x16x32_bf16 v[168:171], v[88:91], v[128:131], v[168:171]
    ds_read2_b32 v[42:43], v12 offset0:98 offset1:99
    v_mfma_f32_16x16x32_bf16 v[172:175], v[88:91], v[132:135], v[172:175]
    ds_read_b128 v[72:75], v13 offset:896
    v_mfma_f32_16x16x32_bf16 v[156:159], v[92:95], v[112:115], v[156:159]
    ds_read2_b32 v[44:45], v12 offset0:224 offset1:225
    v_mfma_f32_16x16x32_bf16 v[160:163], v[92:95], v[116:119], v[160:163]
    ds_read2_b32 v[46:47], v12 offset0:226 offset1:227
    v_mfma_f32_16x16x32_bf16 v[164:167], v[92:95], v[120:123], v[164:167]
    ds_read_b128 v[76:79], v13 offset:384
    v_mfma_f32_16x16x32_bf16 v[168:171], v[92:95], v[124:127], v[168:171]
    v_mfma_f32_16x16x32_bf16 v[172:175], v[92:95], v[128:131], v[172:175]
    v_mfma_f32_16x16x32_bf16 v[160:163], v[96:99], v[112:115], v[160:163]
    v_mfma_f32_16x16x32_bf16 v[164:167], v[96:99], v[116:119], v[164:167]
    v_mfma_f32_16x16x32_bf16 v[168:171], v[96:99], v[120:123], v[168:171]
    v_mfma_f32_16x16x32_bf16 v[172:175], v[96:99], v[124:127], v[172:175]
    v_mfma_f32_16x16x32_bf16 v[164:167], v[100:103], v[112:115], v[164:167]
    v_mfma_f32_16x16x32_bf16 v[168:171], v[100:103], v[116:119], v[168:171]
    v_mfma_f32_16x16x32_bf16 v[172:175], v[100:103], v[120:123], v[172:175]
    v_mfma_f32_16x16x32_bf16 v[168:171], v[104:107], v[112:115], v[168:171]
    v_mfma_f32_16x16x32_bf16 v[172:175], v[104:107], v[116:119], v[172:175]
    v_mfma_f32_16x16x32_bf16 v[172:175], v[108:111], v[112:115], v[172:175]
    s_waitcnt lgkmcnt(0)
    v_mfma_f32_16x16x32_bf16 v[144:147], v[16:19], v[48:51], v[144:147]
    ds_read2_b32 v[80:81], v9 offset0:112 offset1:113
    v_mfma_f32_16x16x32_bf16 v[148:151], v[16:19], v[52:55], v[148:151]
    ds_read2_b32 v[82:83], v9 offset0:114 offset1:115
    v_mfma_f32_16x16x32_bf16 v[152:155], v[16:19], v[56:59], v[152:155]
    ds_read_b128 v[112:115], v13 offset:4032
    v_mfma_f32_16x16x32_bf16 v[156:159], v[16:19], v[60:63], v[156:159]
    ds_read2_b32 v[84:85], v9 offset0:240 offset1:241
    v_mfma_f32_16x16x32_bf16 v[160:163], v[16:19], v[64:67], v[160:163]
    ds_read2_b32 v[86:87], v9 offset0:242 offset1:243
    v_mfma_f32_16x16x32_bf16 v[164:167], v[16:19], v[68:71], v[164:167]
    ds_read_b128 v[116:119], v13 offset:3520
    v_mfma_f32_16x16x32_bf16 v[168:171], v[16:19], v[72:75], v[168:171]
    ds_read2_b32 v[88:89], v10 offset0:112 offset1:113
    v_mfma_f32_16x16x32_bf16 v[172:175], v[16:19], v[76:79], v[172:175]
    ds_read2_b32 v[90:91], v10 offset0:114 offset1:115
    v_mfma_f32_16x16x32_bf16 v[148:151], v[20:23], v[48:51], v[148:151]
    ds_read_b128 v[120:123], v13 offset:3008
    v_mfma_f32_16x16x32_bf16 v[152:155], v[20:23], v[52:55], v[152:155]
    ds_read2_b32 v[92:93], v10 offset0:240 offset1:241
    v_mfma_f32_16x16x32_bf16 v[156:159], v[20:23], v[56:59], v[156:159]
    ds_read2_b32 v[94:95], v10 offset0:242 offset1:243
    v_mfma_f32_16x16x32_bf16 v[160:163], v[20:23], v[60:63], v[160:163]
    ds_read_b128 v[124:127], v13 offset:2496
    v_mfma_f32_16x16x32_bf16 v[164:167], v[20:23], v[64:67], v[164:167]
    ds_read2_b32 v[96:97], v11 offset0:112 offset1:113
    v_mfma_f32_16x16x32_bf16 v[168:171], v[20:23], v[68:71], v[168:171]
    ds_read2_b32 v[98:99], v11 offset0:114 offset1:115
    v_mfma_f32_16x16x32_bf16 v[172:175], v[20:23], v[72:75], v[172:175]
    ds_read_b128 v[128:131], v13 offset:1984
    v_mfma_f32_16x16x32_bf16 v[152:155], v[24:27], v[48:51], v[152:155]
    ds_read2_b32 v[100:101], v11 offset0:240 offset1:241
    v_mfma_f32_16x16x32_bf16 v[156:159], v[24:27], v[52:55], v[156:159]
    ds_read2_b32 v[102:103], v11 offset0:242 offset1:243
    v_mfma_f32_16x16x32_bf16 v[160:163], v[24:27], v[56:59], v[160:163]
    ds_read_b128 v[132:135], v13 offset:1472
    v_mfma_f32_16x16x32_bf16 v[164:167], v[24:27], v[60:63], v[164:167]
    ds_read2_b32 v[104:105], v12 offset0:112 offset1:113
    v_mfma_f32_16x16x32_bf16 v[168:171], v[24:27], v[64:67], v[168:171]
    ds_read2_b32 v[106:107], v12 offset0:114 offset1:115
    v_mfma_f32_16x16x32_bf16 v[172:175], v[24:27], v[68:71], v[172:175]
    ds_read_b128 v[136:139], v13 offset:960
    v_mfma_f32_16x16x32_bf16 v[156:159], v[28:31], v[48:51], v[156:159]
    ds_read2_b32 v[108:109], v12 offset0:240 offset1:241
    v_mfma_f32_16x16x32_bf16 v[160:163], v[28:31], v[52:55], v[160:163]
    ds_read2_b32 v[110:111], v12 offset0:242 offset1:243
    v_mfma_f32_16x16x32_bf16 v[164:167], v[28:31], v[56:59], v[164:167]
    ds_read_b128 v[140:143], v13 offset:448
    v_mfma_f32_16x16x32_bf16 v[168:171], v[28:31], v[60:63], v[168:171]
    v_mfma_f32_16x16x32_bf16 v[172:175], v[28:31], v[64:67], v[172:175]
    v_mfma_f32_16x16x32_bf16 v[160:163], v[32:35], v[48:51], v[160:163]
    v_mfma_f32_16x16x32_bf16 v[164:167], v[32:35], v[52:55], v[164:167]
    v_mfma_f32_16x16x32_bf16 v[168:171], v[32:35], v[56:59], v[168:171]
    v_mfma_f32_16x16x32_bf16 v[172:175], v[32:35], v[60:63], v[172:175]
    v_mfma_f32_16x16x32_bf16 v[164:167], v[36:39], v[48:51], v[164:167]
    v_mfma_f32_16x16x32_bf16 v[168:171], v[36:39], v[52:55], v[168:171]
    v_mfma_f32_16x16x32_bf16 v[172:175], v[36:39], v[56:59], v[172:175]
    v_mfma_f32_16x16x32_bf16 v[168:171], v[40:43], v[48:51], v[168:171]
    v_mfma_f32_16x16x32_bf16 v[172:175], v[40:43], v[52:55], v[172:175]
    v_mfma_f32_16x16x32_bf16 v[172:175], v[44:47], v[48:51], v[172:175]
    s_waitcnt lgkmcnt(0)
    v_mfma_f32_16x16x32_bf16 v[144:147], v[80:83], v[112:115], v[144:147]
    v_mfma_f32_16x16x32_bf16 v[148:151], v[80:83], v[116:119], v[148:151]
    v_mfma_f32_16x16x32_bf16 v[152:155], v[80:83], v[120:123], v[152:155]
    v_mfma_f32_16x16x32_bf16 v[156:159], v[80:83], v[124:127], v[156:159]
    v_mfma_f32_16x16x32_bf16 v[160:163], v[80:83], v[128:131], v[160:163]
    v_mfma_f32_16x16x32_bf16 v[164:167], v[80:83], v[132:135], v[164:167]
    v_mfma_f32_16x16x32_bf16 v[168:171], v[80:83], v[136:139], v[168:171]
    v_mfma_f32_16x16x32_bf16 v[172:175], v[80:83], v[140:143], v[172:175]
    v_mfma_f32_16x16x32_bf16 v[148:151], v[84:87], v[112:115], v[148:151]
    v_mfma_f32_16x16x32_bf16 v[152:155], v[84:87], v[116:119], v[152:155]
    v_mfma_f32_16x16x32_bf16 v[156:159], v[84:87], v[120:123], v[156:159]
    v_mfma_f32_16x16x32_bf16 v[160:163], v[84:87], v[124:127], v[160:163]
    v_mfma_f32_16x16x32_bf16 v[164:167], v[84:87], v[128:131], v[164:167]
    v_mfma_f32_16x16x32_bf16 v[168:171], v[84:87], v[132:135], v[168:171]
    v_mfma_f32_16x16x32_bf16 v[172:175], v[84:87], v[136:139], v[172:175]
    v_mfma_f32_16x16x32_bf16 v[152:155], v[88:91], v[112:115], v[152:155]
    v_mfma_f32_16x16x32_bf16 v[156:159], v[88:91], v[116:119], v[156:159]
    v_mfma_f32_16x16x32_bf16 v[160:163], v[88:91], v[120:123], v[160:163]
    v_mfma_f32_16x16x32_bf16 v[164:167], v[88:91], v[124:127], v[164:167]
    v_mfma_f32_16x16x32_bf16 v[168:171], v[88:91], v[128:131], v[168:171]
    v_mfma_f32_16x16x32_bf16 v[172:175], v[88:91], v[132:135], v[172:175]
    v_mfma_f32_16x16x32_bf16 v[156:159], v[92:95], v[112:115], v[156:159]
    v_mfma_f32_16x16x32_bf16 v[160:163], v[92:95], v[116:119], v[160:163]
    v_mfma_f32_16x16x32_bf16 v[164:167], v[92:95], v[120:123], v[164:167]
    v_mfma_f32_16x16x32_bf16 v[168:171], v[92:95], v[124:127], v[168:171]
    v_mfma_f32_16x16x32_bf16 v[172:175], v[92:95], v[128:131], v[172:175]
    v_mfma_f32_16x16x32_bf16 v[160:163], v[96:99], v[112:115], v[160:163]
    v_mfma_f32_16x16x32_bf16 v[164:167], v[96:99], v[116:119], v[164:167]
    v_mfma_f32_16x16x32_bf16 v[168:171], v[96:99], v[120:123], v[168:171]
    v_mfma_f32_16x16x32_bf16 v[172:175], v[96:99], v[124:127], v[172:175]
    v_mfma_f32_16x16x32_bf16 v[164:167], v[100:103], v[112:115], v[164:167]
    v_mfma_f32_16x16x32_bf16 v[168:171], v[100:103], v[116:119], v[168:171]
    v_mfma_f32_16x16x32_bf16 v[172:175], v[100:103], v[120:123], v[172:175]
    v_mfma_f32_16x16x32_bf16 v[168:171], v[104:107], v[112:115], v[168:171]
    v_mfma_f32_16x16x32_bf16 v[172:175], v[104:107], v[116:119], v[172:175]
    v_mfma_f32_16x16x32_bf16 v[172:175], v[108:111], v[112:115], v[172:175]
    ds_read_b64 v[16:17], v14 offset:3584
    ds_read_b64 v[18:19], v14 offset:3072
    ds_read_b64 v[20:21], v14 offset:2560
    ds_read_b64 v[22:23], v14 offset:2048
    ds_read_b64 v[24:25], v14 offset:1536
    ds_read_b64 v[26:27], v14 offset:1024
    ds_read_b64 v[28:29], v14 offset:512
    ds_read_b64 v[30:31], v14 offset:0
    s_lshl_b32 s32, s64, 16
    s_and_b32 s33, s64, 0xffff0000
    s_cmp_eq_u32 s28, 0
    s_cselect_b32 s32, s32, s33
    s_waitcnt lgkmcnt(0)
    v_and_b32 v2, 0xffff0000, v17
    v_fmac_f32 v144, s32, v2
    v_lshlrev_b32 v2, 16, v17
    v_fmac_f32 v145, s32, v2
    v_and_b32 v2, 0xffff0000, v16
    v_fmac_f32 v146, s32, v2
    v_lshlrev_b32 v2, 16, v16
    v_fmac_f32 v147, s32, v2
    v_cvt_pk_bf16_f32 v32, v147, v146
    v_cvt_pk_bf16_f32 v33, v145, v144
    ds_write_b64 v14, v[32:33] offset:3584
    v_and_b32 v2, 0xffff0000, v19
    v_fmac_f32 v148, s32, v2
    v_lshlrev_b32 v2, 16, v19
    v_fmac_f32 v149, s32, v2
    v_and_b32 v2, 0xffff0000, v18
    v_fmac_f32 v150, s32, v2
    v_lshlrev_b32 v2, 16, v18
    v_fmac_f32 v151, s32, v2
    v_cvt_pk_bf16_f32 v34, v151, v150
    v_cvt_pk_bf16_f32 v35, v149, v148
    ds_write_b64 v14, v[34:35] offset:3072
    v_and_b32 v2, 0xffff0000, v21
    v_fmac_f32 v152, s32, v2
    v_lshlrev_b32 v2, 16, v21
    v_fmac_f32 v153, s32, v2
    v_and_b32 v2, 0xffff0000, v20
    v_fmac_f32 v154, s32, v2
    v_lshlrev_b32 v2, 16, v20
    v_fmac_f32 v155, s32, v2
    v_cvt_pk_bf16_f32 v36, v155, v154
    v_cvt_pk_bf16_f32 v37, v153, v152
    ds_write_b64 v14, v[36:37] offset:2560
    v_and_b32 v2, 0xffff0000, v23
    v_fmac_f32 v156, s32, v2
    v_lshlrev_b32 v2, 16, v23
    v_fmac_f32 v157, s32, v2
    v_and_b32 v2, 0xffff0000, v22
    v_fmac_f32 v158, s32, v2
    v_lshlrev_b32 v2, 16, v22
    v_fmac_f32 v159, s32, v2
    v_cvt_pk_bf16_f32 v38, v159, v158
    v_cvt_pk_bf16_f32 v39, v157, v156
    ds_write_b64 v14, v[38:39] offset:2048
    v_and_b32 v2, 0xffff0000, v25
    v_fmac_f32 v160, s32, v2
    v_lshlrev_b32 v2, 16, v25
    v_fmac_f32 v161, s32, v2
    v_and_b32 v2, 0xffff0000, v24
    v_fmac_f32 v162, s32, v2
    v_lshlrev_b32 v2, 16, v24
    v_fmac_f32 v163, s32, v2
    v_cvt_pk_bf16_f32 v40, v163, v162
    v_cvt_pk_bf16_f32 v41, v161, v160
    ds_write_b64 v14, v[40:41] offset:1536
    v_and_b32 v2, 0xffff0000, v27
    v_fmac_f32 v164, s32, v2
    v_lshlrev_b32 v2, 16, v27
    v_fmac_f32 v165, s32, v2
    v_and_b32 v2, 0xffff0000, v26
    v_fmac_f32 v166, s32, v2
    v_lshlrev_b32 v2, 16, v26
    v_fmac_f32 v167, s32, v2
    v_cvt_pk_bf16_f32 v42, v167, v166
    v_cvt_pk_bf16_f32 v43, v165, v164
    ds_write_b64 v14, v[42:43] offset:1024
    v_and_b32 v2, 0xffff0000, v29
    v_fmac_f32 v168, s32, v2
    v_lshlrev_b32 v2, 16, v29
    v_fmac_f32 v169, s32, v2
    v_and_b32 v2, 0xffff0000, v28
    v_fmac_f32 v170, s32, v2
    v_lshlrev_b32 v2, 16, v28
    v_fmac_f32 v171, s32, v2
    v_cvt_pk_bf16_f32 v44, v171, v170
    v_cvt_pk_bf16_f32 v45, v169, v168
    ds_write_b64 v14, v[44:45] offset:512
    v_and_b32 v2, 0xffff0000, v31
    v_fmac_f32 v172, s32, v2
    v_lshlrev_b32 v2, 16, v31
    v_fmac_f32 v173, s32, v2
    v_and_b32 v2, 0xffff0000, v30
    v_fmac_f32 v174, s32, v2
    v_lshlrev_b32 v2, 16, v30
    v_fmac_f32 v175, s32, v2
    v_cvt_pk_bf16_f32 v46, v175, v174
    v_cvt_pk_bf16_f32 v47, v173, v172
    ds_write_b64 v14, v[46:47] offset:0
    v_add_u32 v13, 4624, v13
    v_add_u32 v14, 4624, v14
    s_add_u32 s28, s28, 1
    s_cmp_lt_u32 s28, 2
    s_cbranch_scc1 L_b_ch
    s_mov_b32 s32, 0
    buffer_load_dwordx4 v[64:67], v4, s[12:15], s32 offen
    s_mov_b32 s32, 2048
    buffer_load_dwordx4 v[68:71], v4, s[12:15], s32 offen
    s_mov_b32 s32, 4096
    buffer_load_dwordx4 v[72:75], v4, s[12:15], s32 offen
    s_mov_b32 s32, 6144
    buffer_load_dwordx4 v[76:79], v4, s[12:15], s32 offen
    s_mov_b32 s32, 8192
    buffer_load_dwordx4 v[80:83], v4, s[12:15], s32 offen
    s_mov_b32 s32, 10240
    buffer_load_dwordx4 v[84:87], v4, s[12:15], s32 offen
    s_mov_b32 s32, 12288
    buffer_load_dwordx4 v[88:91], v4, s[12:15], s32 offen
    s_mov_b32 s32, 14336
    buffer_load_dwordx4 v[92:95], v4, s[12:15], s32 offen
    s_load_dwordx2 s[40:41], s[0:1], 104
    s_mul_i32 s32, s24, 1048576
    s_mul_i32 s47, s62, 32
    s_add_u32 s32, s32, s47
    s_add_u32 s32, s32, 2048
    v_lshrrev_b32 v2, 1, v1
    v_lshlrev_b32 v3, 15, v2
    v_and_b32 v2, 1, v1
    v_lshl_add_u32 v3, v2, 4, v3
    v_add_u32 v3, s32, v3
    s_waitcnt lgkmcnt(0)
    s_barrier
    s_mov_b32 s8, s40
    s_and_b32 s9, s41, 0xffff
    s_mov_b32 s10, 8388608
    s_mov_b32 s11, 0x20000
    ds_read_b128 v[16:19], v5 offset:0
    ds_read_b128 v[20:23], v5 offset:4624
    ds_read_b128 v[24:27], v5 offset:9248
    ds_read_b128 v[28:31], v5 offset:13872
    ds_read_b128 v[32:35], v5 offset:18496
    ds_read_b128 v[36:39], v5 offset:23120
    ds_read_b128 v[40:43], v5 offset:27744
    ds_read_b128 v[44:47], v5 offset:32368
    s_waitcnt vmcnt(0) lgkmcnt(0)
    v_and_b32 v128, 0xffff0000, v19
    v_lshlrev_b32 v129, 16, v64
    v_mul_f32 v128, v128, v129
    v_and_b32 v130, 0xffff0000, v23
    v_and_b32 v131, 0xffff0000, v64
    v_mul_f32 v130, v130, v131
    v_cvt_pk_bf16_f32 v96, v128, v130
    v_and_b32 v128, 0xffff0000, v27
    v_lshlrev_b32 v129, 16, v65
    v_mul_f32 v128, v128, v129
    v_and_b32 v130, 0xffff0000, v31
    v_and_b32 v131, 0xffff0000, v65
    v_mul_f32 v130, v130, v131
    v_cvt_pk_bf16_f32 v97, v128, v130
    v_and_b32 v128, 0xffff0000, v35
    v_lshlrev_b32 v129, 16, v66
    v_mul_f32 v128, v128, v129
    v_and_b32 v130, 0xffff0000, v39
    v_and_b32 v131, 0xffff0000, v66
    v_mul_f32 v130, v130, v131
    v_cvt_pk_bf16_f32 v98, v128, v130
    v_and_b32 v128, 0xffff0000, v43
    v_lshlrev_b32 v129, 16, v67
    v_mul_f32 v128, v128, v129
    v_and_b32 v130, 0xffff0000, v47
    v_and_b32 v131, 0xffff0000, v67
    v_mul_f32 v130, v130, v131
    v_cvt_pk_bf16_f32 v99, v128, v130
    s_mov_b32 s32, 0
    buffer_store_dwordx4 v[96:99], v3, s[8:11], s32 offen
    v_lshlrev_b32 v128, 16, v19
    v_lshlrev_b32 v129, 16, v68
    v_mul_f32 v128, v128, v129
    v_lshlrev_b32 v130, 16, v23
    v_and_b32 v131, 0xffff0000, v68
    v_mul_f32 v130, v130, v131
    v_cvt_pk_bf16_f32 v100, v128, v130
    v_lshlrev_b32 v128, 16, v27
    v_lshlrev_b32 v129, 16, v69
    v_mul_f32 v128, v128, v129
    v_lshlrev_b32 v130, 16, v31
    v_and_b32 v131, 0xffff0000, v69
    v_mul_f32 v130, v130, v131
    v_cvt_pk_bf16_f32 v101, v128, v130
    v_lshlrev_b32 v128, 16, v35
    v_lshlrev_b32 v129, 16, v70
    v_mul_f32 v128, v128, v129
    v_lshlrev_b32 v130, 16, v39
    v_and_b32 v131, 0xffff0000, v70
    v_mul_f32 v130, v130, v131
    v_cvt_pk_bf16_f32 v102, v128, v130
    v_lshlrev_b32 v128, 16, v43
    v_lshlrev_b32 v129, 16, v71
    v_mul_f32 v128, v128, v129
    v_lshlrev_b32 v130, 16, v47
    v_and_b32 v131, 0xffff0000, v71
    v_mul_f32 v130, v130, v131
    v_cvt_pk_bf16_f32 v103, v128, v130
    s_mov_b32 s32, 4096
    buffer_store_dwordx4 v[100:103], v3, s[8:11], s32 offen
    v_and_b32 v128, 0xffff0000, v18
    v_lshlrev_b32 v129, 16, v72
    v_mul_f32 v128, v128, v129
    v_and_b32 v130, 0xffff0000, v22
    v_and_b32 v131, 0xffff0000, v72
    v_mul_f32 v130, v130, v131
    v_cvt_pk_bf16_f32 v104, v128, v130
    v_and_b32 v128, 0xffff0000, v26
    v_lshlrev_b32 v129, 16, v73
    v_mul_f32 v128, v128, v129
    v_and_b32 v130, 0xffff0000, v30
    v_and_b32 v131, 0xffff0000, v73
    v_mul_f32 v130, v130, v131
    v_cvt_pk_bf16_f32 v105, v128, v130
    v_and_b32 v128, 0xffff0000, v34
    v_lshlrev_b32 v129, 16, v74
    v_mul_f32 v128, v128, v129
    v_and_b32 v130, 0xffff0000, v38
    v_and_b32 v131, 0xffff0000, v74
    v_mul_f32 v130, v130, v131
    v_cvt_pk_bf16_f32 v106, v128, v130
    v_and_b32 v128, 0xffff0000, v42
    v_lshlrev_b32 v129, 16, v75
    v_mul_f32 v128, v128, v129
    v_and_b32 v130, 0xffff0000, v46
    v_and_b32 v131, 0xffff0000, v75
    v_mul_f32 v130, v130, v131
    v_cvt_pk_bf16_f32 v107, v128, v130
    s_mov_b32 s32, 8192
    buffer_store_dwordx4 v[104:107], v3, s[8:11], s32 offen
    v_lshlrev_b32 v128, 16, v18
    v_lshlrev_b32 v129, 16, v76
    v_mul_f32 v128, v128, v129
    v_lshlrev_b32 v130, 16, v22
    v_and_b32 v131, 0xffff0000, v76
    v_mul_f32 v130, v130, v131
    v_cvt_pk_bf16_f32 v108, v128, v130
    v_lshlrev_b32 v128, 16, v26
    v_lshlrev_b32 v129, 16, v77
    v_mul_f32 v128, v128, v129
    v_lshlrev_b32 v130, 16, v30
    v_and_b32 v131, 0xffff0000, v77
    v_mul_f32 v130, v130, v131
    v_cvt_pk_bf16_f32 v109, v128, v130
    v_lshlrev_b32 v128, 16, v34
    v_lshlrev_b32 v129, 16, v78
    v_mul_f32 v128, v128, v129
    v_lshlrev_b32 v130, 16, v38
    v_and_b32 v131, 0xffff0000, v78
    v_mul_f32 v130, v130, v131
    v_cvt_pk_bf16_f32 v110, v128, v130
    v_lshlrev_b32 v128, 16, v42
    v_lshlrev_b32 v129, 16, v79
    v_mul_f32 v128, v128, v129
    v_lshlrev_b32 v130, 16, v46
    v_and_b32 v131, 0xffff0000, v79
    v_mul_f32 v130, v130, v131
    v_cvt_pk_bf16_f32 v111, v128, v130
    s_mov_b32 s32, 12288
    buffer_store_dwordx4 v[108:111], v3, s[8:11], s32 offen
    v_and_b32 v128, 0xffff0000, v17
    v_lshlrev_b32 v129, 16, v80
    v_mul_f32 v128, v128, v129
    v_and_b32 v130, 0xffff0000, v21
    v_and_b32 v131, 0xffff0000, v80
    v_mul_f32 v130, v130, v131
    v_cvt_pk_bf16_f32 v112, v128, v130
    v_and_b32 v128, 0xffff0000, v25
    v_lshlrev_b32 v129, 16, v81
    v_mul_f32 v128, v128, v129
    v_and_b32 v130, 0xffff0000, v29
    v_and_b32 v131, 0xffff0000, v81
    v_mul_f32 v130, v130, v131
    v_cvt_pk_bf16_f32 v113, v128, v130
    v_and_b32 v128, 0xffff0000, v33
    v_lshlrev_b32 v129, 16, v82
    v_mul_f32 v128, v128, v129
    v_and_b32 v130, 0xffff0000, v37
    v_and_b32 v131, 0xffff0000, v82
    v_mul_f32 v130, v130, v131
    v_cvt_pk_bf16_f32 v114, v128, v130
    v_and_b32 v128, 0xffff0000, v41
    v_lshlrev_b32 v129, 16, v83
    v_mul_f32 v128, v128, v129
    v_and_b32 v130, 0xffff0000, v45
    v_and_b32 v131, 0xffff0000, v83
    v_mul_f32 v130, v130, v131
    v_cvt_pk_bf16_f32 v115, v128, v130
    s_mov_b32 s32, 16384
    buffer_store_dwordx4 v[112:115], v3, s[8:11], s32 offen
    v_lshlrev_b32 v128, 16, v17
    v_lshlrev_b32 v129, 16, v84
    v_mul_f32 v128, v128, v129
    v_lshlrev_b32 v130, 16, v21
    v_and_b32 v131, 0xffff0000, v84
    v_mul_f32 v130, v130, v131
    v_cvt_pk_bf16_f32 v116, v128, v130
    v_lshlrev_b32 v128, 16, v25
    v_lshlrev_b32 v129, 16, v85
    v_mul_f32 v128, v128, v129
    v_lshlrev_b32 v130, 16, v29
    v_and_b32 v131, 0xffff0000, v85
    v_mul_f32 v130, v130, v131
    v_cvt_pk_bf16_f32 v117, v128, v130
    v_lshlrev_b32 v128, 16, v33
    v_lshlrev_b32 v129, 16, v86
    v_mul_f32 v128, v128, v129
    v_lshlrev_b32 v130, 16, v37
    v_and_b32 v131, 0xffff0000, v86
    v_mul_f32 v130, v130, v131
    v_cvt_pk_bf16_f32 v118, v128, v130
    v_lshlrev_b32 v128, 16, v41
    v_lshlrev_b32 v129, 16, v87
    v_mul_f32 v128, v128, v129
    v_lshlrev_b32 v130, 16, v45
    v_and_b32 v131, 0xffff0000, v87
    v_mul_f32 v130, v130, v131
    v_cvt_pk_bf16_f32 v119, v128, v130
    s_mov_b32 s32, 20480
    buffer_store_dwordx4 v[116:119], v3, s[8:11], s32 offen
    v_and_b32 v128, 0xffff0000, v16
    v_lshlrev_b32 v129, 16, v88
    v_mul_f32 v128, v128, v129
    v_and_b32 v130, 0xffff0000, v20
    v_and_b32 v131, 0xffff0000, v88
    v_mul_f32 v130, v130, v131
    v_cvt_pk_bf16_f32 v120, v128, v130
    v_and_b32 v128, 0xffff0000, v24
    v_lshlrev_b32 v129, 16, v89
    v_mul_f32 v128, v128, v129
    v_and_b32 v130, 0xffff0000, v28
    v_and_b32 v131, 0xffff0000, v89
    v_mul_f32 v130, v130, v131
    v_cvt_pk_bf16_f32 v121, v128, v130
    v_and_b32 v128, 0xffff0000, v32
    v_lshlrev_b32 v129, 16, v90
    v_mul_f32 v128, v128, v129
    v_and_b32 v130, 0xffff0000, v36
    v_and_b32 v131, 0xffff0000, v90
    v_mul_f32 v130, v130, v131
    v_cvt_pk_bf16_f32 v122, v128, v130
    v_and_b32 v128, 0xffff0000, v40
    v_lshlrev_b32 v129, 16, v91
    v_mul_f32 v128, v128, v129
    v_and_b32 v130, 0xffff0000, v44
    v_and_b32 v131, 0xffff0000, v91
    v_mul_f32 v130, v130, v131
    v_cvt_pk_bf16_f32 v123, v128, v130
    s_mov_b32 s32, 24576
    buffer_store_dwordx4 v[120:123], v3, s[8:11], s32 offen
    v_lshlrev_b32 v128, 16, v16
    v_lshlrev_b32 v129, 16, v92
    v_mul_f32 v128, v128, v129
    v_lshlrev_b32 v130, 16, v20
    v_and_b32 v131, 0xffff0000, v92
    v_mul_f32 v130, v130, v131
    v_cvt_pk_bf16_f32 v124, v128, v130
    v_lshlrev_b32 v128, 16, v24
    v_lshlrev_b32 v129, 16, v93
    v_mul_f32 v128, v128, v129
    v_lshlrev_b32 v130, 16, v28
    v_and_b32 v131, 0xffff0000, v93
    v_mul_f32 v130, v130, v131
    v_cvt_pk_bf16_f32 v125, v128, v130
    v_lshlrev_b32 v128, 16, v32
    v_lshlrev_b32 v129, 16, v94
    v_mul_f32 v128, v128, v129
    v_lshlrev_b32 v130, 16, v36
    v_and_b32 v131, 0xffff0000, v94
    v_mul_f32 v130, v130, v131
    v_cvt_pk_bf16_f32 v126, v128, v130
    v_lshlrev_b32 v128, 16, v40
    v_lshlrev_b32 v129, 16, v95
    v_mul_f32 v128, v128, v129
    v_lshlrev_b32 v130, 16, v44
    v_and_b32 v131, 0xffff0000, v95
    v_mul_f32 v130, v130, v131
    v_cvt_pk_bf16_f32 v127, v128, v130
    s_mov_b32 s32, 28672
    buffer_store_dwordx4 v[124:127], v3, s[8:11], s32 offen
    s_branch L_done
L_q:
    v_and_b32 v40, 63, v0
    v_mov_b32 v10, 0
    s_and_b32 s60, s24, 3
    s_lshr_b32 s61, s24, 2
    s_bfe_u32 s47, s25, 0x20000
    s_mul_i32 s62, s47, 8
    s_bfe_u32 s47, s26, 0x30000
    s_mul_i32 s47, s47, 1
    s_add_u32 s62, s62, s47
    s_mul_i32 s51, s62, 128
    s_add_u32 s51, s51, 98598912
    s_mul_i32 s3, s25, 128
    s_add_u32 s3, s3, 98568192
    s_cmp_lg_u32 s24, 0
    s_cbranch_scc1 GC_10
    s_mov_b64 exec, 1
    buffer_store_dword v10, v10, s[4:7], s3 offen sc1
    buffer_store_dword v10, v10, s[4:7], s51 offen offset:0 sc1
    s_mov_b64 exec, -1
GC_10:
    s_barrier
    s_cmp_lt_u32 s24, 4
    s_cbranch_scc1 WP_12
    s_load_dwordx4 s[64:67], s[0:1], 16
    s_load_dwordx4 s[68:71], s[0:1], 32
    s_bfe_u32 s47, s26, 0x20002
    s_mul_i32 s32, s47, 2097152
    s_bfe_u32 s47, s26, 0x20000
    s_mul_i32 s47, s47, 131072
    s_add_u32 s32, s32, s47
    s_bfe_u32 s47, s24, 0x20000
    s_mul_i32 s47, s47, 32768
    s_add_u32 s32, s32, s47
    s_bfe_u32 s47, s25, 0x20000
    s_mul_i32 s47, s47, 2048
    s_add_u32 s32, s32, s47
    v_bfe_u32 v41, v40, 4, 2
    v_lshlrev_b32 v77, 13, v41
    v_and_b32 v41, 15, v40
    v_lshl_add_u32 v77, v41, 7, v77
    v_add_u32 v77, s32, v77
    s_bfe_u32 s47, s26, 0x40000
    s_mul_i32 s32, s47, 32768
    s_bfe_u32 s47, s24, 0x20000
    s_mul_i32 s47, s47, 8192
    s_add_u32 s32, s32, s47
    s_bfe_u32 s47, s25, 0x20000
    s_mul_i32 s47, s47, 2097152
    s_add_u32 s32, s32, s47
    v_lshlrev_b32 v78, 7, v40
    v_add_u32 v78, s32, v78
    s_waitcnt lgkmcnt(0)
    s_mov_b32 s8, s66
    s_and_b32 s9, s67, 0xffff
    s_mov_b32 s10, 8388608
    s_mov_b32 s11, 0x20000
    s_mov_b32 s12, s68
    s_and_b32 s13, s69, 0xffff
    s_mov_b32 s14, 8388608
    s_mov_b32 s15, 0x20000
    s_mov_b32 s32, 0
    buffer_load_dword v79, v77, s[8:11], s32 offen
    s_mov_b32 s32, 0
    buffer_load_dword v79, v77, s[12:15], s32 offen
    s_mov_b32 s32, 524288
    buffer_load_dword v79, v77, s[8:11], s32 offen
    s_mov_b32 s32, 524288
    buffer_load_dword v79, v77, s[12:15], s32 offen
    s_mov_b32 s32, 1048576
    buffer_load_dword v79, v77, s[8:11], s32 offen
    s_mov_b32 s32, 1048576
    buffer_load_dword v79, v77, s[12:15], s32 offen
    s_mov_b32 s32, 1572864
    buffer_load_dword v79, v77, s[8:11], s32 offen
    s_mov_b32 s32, 1572864
    buffer_load_dword v79, v77, s[12:15], s32 offen
    s_mov_b32 s8, s64
    s_and_b32 s9, s65, 0xffff
    s_mov_b32 s10, 8388608
    s_mov_b32 s11, 0x20000
    s_mov_b32 s12, s70
    s_and_b32 s13, s71, 0xffff
    s_mov_b32 s14, 8388608
    s_mov_b32 s15, 0x20000
    s_mov_b32 s32, 0
    buffer_load_dword v79, v77, s[8:11], s32 offen
    s_mov_b32 s32, 524288
    buffer_load_dword v79, v77, s[8:11], s32 offen
    s_mov_b32 s32, 1048576
    buffer_load_dword v79, v77, s[8:11], s32 offen
    s_mov_b32 s32, 1572864
    buffer_load_dword v79, v77, s[8:11], s32 offen
WP_12:
    s_cmp_lg_u32 s24, 0
    s_cbranch_scc1 GA_11
    s_waitcnt vmcnt(0)
    s_mov_b32 s72, 1
    s_atomic_add s72, s[20:21], 4
GA_11:
    s_barrier
    s_mov_b32 s48, 400000
WI_13:
    buffer_load_dword v11, v10, s[4:7], s3 offen sc1
    s_sub_u32 s48, s48, 1
    s_cbranch_scc1 L_abort
    s_waitcnt vmcnt(0)
    v_readfirstlane_b32 s29, v11
    s_nop 3
    s_cmp_lg_u32 s29, 0
    s_cbranch_scc1 WE_14
    s_sleep 8
    s_branch WI_13
WE_14:
    s_bfe_u32 s27, s29, 0x10008
    s_load_dwordx2 s[40:41], s[0:1], 16
    s_waitcnt lgkmcnt(0)
    s_mul_i32 s32, s61, 4194304
    s_mul_i32 s47, s62, 256
    s_add_u32 s32, s32, s47
    s_mul_i32 s47, s60, 262144
    s_add_u32 s32, s32, s47
    s_mov_b32 s8, s40
    s_and_b32 s9, s41, 0xffff
    s_mov_b32 s10, 8388608
    s_mov_b32 s11, 0x20000
    v_lshrrev_b32 v42, 4, v40
    v_lshlrev_b32 v42, 2, v42
    v_xor_b32 v45, v42, v40
    v_bfe_u32 v41, v40, 4, 2
    v_lshlrev_b32 v42, 13, v41
    v_and_b32 v41, 15, v45
    v_lshl_add_u32 v42, v41, 4, v42
    v_add_u32 v42, s32, v42
    v_bfe_u32 v41, v40, 2, 2
    v_xor_b32 v46, s60, v41
    s_mul_i32 s32, s61, 32768
    v_bfe_u32 v41, v40, 4, 2
    v_lshlrev_b32 v45, 11, v41
    v_bfe_u32 v41, v40, 2, 2
    v_lshl_add_u32 v45, v41, 8, v45
    v_lshl_add_u32 v45, v46, 6, v45
    v_and_b32 v41, 3, v40
    v_lshl_add_u32 v45, v41, 4, v45
    v_add_u32 v45, s32, v45
    s_lshl_b32 s56, s24, 13
    s_add_u32 m0, s56, 0
    s_mov_b32 s40, 0
    buffer_load_dwordx4 v42, s[8:11], s40 offen lds
    s_add_u32 m0, s56, 1024
    s_mov_b32 s40, 32768
    buffer_load_dwordx4 v42, s[8:11], s40 offen lds
    s_add_u32 m0, s56, 2048
    s_mov_b32 s40, 65536
    buffer_load_dwordx4 v42, s[8:11], s40 offen lds
    s_add_u32 m0, s56, 3072
    s_mov_b32 s40, 98304
    buffer_load_dwordx4 v42, s[8:11], s40 offen lds
    s_add_u32 m0, s56, 4096
    s_mov_b32 s40, 131072
    buffer_load_dwordx4 v42, s[8:11], s40 offen lds
    s_add_u32 m0, s56, 5120
    s_mov_b32 s40, 163840
    buffer_load_dwordx4 v42, s[8:11], s40 offen lds
    s_add_u32 m0, s56, 6144
    s_mov_b32 s40, 196608
    buffer_load_dwordx4 v42, s[8:11], s40 offen lds
    s_add_u32 m0, s56, 7168
    s_mov_b32 s40, 229376
    buffer_load_dwordx4 v42, s[8:11], s40 offen lds
    s_add_u32 m0, s56, 65536
    s_mov_b32 s40, 1048576
    buffer_load_dwordx4 v42, s[8:11], s40 offen lds
    s_add_u32 m0, s56, 66560
    s_mov_b32 s40, 1081344
    buffer_load_dwordx4 v42, s[8:11], s40 offen lds
    s_add_u32 m0, s56, 67584
    s_mov_b32 s40, 1114112
    buffer_load_dwordx4 v42, s[8:11], s40 offen lds
    s_add_u32 m0, s56, 68608
    s_mov_b32 s40, 1146880
    buffer_load_dwordx4 v42, s[8:11], s40 offen lds
    s_add_u32 m0, s56, 69632
    s_mov_b32 s40, 1179648
    buffer_load_dwordx4 v42, s[8:11], s40 offen lds
    s_add_u32 m0, s56, 70656
    s_mov_b32 s40, 1212416
    buffer_load_dwordx4 v42, s[8:11], s40 offen lds
    s_add_u32 m0, s56, 71680
    s_mov_b32 s40, 1245184
    buffer_load_dwordx4 v42, s[8:11], s40 offen lds
    s_add_u32 m0, s56, 72704
    s_mov_b32 s40, 1277952
    buffer_load_dwordx4 v42, s[8:11], s40 offen lds
    s_load_dwordx2 s[42:43], s[0:1], 0
    v_bfe_u32 v41, v40, 1, 3
    v_lshrrev_b32 v43, 4, v40
    v_xor_b32 v43, v43, v41
    s_mul_i32 s32, s61, 32768
    v_bfe_u32 v41, v40, 3, 1
    v_lshlrev_b32 v1, 10, v41
    v_and_b32 v41, 7, v40
    v_lshl_add_u32 v1, v41, 7, v1
    v_lshl_add_u32 v1, v43, 4, v1
    v_add_u32 v1, s32, v1
    v_xor_b32 v2, 64, v1
    v_and_b32 v41, 7, v40
    v_lshrrev_b32 v43, 4, v40
    v_xor_b32 v43, v43, v41
    s_lshl_b32 s30, s60, 13
    s_mov_b32 s31, 0
    s_mul_i32 s32, s60, 256
    v_lshrrev_b32 v41, 3, v40
    v_lshlrev_b32 v5, 11, v41
    v_lshl_add_u32 v5, v43, 4, v5
    v_add_u32 v5, s32, v5
    v_xor_b32 v6, 64, v5
    s_waitcnt lgkmcnt(0)
    s_mov_b32 s12, s42
    s_and_b32 s13, s43, 0xffff
    s_mov_b32 s14, 4194304
    s_mov_b32 s15, 0x20000
    s_mul_i32 s32, s60, 4096
    s_add_u32 s32, s32, 131072
    v_lshlrev_b32 v7, 4, v40
    v_add_u32 v7, s32, v7
    v_xor_b32 v8, 0x2000, v7
    v_and_b32 v41, 3, v40
    v_lshlrev_b32 v0, 7, v41
    s_mul_i32 s68, s62, 512
    s_add_u32 s68, s68, 98582528
    s_mov_b32 s54, 0x3e0293ee
    s_mov_b32 s58, 0
    s_mov_b32 s28, 0
    s_mul_i32 s32, s62, 16384
    s_mul_i32 s47, s60, 4096
    s_add_u32 s32, s32, s47
    v_lshlrev_b32 v12, 4, v40
    v_add_u32 v12, s32, v12
    s_lshl_b32 s32, s60, 3
    v_and_b32 v41, s32, v40
    v_and_b32 v41, 16, v41
    v_lshlrev_b32 v41, 3, v41
    v_xor_b32 v12, v12, v41
    s_mul_i32 s32, s62, 4096
    s_add_u32 s32, s32, 37748736
    v_lshlrev_b32 v13, 4, v40
    v_add_u32 v13, s32, v13
    s_bfe_u32 s47, s26, 0x30000
    s_mul_i32 s32, s47, 8192
    s_mul_i32 s47, s60, 2048
    s_add_u32 s32, s32, s47
    v_and_b32 v41, 15, v40
    v_lshlrev_b32 v14, 7, v41
    v_add_u32 v14, s32, v14
    s_mul_i32 s32, s62, 8192
    s_bfe_u32 s47, s24, 0x10000
    s_mul_i32 s47, s47, 4096
    s_add_u32 s32, s32, s47
    s_bfe_u32 s47, s24, 0x10001
    s_mul_i32 s47, s47, 2048
    s_add_u32 s32, s32, s47
    s_add_u32 s32, s32, 46137344
    v_lshlrev_b32 v9, 4, v40
    v_add_u32 v9, s32, v9
    s_mul_i32 s32, s60, 1024
    s_add_u32 s32, s32, 147456
    v_lshlrev_b32 v8, 4, v40
    v_add_u32 v8, s32, v8
    s_bfe_u32 s47, s24, 0x10000
    s_mul_i32 s32, s47, 4096
    s_add_u32 s32, s32, 147456
    v_lshlrev_b32 v3, 4, v40
    v_add_u32 v3, s32, v3
    v_lshlrev_b32 v4, 4, v40
    v_add_u32 v4, 98304, v4
    v_bfe_u32 v41, v40, 4, 2
    v_lshlrev_b32 v33, 7, v41
    v_bfe_u32 v41, v40, 2, 2
    v_lshl_add_u32 v33, v41, 5, v33
    v_and_b32 v41, 1, v40
    v_lshl_add_u32 v33, v41, 4, v33
    v_add_u32 v33, 155648, v33
    s_bfe_u32 s47, s24, 0x10001
    s_mul_i32 s32, s47, 2048
    s_add_u32 s32, s32, 106496
    v_bfe_u32 v41, v40, 1, 1
    v_mul_u32_u24 v41, 384, v41
    v_mov_b32 v15, v41
    v_bfe_u32 v41, v40, 2, 3
    v_lshl_add_u32 v15, v41, 4, v15
    v_and_b32 v41, 1, v40
    v_lshl_add_u32 v15, v41, 3, v15
    v_add_u32 v15, s32, v15
    v_and_b32 v41, 32, v40
    v_lshlrev_b32 v41, 2, v41
    v_xor_b32 v15, v15, v41
    s_bfe_u32 s47, s24, 0x10001
    s_mul_i32 s32, s47, 1024
    s_add_u32 s32, s32, 157696
    v_bfe_u32 v41, v40, 1, 1
    v_lshlrev_b32 v32, 7, v41
    v_bfe_u32 v41, v40, 4, 2
    v_lshl_add_u32 v32, v41, 5, v32
    v_bfe_u32 v41, v40, 2, 1
    v_lshl_add_u32 v32, v41, 4, v32
    v_and_b32 v41, 1, v40
    v_lshl_add_u32 v32, v41, 3, v32
    v_add_u32 v32, s32, v32
    s_bfe_u32 s47, s24, 0x10000
    s_mul_i32 s32, s47, 16
    v_and_b32 v41, 15, v40
    v_lshlrev_b32 v43, 0, v41
    v_bfe_u32 v41, v40, 4, 2
    v_mul_u32_u24 v41, 4, v41
    v_sub_u32 v43, v43, v41
    v_add_u32 v43, s32, v43
    v_mov_b32 v44, 0xf149f2ca
    v_cmp_gt_i32 vcc, 0, v43
    s_nop 1
    v_cndmask_b32 v80, 0, v44, vcc
    v_cmp_gt_i32 vcc, 1, v43
    s_nop 1
    v_cndmask_b32 v81, 0, v44, vcc
    v_cmp_gt_i32 vcc, 2, v43
    s_nop 1
    v_cndmask_b32 v82, 0, v44, vcc
    v_cmp_gt_i32 vcc, 3, v43
    s_nop 1
    v_cndmask_b32 v83, 0, v44, vcc
    v_cmp_gt_i32 vcc, 16, v43
    s_nop 1
    v_cndmask_b32 v84, 0, v44, vcc
    v_cmp_gt_i32 vcc, 17, v43
    s_nop 1
    v_cndmask_b32 v85, 0, v44, vcc
    v_cmp_gt_i32 vcc, 18, v43
    s_nop 1
    v_cndmask_b32 v86, 0, v44, vcc
    v_cmp_gt_i32 vcc, 19, v43
    s_nop 1
    v_cndmask_b32 v87, 0, v44, vcc
    v_mov_b32 v88, 0x3f803f80
    v_mov_b32 v92, 0
    v_mov_b32 v120, 0
    v_mov_b32 v89, 0x3f803f80
    v_mov_b32 v93, 0
    v_mov_b32 v121, 0
    v_mov_b32 v90, 0x3f803f80
    v_mov_b32 v94, 0
    v_mov_b32 v122, 0
    v_mov_b32 v91, 0x3f803f80
    v_mov_b32 v95, 0
    v_mov_b32 v123, 0
    s_waitcnt vmcnt(8)
    s_barrier
    ds_read_b64_tr_b16 v[128:129], v45 offset:0
    ds_read_b64_tr_b16 v[130:131], v45 offset:1024
    ds_read_b64_tr_b16 v[132:133], v45 offset:8
    ds_read_b64_tr_b16 v[134:135], v45 offset:1032
    ds_read_b64_tr_b16 v[136:137], v45 offset:8192
    ds_read_b64_tr_b16 v[138:139], v45 offset:9216
    ds_read_b64_tr_b16 v[140:141], v45 offset:8200
    ds_read_b64_tr_b16 v[142:143], v45 offset:9224
    ds_read_b64_tr_b16 v[144:145], v45 offset:16384
    ds_read_b64_tr_b16 v[146:147], v45 offset:17408
    ds_read_b64_tr_b16 v[148:149], v45 offset:16392
    ds_read_b64_tr_b16 v[150:151], v45 offset:17416
    ds_read_b64_tr_b16 v[152:153], v45 offset:24576
    ds_read_b64_tr_b16 v[154:155], v45 offset:25600
    ds_read_b64_tr_b16 v[156:157], v45 offset:24584
    ds_read_b64_tr_b16 v[158:159], v45 offset:25608
    v_xor_b32 v45, 0x10000, v45
    s_waitcnt lgkmcnt(0)
    s_barrier
    s_add_u32 m0, s56, 0
    s_mov_b32 s40, 2097152
    buffer_load_dwordx4 v42, s[8:11], s40 offen lds
    s_add_u32 m0, s56, 1024
    s_mov_b32 s40, 2129920
    buffer_load_dwordx4 v42, s[8:11], s40 offen lds
    s_add_u32 m0, s56, 2048
    s_mov_b32 s40, 2162688
    buffer_load_dwordx4 v42, s[8:11], s40 offen lds
    s_add_u32 m0, s56, 3072
    s_mov_b32 s40, 2195456
    buffer_load_dwordx4 v42, s[8:11], s40 offen lds
    s_add_u32 m0, s56, 4096
    s_mov_b32 s40, 2228224
    buffer_load_dwordx4 v42, s[8:11], s40 offen lds
    s_add_u32 m0, s56, 5120
    s_mov_b32 s40, 2260992
    buffer_load_dwordx4 v42, s[8:11], s40 offen lds
    s_add_u32 m0, s56, 6144
    s_mov_b32 s40, 2293760
    buffer_load_dwordx4 v42, s[8:11], s40 offen lds
    s_add_u32 m0, s56, 7168
    s_mov_b32 s40, 2326528
    buffer_load_dwordx4 v42, s[8:11], s40 offen lds
    s_waitcnt vmcnt(8)
    s_barrier
    ds_read_b64_tr_b16 v[160:161], v45 offset:0
    ds_read_b64_tr_b16 v[162:163], v45 offset:1024
    ds_read_b64_tr_b16 v[164:165], v45 offset:8
    ds_read_b64_tr_b16 v[166:167], v45 offset:1032
    ds_read_b64_tr_b16 v[168:169], v45 offset:8192
    ds_read_b64_tr_b16 v[170:171], v45 offset:9216
    ds_read_b64_tr_b16 v[172:173], v45 offset:8200
    ds_read_b64_tr_b16 v[174:175], v45 offset:9224
    ds_read_b64_tr_b16 v[176:177], v45 offset:16384
    ds_read_b64_tr_b16 v[178:179], v45 offset:17408
    ds_read_b64_tr_b16 v[180:181], v45 offset:16392
    ds_read_b64_tr_b16 v[182:183], v45 offset:17416
    ds_read_b64_tr_b16 v[184:185], v45 offset:24576
    ds_read_b64_tr_b16 v[186:187], v45 offset:25600
    ds_read_b64_tr_b16 v[188:189], v45 offset:24584
    ds_read_b64_tr_b16 v[190:191], v45 offset:25608
    v_xor_b32 v45, 0x10000, v45
    s_waitcnt lgkmcnt(0)
    s_barrier
    s_add_u32 m0, s56, 65536
    s_mov_b32 s40, 3145728
    buffer_load_dwordx4 v42, s[8:11], s40 offen lds
    s_add_u32 m0, s56, 66560
    s_mov_b32 s40, 3178496
    buffer_load_dwordx4 v42, s[8:11], s40 offen lds
    s_add_u32 m0, s56, 67584
    s_mov_b32 s40, 3211264
    buffer_load_dwordx4 v42, s[8:11], s40 offen lds
    s_add_u32 m0, s56, 68608
    s_mov_b32 s40, 3244032
    buffer_load_dwordx4 v42, s[8:11], s40 offen lds
    s_add_u32 m0, s56, 69632
    s_mov_b32 s40, 3276800
    buffer_load_dwordx4 v42, s[8:11], s40 offen lds
    s_add_u32 m0, s56, 70656
    s_mov_b32 s40, 3309568
    buffer_load_dwordx4 v42, s[8:11], s40 offen lds
    s_add_u32 m0, s56, 71680
    s_mov_b32 s40, 3342336
    buffer_load_dwordx4 v42, s[8:11], s40 offen lds
    s_add_u32 m0, s56, 72704
    s_mov_b32 s40, 3375104
    buffer_load_dwordx4 v42, s[8:11], s40 offen lds
    s_waitcnt vmcnt(8)
    s_barrier
    ds_read_b64_tr_b16 v[192:193], v45 offset:0
    ds_read_b64_tr_b16 v[194:195], v45 offset:1024
    ds_read_b64_tr_b16 v[196:197], v45 offset:8
    ds_read_b64_tr_b16 v[198:199], v45 offset:1032
    ds_read_b64_tr_b16 v[200:201], v45 offset:8192
    ds_read_b64_tr_b16 v[202:203], v45 offset:9216
    ds_read_b64_tr_b16 v[204:205], v45 offset:8200
    ds_read_b64_tr_b16 v[206:207], v45 offset:9224
    ds_read_b64_tr_b16 v[208:209], v45 offset:16384
    ds_read_b64_tr_b16 v[210:211], v45 offset:17408
    ds_read_b64_tr_b16 v[212:213], v45 offset:16392
    ds_read_b64_tr_b16 v[214:215], v45 offset:17416
    ds_read_b64_tr_b16 v[216:217], v45 offset:24576
    ds_read_b64_tr_b16 v[218:219], v45 offset:25600
    ds_read_b64_tr_b16 v[220:221], v45 offset:24584
    ds_read_b64_tr_b16 v[222:223], v45 offset:25608
    v_xor_b32 v45, 0x10000, v45
    s_waitcnt lgkmcnt(0)
    s_barrier
    s_waitcnt vmcnt(0)
    s_barrier
    ds_read_b64_tr_b16 v[224:225], v45 offset:0
    ds_read_b64_tr_b16 v[226:227], v45 offset:1024
    ds_read_b64_tr_b16 v[228:229], v45 offset:8
    ds_read_b64_tr_b16 v[230:231], v45 offset:1032
    ds_read_b64_tr_b16 v[232:233], v45 offset:8192
    ds_read_b64_tr_b16 v[234:235], v45 offset:9216
    ds_read_b64_tr_b16 v[236:237], v45 offset:8200
    ds_read_b64_tr_b16 v[238:239], v45 offset:9224
    ds_read_b64_tr_b16 v[240:241], v45 offset:16384
    ds_read_b64_tr_b16 v[242:243], v45 offset:17408
    ds_read_b64_tr_b16 v[244:245], v45 offset:16392
    ds_read_b64_tr_b16 v[246:247], v45 offset:17416
    ds_read_b64_tr_b16 v[248:249], v45 offset:24576
    ds_read_b64_tr_b16 v[250:251], v45 offset:25600
    ds_read_b64_tr_b16 v[252:253], v45 offset:24584
    ds_read_b64_tr_b16 v[254:255], v45 offset:25608
    v_xor_b32 v45, 0x10000, v45
    s_waitcnt lgkmcnt(0)
    s_barrier
    s_cmp_eq_u32 s61, 0
    s_cbranch_scc1 L_q_x0
    s_add_u32 s66, s30, 0x8000
    s_setprio 1
L_q_y:
    s_cmp_lg_u32 s24, 4
    s_cbranch_scc1 FS_15
    s_add_u32 s74, s28, -1
    s_max_i32 s74, s74, 0
    v_mov_b32 v11, s74
    s_mov_b64 exec, 1
    s_cmp_lg_u32 s27, 0
    s_cbranch_scc1 FS_16
    buffer_store_dword v11, v10, s[4:7], s51 offen
    s_mov_b64 exec, -1
    s_branch FS_15
FS_16:
    buffer_store_dword v11, v10, s[4:7], s51 offen sc1
    s_mov_b64 exec, -1
FS_15:
    s_add_u32 m0, s66, 0
    s_add_u32 s34, s31, 1024
    buffer_load_dwordx4 v5, s[12:15], s34 offen lds
    s_add_u32 m0, s66, 1024
    s_add_u32 s34, s31, 17408
    buffer_load_dwordx4 v6, s[12:15], s34 offen lds
    s_add_u32 m0, s66, 2048
    s_add_u32 s34, s31, 33792
    buffer_load_dwordx4 v5, s[12:15], s34 offen lds
    s_add_u32 m0, s66, 3072
    s_add_u32 s34, s31, 50176
    buffer_load_dwordx4 v6, s[12:15], s34 offen lds
    s_add_u32 m0, s66, 4096
    s_add_u32 s34, s31, 1152
    buffer_load_dwordx4 v5, s[12:15], s34 offen lds
    s_add_u32 m0, s66, 5120
    s_add_u32 s34, s31, 17536
    buffer_load_dwordx4 v6, s[12:15], s34 offen lds
    s_add_u32 m0, s66, 6144
    s_add_u32 s34, s31, 33920
    buffer_load_dwordx4 v5, s[12:15], s34 offen lds
    s_add_u32 m0, s66, 7168
    s_add_u32 s34, s31, 50304
    buffer_load_dwordx4 v6, s[12:15], s34 offen lds
    s_add_u32 m0, s30, 0
    s_add_u32 s34, s31, 0
    buffer_load_dwordx4 v5, s[12:15], s34 offen lds
    s_add_u32 m0, s30, 1024
    s_add_u32 s34, s31, 16384
    buffer_load_dwordx4 v6, s[12:15], s34 offen lds
    s_add_u32 m0, s30, 2048
    s_add_u32 s34, s31, 32768
    buffer_load_dwordx4 v5, s[12:15], s34 offen lds
    s_add_u32 m0, s30, 3072
    s_add_u32 s34, s31, 49152
    buffer_load_dwordx4 v6, s[12:15], s34 offen lds
    s_add_u32 m0, s30, 4096
    s_add_u32 s34, s31, 128
    buffer_load_dwordx4 v5, s[12:15], s34 offen lds
    s_add_u32 m0, s30, 5120
    s_add_u32 s34, s31, 16512
    buffer_load_dwordx4 v6, s[12:15], s34 offen lds
    s_mov_b64 exec, 0xffff
    s_add_u32 s34, s31, 131072
    buffer_load_dword v32, v14, s[12:15], s34 offen
    s_mov_b64 exec, -1
    s_waitcnt vmcnt(7)
    s_barrier
    ds_read_b128 v[40:43], v1 offset:0
    ds_read_b128 v[44:47], v2 offset:0
    ds_read_b128 v[48:51], v1 offset:4096
    ds_read_b128 v[52:55], v2 offset:4096
    ds_read_b128 v[56:59], v1 offset:8192
    ds_read_b128 v[60:63], v2 offset:8192
    ds_read_b128 v[64:67], v1 offset:12288
    s_waitcnt lgkmcnt(6)
    v_mfma_f32_16x16x32_bf16 v[16:19], v[128:131], v[40:43], 0
    ds_read_b128 v[68:71], v2 offset:12288
    v_mfma_f32_16x16x32_bf16 v[20:23], v[132:135], v[40:43], 0
    s_waitcnt lgkmcnt(6)
    v_mfma_f32_16x16x32_bf16 v[16:19], v[136:139], v[44:47], v[16:19]
    ds_read_b128 v[40:43], v1 offset:16384
    v_mfma_f32_16x16x32_bf16 v[20:23], v[140:143], v[44:47], v[20:23]
    s_waitcnt lgkmcnt(6)
    v_mfma_f32_16x16x32_bf16 v[16:19], v[144:147], v[48:51], v[16:19]
    ds_read_b128 v[44:47], v2 offset:16384
    v_mfma_f32_16x16x32_bf16 v[20:23], v[148:151], v[48:51], v[20:23]
    s_waitcnt lgkmcnt(6)
    v_mfma_f32_16x16x32_bf16 v[16:19], v[152:155], v[52:55], v[16:19]
    ds_read_b128 v[48:51], v1 offset:20480
    v_mfma_f32_16x16x32_bf16 v[20:23], v[156:159], v[52:55], v[20:23]
    s_waitcnt lgkmcnt(6)
    v_mfma_f32_16x16x32_bf16 v[16:19], v[160:163], v[56:59], v[16:19]
    ds_read_b128 v[52:55], v2 offset:20480
    v_mfma_f32_16x16x32_bf16 v[20:23], v[164:167], v[56:59], v[20:23]
    s_barrier
    s_waitcnt lgkmcnt(6)
    v_mfma_f32_16x16x32_bf16 v[16:19], v[168:171], v[60:63], v[16:19]
    ds_read_b128 v[56:59], v1 offset:24576
    v_mfma_f32_16x16x32_bf16 v[20:23], v[172:175], v[60:63], v[20:23]
    s_waitcnt lgkmcnt(6)
    v_mfma_f32_16x16x32_bf16 v[16:19], v[176:179], v[64:67], v[16:19]
    ds_read_b128 v[60:63], v2 offset:24576
    v_mfma_f32_16x16x32_bf16 v[20:23], v[180:183], v[64:67], v[20:23]
    s_waitcnt lgkmcnt(6)
    v_mfma_f32_16x16x32_bf16 v[16:19], v[184:187], v[68:71], v[16:19]
    ds_read_b128 v[64:67], v1 offset:28672
    v_mfma_f32_16x16x32_bf16 v[20:23], v[188:191], v[68:71], v[20:23]
    s_waitcnt lgkmcnt(6)
    v_mfma_f32_16x16x32_bf16 v[16:19], v[192:195], v[40:43], v[16:19]
    ds_read_b128 v[68:71], v2 offset:28672
    v_mfma_f32_16x16x32_bf16 v[20:23], v[196:199], v[40:43], v[20:23]
    s_waitcnt lgkmcnt(6)
    v_mfma_f32_16x16x32_bf16 v[16:19], v[200:203], v[44:47], v[16:19]
    ds_read_b128 v[40:43], v1 offset:2048
    v_mfma_f32_16x16x32_bf16 v[20:23], v[204:207], v[44:47], v[20:23]
    s_waitcnt lgkmcnt(6)
    v_mfma_f32_16x16x32_bf16 v[16:19], v[208:211], v[48:51], v[16:19]
    ds_read_b128 v[44:47], v2 offset:2048
    v_mfma_f32_16x16x32_bf16 v[20:23], v[212:215], v[48:51], v[20:23]
    s_waitcnt lgkmcnt(6)
    v_mfma_f32_16x16x32_bf16 v[16:19], v[216:219], v[52:55], v[16:19]
    ds_read_b128 v[48:51], v1 offset:6144
    v_mfma_f32_16x16x32_bf16 v[20:23], v[220:223], v[52:55], v[20:23]
    s_waitcnt lgkmcnt(6)
    v_mfma_f32_16x16x32_bf16 v[16:19], v[224:227], v[56:59], v[16:19]
    ds_read_b128 v[52:55], v2 offset:6144
    v_mfma_f32_16x16x32_bf16 v[20:23], v[228:231], v[56:59], v[20:23]
    s_waitcnt lgkmcnt(6)
    v_mfma_f32_16x16x32_bf16 v[16:19], v[232:235], v[60:63], v[16:19]
    ds_read_b128 v[56:59], v1 offset:10240
    v_mfma_f32_16x16x32_bf16 v[20:23], v[236:239], v[60:63], v[20:23]
    s_waitcnt lgkmcnt(6)
    v_mfma_f32_16x16x32_bf16 v[16:19], v[240:243], v[64:67], v[16:19]
    ds_read_b128 v[60:63], v2 offset:10240
    v_mfma_f32_16x16x32_bf16 v[20:23], v[244:247], v[64:67], v[20:23]
    s_waitcnt lgkmcnt(6)
    v_mfma_f32_16x16x32_bf16 v[16:19], v[248:251], v[68:71], v[16:19]
    ds_read_b128 v[64:67], v1 offset:14336
    v_mfma_f32_16x16x32_bf16 v[20:23], v[252:255], v[68:71], v[20:23]
    s_waitcnt lgkmcnt(6)
    v_mfma_f32_16x16x32_bf16 v[24:27], v[128:131], v[40:43], 0
    ds_read_b128 v[68:71], v2 offset:14336
    v_mfma_f32_16x16x32_bf16 v[28:31], v[132:135], v[40:43], 0
    s_waitcnt lgkmcnt(6)
    v_mfma_f32_16x16x32_bf16 v[24:27], v[136:139], v[44:47], v[24:27]
    ds_read_b128 v[40:43], v1 offset:18432
    v_mfma_f32_16x16x32_bf16 v[28:31], v[140:143], v[44:47], v[28:31]
    s_waitcnt lgkmcnt(6)
    v_mfma_f32_16x16x32_bf16 v[24:27], v[144:147], v[48:51], v[24:27]
    ds_read_b128 v[44:47], v2 offset:18432
    v_mfma_f32_16x16x32_bf16 v[28:31], v[148:151], v[48:51], v[28:31]
    s_waitcnt lgkmcnt(6)
    v_mfma_f32_16x16x32_bf16 v[24:27], v[152:155], v[52:55], v[24:27]
    ds_read_b128 v[48:51], v1 offset:22528
    v_mfma_f32_16x16x32_bf16 v[28:31], v[156:159], v[52:55], v[28:31]
    s_waitcnt lgkmcnt(6)
    v_mfma_f32_16x16x32_bf16 v[24:27], v[160:163], v[56:59], v[24:27]
    ds_read_b128 v[52:55], v2 offset:22528
    v_mfma_f32_16x16x32_bf16 v[28:31], v[164:167], v[56:59], v[28:31]
    s_waitcnt lgkmcnt(6)
    v_mfma_f32_16x16x32_bf16 v[24:27], v[168:171], v[60:63], v[24:27]
    ds_read_b128 v[56:59], v1 offset:26624
    v_mfma_f32_16x16x32_bf16 v[28:31], v[172:175], v[60:63], v[28:31]
    s_waitcnt lgkmcnt(6)
    v_mfma_f32_16x16x32_bf16 v[24:27], v[176:179], v[64:67], v[24:27]
    ds_read_b128 v[60:63], v2 offset:26624
    v_mfma_f32_16x16x32_bf16 v[28:31], v[180:183], v[64:67], v[28:31]
    s_waitcnt lgkmcnt(6)
    v_mfma_f32_16x16x32_bf16 v[24:27], v[184:187], v[68:71], v[24:27]
    ds_read_b128 v[64:67], v1 offset:30720
    v_mfma_f32_16x16x32_bf16 v[28:31], v[188:191], v[68:71], v[28:31]
    s_waitcnt lgkmcnt(6)
    v_mfma_f32_16x16x32_bf16 v[24:27], v[192:195], v[40:43], v[24:27]
    ds_read_b128 v[68:71], v2 offset:30720
    v_mfma_f32_16x16x32_bf16 v[28:31], v[196:199], v[40:43], v[28:31]
    s_waitcnt lgkmcnt(6)
    v_mfma_f32_16x16x32_bf16 v[24:27], v[200:203], v[44:47], v[24:27]
    v_mfma_f32_16x16x32_bf16 v[28:31], v[204:207], v[44:47], v[28:31]
    s_waitcnt lgkmcnt(5)
    v_mfma_f32_16x16x32_bf16 v[24:27], v[208:211], v[48:51], v[24:27]
    v_mfma_f32_16x16x32_bf16 v[28:31], v[212:215], v[48:51], v[28:31]
    s_waitcnt lgkmcnt(4)
    v_mfma_f32_16x16x32_bf16 v[24:27], v[216:219], v[52:55], v[24:27]
    v_mfma_f32_16x16x32_bf16 v[28:31], v[220:223], v[52:55], v[28:31]
    s_waitcnt lgkmcnt(3)
    v_mfma_f32_16x16x32_bf16 v[24:27], v[224:227], v[56:59], v[24:27]
    v_mfma_f32_16x16x32_bf16 v[28:31], v[228:231], v[56:59], v[28:31]
    ds_write_b128 v7, v[16:19] offset:0
    ds_write_b128 v7, v[20:23] offset:1024
    s_waitcnt lgkmcnt(4)
    v_mfma_f32_16x16x32_bf16 v[24:27], v[232:235], v[60:63], v[24:27]
    v_mfma_f32_16x16x32_bf16 v[28:31], v[236:239], v[60:63], v[28:31]
    s_waitcnt lgkmcnt(3)
    v_mfma_f32_16x16x32_bf16 v[24:27], v[240:243], v[64:67], v[24:27]
    v_mfma_f32_16x16x32_bf16 v[28:31], v[244:247], v[64:67], v[28:31]
    s_waitcnt lgkmcnt(2)
    v_mfma_f32_16x16x32_bf16 v[24:27], v[248:251], v[68:71], v[24:27]
    v_mfma_f32_16x16x32_bf16 v[28:31], v[252:255], v[68:71], v[28:31]
    s_nop 1
    s_add_u32 s31, s31, 65536
    s_xor_b32 s30, s30, 0x10000
    s_nop 3
    ds_write_b128 v7, v[24:27] offset:2048
    ds_write_b128 v7, v[28:31] offset:3072
    s_waitcnt vmcnt(0) lgkmcnt(0)
    s_barrier
    s_add_u32 s28, s28, 1
    s_cmp_lt_u32 s28, 64
    s_cbranch_scc1 L_q_y
    s_cmp_lg_u32 s24, 4
    s_cbranch_scc1 FS_17
    s_add_u32 s74, s28, -1
    s_max_i32 s74, s74, 0
    v_mov_b32 v11, s74
    s_mov_b64 exec, 1
    s_cmp_lg_u32 s27, 0
    s_cbranch_scc1 FS_18
    buffer_store_dword v11, v10, s[4:7], s51 offen
    s_mov_b64 exec, -1
    s_branch FS_17
FS_18:
    buffer_store_dword v11, v10, s[4:7], s51 offen sc1
    s_mov_b64 exec, -1
FS_17:
    s_barrier
    s_barrier
    s_barrier
    s_cmp_lg_u32 s24, 4
    s_cbranch_scc1 FS_19
    s_add_u32 s74, s28, 0
    s_max_i32 s74, s74, 0
    v_mov_b32 v11, s74
    s_mov_b64 exec, 1
    s_cmp_lg_u32 s27, 0
    s_cbranch_scc1 FS_20
    buffer_store_dword v11, v10, s[4:7], s51 offen
    s_mov_b64 exec, -1
    s_branch FS_19
FS_20:
    buffer_store_dword v11, v10, s[4:7], s51 offen sc1
    s_mov_b64 exec, -1
FS_19:
    s_branch L_done
L_q_x0:
    s_lshr_b32 s47, s62, 3
    s_mul_i32 s69, s47, 128
    s_add_u32 s69, s69, 98615296
    v_bfe_u32 v41, v14, 7, 3
    v_lshlrev_b32 v34, 9, v41
    s_mul_i32 s50, s60, 4096
    s_add_u32 s50, s50, 98304
    s_bfe_u32 s47, s24, 0x10001
    s_mul_i32 s66, s47, 1024
    s_mov_b32 s59, 0
    s_mov_b32 s52, 0
    v_mov_b32 v35, 0
    s_barrier
    s_barrier
    s_mov_b32 s32, 1
    s_cmp_ge_i32 s58, s32
    s_cbranch_scc1 PD_22
    s_mov_b32 s48, 400000
PW_21:
    s_mov_b64 exec, 0xf
    buffer_load_dword v11, v0, s[4:7], s68 offen sc1
    s_mov_b64 exec, -1
    s_sub_u32 s48, s48, 1
    s_cbranch_scc1 L_abort
    s_waitcnt vmcnt(0)
    v_min_u32_dpp v11, v11, v11 quad_perm:[1,0,3,2] row_mask:0xf bank_mask:0xf
    s_nop 1
    v_min_u32_dpp v11, v11, v11 quad_perm:[2,3,0,1] row_mask:0xf bank_mask:0xf
    s_nop 0
    v_readfirstlane_b32 s58, v11
    s_nop 3
    s_cmp_ge_i32 s58, s32
    s_cbranch_scc1 PD_22
    s_sleep 2
    s_branch PW_21
PD_22:
    s_mov_b32 s28, -1
    s_add_u32 s53, s28, 1
    s_lshl_b32 s53, s53, 19
    s_cmp_eq_u32 s28, 63
    s_cselect_b32 s53, 2146435056, s53
    s_mov_b32 m0, s50
    s_xor_b32 s50, s50, 0x4000
    buffer_load_dwordx4 v12, s[4:7], s53 offen offset:0 sc1 lds
    buffer_load_dwordx4 v12, s[4:7], s53 offen offset:1024 sc1 lds
    buffer_load_dwordx4 v12, s[4:7], s53 offen offset:2048 sc1 lds
    buffer_load_dwordx4 v12, s[4:7], s53 offen offset:3072 sc1 lds
    s_add_u32 m0, s30, 6144
    s_add_u32 s34, s31, 32896
    buffer_load_dwordx4 v5, s[12:15], s34 offen lds
    s_add_u32 m0, s30, 7168
    s_add_u32 s34, s31, 49280
    buffer_load_dwordx4 v6, s[12:15], s34 offen lds
    s_mov_b32 s28, 0
    s_waitcnt vmcnt(0)
L_q_x:
    s_setprio 3
    s_barrier
    ds_read_b128 v[16:19], v7 offset:0
    ds_read_b128 v[20:23], v7 offset:1024
    ds_read_b128 v[40:43], v1 offset:0
    ds_read_b128 v[44:47], v2 offset:0
    ds_read_b128 v[48:51], v1 offset:4096
    ds_read_b128 v[24:27], v7 offset:2048
    ds_read_b128 v[28:31], v7 offset:3072
    s_waitcnt lgkmcnt(4)
    v_mfma_f32_16x16x32_bf16 v[16:19], v[128:131], v[40:43], v[16:19]
    ds_read_b128 v[52:55], v2 offset:4096
    v_mfma_f32_16x16x32_bf16 v[20:23], v[132:135], v[40:43], v[20:23]
    s_waitcnt lgkmcnt(4)
    v_mfma_f32_16x16x32_bf16 v[16:19], v[136:139], v[44:47], v[16:19]
    ds_read_b128 v[40:43], v1 offset:8192
    v_mfma_f32_16x16x32_bf16 v[20:23], v[140:143], v[44:47], v[20:23]
    s_waitcnt lgkmcnt(4)
    v_mfma_f32_16x16x32_bf16 v[16:19], v[144:147], v[48:51], v[16:19]
    ds_read_b128 v[44:47], v2 offset:8192
    v_mfma_f32_16x16x32_bf16 v[20:23], v[148:151], v[48:51], v[20:23]
    ds_read_b128 v[56:59], v4 offset:0
    s_waitcnt lgkmcnt(3)
    v_mfma_f32_16x16x32_bf16 v[16:19], v[152:155], v[52:55], v[16:19]
    ds_read_b128 v[48:51], v1 offset:12288
    v_mfma_f32_16x16x32_bf16 v[20:23], v[156:159], v[52:55], v[20:23]
    s_waitcnt lgkmcnt(3)
    v_mfma_f32_16x16x32_bf16 v[16:19], v[160:163], v[40:43], v[16:19]
    ds_read_b128 v[52:55], v2 offset:12288
    v_mfma_f32_16x16x32_bf16 v[20:23], v[164:167], v[40:43], v[20:23]
    ds_read_b128 v[60:63], v4 offset:4096
    s_waitcnt lgkmcnt(4)
    v_mfma_f32_16x16x32_bf16 v[16:19], v[168:171], v[44:47], v[16:19]
    ds_read_b128 v[40:43], v1 offset:16384
    v_mfma_f32_16x16x32_bf16 v[20:23], v[172:175], v[44:47], v[20:23]
    s_waitcnt lgkmcnt(3)
    v_mfma_f32_16x16x32_bf16 v[16:19], v[176:179], v[48:51], v[16:19]
    ds_read_b128 v[44:47], v2 offset:16384
    v_mfma_f32_16x16x32_bf16 v[20:23], v[180:183], v[48:51], v[20:23]
    ds_read_b128 v[64:67], v4 offset:1024
    s_waitcnt lgkmcnt(4)
    v_mfma_f32_16x16x32_bf16 v[16:19], v[184:187], v[52:55], v[16:19]
    ds_read_b128 v[48:51], v1 offset:20480
    v_mfma_f32_16x16x32_bf16 v[20:23], v[188:191], v[52:55], v[20:23]
    s_waitcnt lgkmcnt(3)
    v_mfma_f32_16x16x32_bf16 v[16:19], v[192:195], v[40:43], v[16:19]
    ds_read_b128 v[52:55], v2 offset:20480
    v_mfma_f32_16x16x32_bf16 v[20:23], v[196:199], v[40:43], v[20:23]
    ds_read_b128 v[68:71], v4 offset:5120
    s_waitcnt lgkmcnt(4)
    v_mfma_f32_16x16x32_bf16 v[16:19], v[200:203], v[44:47], v[16:19]
    ds_read_b128 v[40:43], v1 offset:24576
    v_mfma_f32_16x16x32_bf16 v[20:23], v[204:207], v[44:47], v[20:23]
    s_waitcnt lgkmcnt(3)
    v_mfma_f32_16x16x32_bf16 v[16:19], v[208:211], v[48:51], v[16:19]
    ds_read_b128 v[44:47], v2 offset:24576
    v_mfma_f32_16x16x32_bf16 v[20:23], v[212:215], v[48:51], v[20:23]
    ds_read_b128 v[72:75], v4 offset:2048
    s_waitcnt lgkmcnt(4)
    v_mfma_f32_16x16x32_bf16 v[16:19], v[216:219], v[52:55], v[16:19]
    ds_read_b128 v[48:51], v1 offset:28672
    v_mfma_f32_16x16x32_bf16 v[20:23], v[220:223], v[52:55], v[20:23]
    s_waitcnt lgkmcnt(3)
    v_mfma_f32_16x16x32_bf16 v[16:19], v[224:227], v[40:43], v[16:19]
    ds_read_b128 v[52:55], v2 offset:28672
    v_mfma_f32_16x16x32_bf16 v[20:23], v[228:231], v[40:43], v[20:23]
    ds_read_b128 v[76:79], v4 offset:6144
    s_waitcnt lgkmcnt(4)
    v_mfma_f32_16x16x32_bf16 v[16:19], v[232:235], v[44:47], v[16:19]
    ds_read_b128 v[40:43], v1 offset:2048
    v_mfma_f32_16x16x32_bf16 v[20:23], v[236:239], v[44:47], v[20:23]
    s_waitcnt lgkmcnt(3)
    v_mfma_f32_16x16x32_bf16 v[16:19], v[240:243], v[48:51], v[16:19]
    ds_read_b128 v[44:47], v2 offset:2048
    v_mfma_f32_16x16x32_bf16 v[20:23], v[244:247], v[48:51], v[20:23]
    ds_read_b64_tr_b16 v[96:97], v15 offset:0
    s_waitcnt lgkmcnt(4)
    v_mfma_f32_16x16x32_bf16 v[16:19], v[248:251], v[52:55], v[16:19]
    ds_read_b128 v[48:51], v1 offset:6144
    v_mfma_f32_16x16x32_bf16 v[20:23], v[252:255], v[52:55], v[20:23]
    s_waitcnt lgkmcnt(3)
    v_mfma_f32_16x16x32_bf16 v[24:27], v[128:131], v[40:43], v[24:27]
    ds_read_b128 v[52:55], v2 offset:6144
    v_mfma_f32_16x16x32_bf16 v[28:31], v[132:135], v[40:43], v[28:31]
    ds_read_b64_tr_b16 v[98:99], v15 offset:4096
    s_waitcnt lgkmcnt(4)
    v_mfma_f32_16x16x32_bf16 v[24:27], v[136:139], v[44:47], v[24:27]
    ds_read_b128 v[40:43], v1 offset:10240
    v_mfma_f32_16x16x32_bf16 v[28:31], v[140:143], v[44:47], v[28:31]
    s_waitcnt lgkmcnt(3)
    v_mfma_f32_16x16x32_bf16 v[24:27], v[144:147], v[48:51], v[24:27]
    ds_read_b128 v[44:47], v2 offset:10240
    v_mfma_f32_16x16x32_bf16 v[28:31], v[148:151], v[48:51], v[28:31]
    ds_read_b64_tr_b16 v[100:101], v15 offset:512
    s_waitcnt lgkmcnt(4)
    v_mfma_f32_16x16x32_bf16 v[24:27], v[152:155], v[52:55], v[24:27]
    ds_read_b128 v[48:51], v1 offset:14336
    v_mfma_f32_16x16x32_bf16 v[28:31], v[156:159], v[52:55], v[28:31]
    v_cvt_pk_bf16_f32 v120, v16, v17
    v_cvt_pk_bf16_f32 v121, v18, v19
    v_cvt_pk_bf16_f32 v122, v20, v21
    v_cvt_pk_bf16_f32 v123, v22, v23
    s_waitcnt lgkmcnt(3)
    v_mfma_f32_16x16x32_bf16 v[24:27], v[160:163], v[40:43], v[24:27]
    ds_read_b128 v[52:55], v2 offset:14336
    v_mfma_f32_16x16x32_bf16 v[28:31], v[164:167], v[40:43], v[28:31]
    ds_read_b64_tr_b16 v[102:103], v15 offset:4608
    s_waitcnt lgkmcnt(4)
    v_mfma_f32_16x16x32_bf16 v[24:27], v[168:171], v[44:47], v[24:27]
    ds_read_b128 v[40:43], v1 offset:18432
    v_mfma_f32_16x16x32_bf16 v[28:31], v[172:175], v[44:47], v[28:31]
    s_add_u32 s32, s28, 2
    s_cmp_gt_u32 s58, s32
    s_cbranch_scc1 QF_23
    s_mov_b64 exec, 0xf
    buffer_load_dword v11, v0, s[4:7], s68 offen sc1
    s_mov_b64 exec, -1
QF_23:
    s_sub_u32 s32, s28, 6
    s_cmp_ge_i32 s59, s32
    s_cbranch_scc1 QF_24
    s_mov_b64 exec, 0xff
    buffer_load_dword v35, v34, s[4:7], s69 offen sc1
    s_mov_b64 exec, -1
QF_24:
    s_waitcnt lgkmcnt(3)
    v_mfma_f32_16x16x32_bf16 v[24:27], v[176:179], v[48:51], v[24:27]
    ds_read_b128 v[44:47], v2 offset:18432
    v_mfma_f32_16x16x32_bf16 v[28:31], v[180:183], v[48:51], v[28:31]
    ds_read_b64_tr_b16 v[104:105], v15 offset:1024
    s_waitcnt lgkmcnt(4)
    v_mfma_f32_16x16x32_bf16 v[24:27], v[184:187], v[52:55], v[24:27]
    ds_read_b128 v[48:51], v1 offset:22528
    v_mfma_f32_16x16x32_bf16 v[28:31], v[188:191], v[52:55], v[28:31]
    s_waitcnt lgkmcnt(3)
    v_mfma_f32_16x16x32_bf16 v[24:27], v[192:195], v[40:43], v[24:27]
    ds_read_b128 v[52:55], v2 offset:22528
    v_mfma_f32_16x16x32_bf16 v[28:31], v[196:199], v[40:43], v[28:31]
    ds_read_b64_tr_b16 v[106:107], v15 offset:5120
    s_barrier
    s_waitcnt lgkmcnt(4)
    v_mfma_f32_16x16x32_bf16 v[24:27], v[200:203], v[44:47], v[24:27]
    ds_read_b128 v[40:43], v1 offset:26624
    v_mfma_f32_16x16x32_bf16 v[28:31], v[204:207], v[44:47], v[28:31]
    s_waitcnt lgkmcnt(3)
    v_mfma_f32_16x16x32_bf16 v[24:27], v[208:211], v[48:51], v[24:27]
    ds_read_b128 v[44:47], v2 offset:26624
    v_mfma_f32_16x16x32_bf16 v[28:31], v[212:215], v[48:51], v[28:31]
    ds_read_b64_tr_b16 v[108:109], v15 offset:1536
    s_waitcnt lgkmcnt(4)
    v_mfma_f32_16x16x32_bf16 v[24:27], v[216:219], v[52:55], v[24:27]
    ds_read_b128 v[48:51], v1 offset:30720
    v_mfma_f32_16x16x32_bf16 v[28:31], v[220:223], v[52:55], v[28:31]
    s_waitcnt lgkmcnt(3)
    v_mfma_f32_16x16x32_bf16 v[24:27], v[224:227], v[40:43], v[24:27]
    ds_read_b128 v[52:55], v2 offset:30720
    v_mfma_f32_16x16x32_bf16 v[28:31], v[228:231], v[40:43], v[28:31]
    ds_read_b64_tr_b16 v[110:111], v15 offset:5632
    s_waitcnt lgkmcnt(4)
    v_mfma_f32_16x16x32_bf16 v[24:27], v[232:235], v[44:47], v[24:27]
    v_mfma_f32_16x16x32_bf16 v[28:31], v[236:239], v[44:47], v[28:31]
    ds_write_b128 v8, v[120:123]
    s_waitcnt lgkmcnt(3)
    v_mfma_f32_16x16x32_bf16 v[24:27], v[240:243], v[48:51], v[24:27]
    v_mfma_f32_16x16x32_bf16 v[28:31], v[244:247], v[48:51], v[28:31]
    s_waitcnt lgkmcnt(2)
    v_mfma_f32_16x16x32_bf16 v[24:27], v[248:251], v[52:55], v[24:27]
    v_mfma_f32_16x16x32_bf16 v[28:31], v[252:255], v[52:55], v[28:31]
    v_xor_b32 v1, 0x10000, v1
    v_xor_b32 v2, 0x10000, v2
    s_and_b32 s49, s28, 7
    s_lshl_b32 s49, s49, 18
    s_nop 1
    s_add_u32 s31, s31, 65536
    s_xor_b32 s30, s30, 0x10000
    v_cvt_pk_bf16_f32 v124, v24, v25
    v_cvt_pk_bf16_f32 v125, v26, v27
    v_cvt_pk_bf16_f32 v126, v28, v29
    v_cvt_pk_bf16_f32 v127, v30, v31
    ds_write_b128 v8, v[124:127] offset:4096
    s_cmp_lg_u32 s52, 0
    s_cbranch_scc1 L_q_s2
    s_waitcnt vmcnt(0)
    v_min_u32_dpp v11, v11, v11 quad_perm:[1,0,3,2] row_mask:0xf bank_mask:0xf
    s_nop 1
    v_min_u32_dpp v11, v11, v11 quad_perm:[2,3,0,1] row_mask:0xf bank_mask:0xf
    s_nop 0
    v_readfirstlane_b32 s58, v11
    s_nop 3
    s_cmp_gt_u32 s58, s28
    s_cbranch_scc0 L_q_s2
    s_mov_b32 s52, 2
    s_add_u32 s55, s28, 0
    s_and_b32 s34, s55, 1
    s_lshl_b32 s34, s34, 12
    s_add_u32 m0, s34, 155648
    s_lshl_b32 s55, s55, 17
    buffer_load_dwordx4 v13, s[4:7], s55 offen sc1 lds
    buffer_load_dwordx4 v13, s[4:7], s55 offen offset:1024 sc1 lds
    s_add_u32 m0, m0, s66
    s_add_u32 s55, s55, s66
    buffer_load_dwordx4 v13, s[4:7], s55 offen offset:2048 sc1 lds
L_q_s2:
    s_waitcnt lgkmcnt(0)
    s_barrier
    ds_read_b128 v[16:19], v3 offset:0
    ds_read_b128 v[20:23], v3 offset:1024
    ds_read_b128 v[24:27], v3 offset:2048
    ds_read_b128 v[28:31], v3 offset:3072
    ds_read_b128 v[120:123], v4 offset:3072
    ds_read_b128 v[124:127], v4 offset:7168
    ds_read_b128 v[40:43], v33 offset:0
    ds_read_b128 v[44:47], v33 offset:512
    ds_read_b128 v[48:51], v33 offset:1024
    ds_read_b128 v[52:55], v33 offset:1536
    ds_read_b64_tr_b16 v[112:113], v32 offset:0
    ds_read_b64_tr_b16 v[114:115], v32 offset:256
    ds_read_b64_tr_b16 v[116:117], v32 offset:512
    ds_read_b64_tr_b16 v[118:119], v32 offset:768
    s_add_u32 s53, s28, 1
    s_lshl_b32 s53, s53, 19
    s_cmp_eq_u32 s28, 63
    s_cselect_b32 s53, 2146435056, s53
    s_mov_b32 m0, s50
    s_xor_b32 s50, s50, 0x4000
    buffer_load_dwordx4 v12, s[4:7], s53 offen offset:0 sc1 lds
    s_waitcnt lgkmcnt(13)
    v_mfma_f32_16x16x32_bf16 v[56:59], v[56:59], v[16:19], v[80:83]
    v_mfma_f32_16x16x32_bf16 v[60:63], v[60:63], v[16:19], v[84:87]
    buffer_load_dwordx4 v12, s[4:7], s53 offen offset:1024 sc1 lds
    s_waitcnt lgkmcnt(12)
    v_mfma_f32_16x16x32_bf16 v[56:59], v[64:67], v[20:23], v[56:59]
    v_mfma_f32_16x16x32_bf16 v[60:63], v[68:71], v[20:23], v[60:63]
    buffer_load_dwordx4 v12, s[4:7], s53 offen offset:2048 sc1 lds
    s_waitcnt lgkmcnt(11)
    v_mfma_f32_16x16x32_bf16 v[56:59], v[72:75], v[24:27], v[56:59]
    v_mfma_f32_16x16x32_bf16 v[60:63], v[76:79], v[24:27], v[60:63]
    buffer_load_dwordx4 v12, s[4:7], s53 offen offset:3072 sc1 lds
    s_waitcnt lgkmcnt(8)
    v_mfma_f32_16x16x32_bf16 v[56:59], v[120:123], v[28:31], v[56:59]
    v_mfma_f32_16x16x32_bf16 v[60:63], v[124:127], v[28:31], v[60:63]
    s_cmp_eq_u32 s52, 1
    s_cbranch_scc1 L_q_e
    s_cmp_eq_u32 s52, 2
    s_cbranch_scc1 L_q_e2
    s_add_u32 s32, s28, 1
    s_waitcnt vmcnt(4)
    v_min_u32_dpp v11, v11, v11 quad_perm:[1,0,3,2] row_mask:0xf bank_mask:0xf
    s_nop 1
    v_min_u32_dpp v11, v11, v11 quad_perm:[2,3,0,1] row_mask:0xf bank_mask:0xf
    s_nop 0
    v_readfirstlane_b32 s58, v11
    s_nop 3
    s_cmp_ge_i32 s58, s32
    s_cbranch_scc1 PD_26
    s_mov_b32 s48, 400000
PW_25:
    s_mov_b64 exec, 0xf
    buffer_load_dword v11, v0, s[4:7], s68 offen sc1
    s_mov_b64 exec, -1
    s_sub_u32 s48, s48, 1
    s_cbranch_scc1 L_abort
    s_waitcnt vmcnt(0)
    v_min_u32_dpp v11, v11, v11 quad_perm:[1,0,3,2] row_mask:0xf bank_mask:0xf
    s_nop 1
    v_min_u32_dpp v11, v11, v11 quad_perm:[2,3,0,1] row_mask:0xf bank_mask:0xf
    s_nop 0
    v_readfirstlane_b32 s58, v11
    s_nop 3
    s_cmp_ge_i32 s58, s32
    s_cbranch_scc1 PD_26
    s_sleep 2
    s_branch PW_25
PD_26:
    s_add_u32 s55, s28, 0
    s_and_b32 s34, s55, 1
    s_lshl_b32 s34, s34, 12
    s_add_u32 m0, s34, 155648
    s_lshl_b32 s55, s55, 17
    buffer_load_dwordx4 v13, s[4:7], s55 offen sc1 lds
    buffer_load_dwordx4 v13, s[4:7], s55 offen offset:1024 sc1 lds
    s_add_u32 m0, m0, s66
    s_add_u32 s55, s55, s66
    buffer_load_dwordx4 v13, s[4:7], s55 offen offset:2048 sc1 lds
    s_waitcnt vmcnt(0)
L_q_e2:
    s_waitcnt vmcnt(4) lgkmcnt(0)
    ds_read_b128 v[40:43], v33 offset:0
    ds_read_b128 v[44:47], v33 offset:512
    ds_read_b128 v[48:51], v33 offset:1024
    ds_read_b128 v[52:55], v33 offset:1536
    ds_read_b64_tr_b16 v[112:113], v32 offset:0
    ds_read_b64_tr_b16 v[114:115], v32 offset:256
    ds_read_b64_tr_b16 v[116:117], v32 offset:512
    ds_read_b64_tr_b16 v[118:119], v32 offset:768
L_q_e:
    s_waitcnt lgkmcnt(7)
    v_mfma_f32_16x16x32_bf16 v[64:67], v[40:43], v[16:19], 0
    s_waitcnt lgkmcnt(6)
    v_mfma_f32_16x16x32_bf16 v[64:67], v[44:47], v[20:23], v[64:67]
    s_waitcnt lgkmcnt(5)
    v_mfma_f32_16x16x32_bf16 v[64:67], v[48:51], v[24:27], v[64:67]
    s_waitcnt lgkmcnt(4)
    v_mfma_f32_16x16x32_bf16 v[64:67], v[52:55], v[28:31], v[64:67]
    s_setprio 0
    s_nop 1
    s_add_u32 s32, s28, 1
    s_cmp_gt_u32 s58, s32
    s_cselect_b32 s52, 1, 0
    s_cbranch_scc0 QY_27
    s_add_u32 s55, s28, 1
    s_and_b32 s34, s55, 1
    s_lshl_b32 s34, s34, 12
    s_add_u32 m0, s34, 155648
    s_lshl_b32 s55, s55, 17
    buffer_load_dwordx4 v13, s[4:7], s55 offen sc1 lds
    buffer_load_dwordx4 v13, s[4:7], s55 offen offset:1024 sc1 lds
    s_add_u32 m0, m0, s66
    s_add_u32 s55, s55, s66
    buffer_load_dwordx4 v13, s[4:7], s55 offen offset:2048 sc1 lds
QY_27:
    v_max3_f32 v40, v56, v57, v58
    v_max3_f32 v40, v40, v59, v60
    v_max3_f32 v40, v40, v61, v62
    v_max3_f32 v40, v40, v63, v64
    v_max_f32 v41, v40, v65
    v_max_f32 v40, v40, v65
    v_xor_b32 v4, 0x4000, v4
    v_xor_b32 v15, 0x4000, v15
    v_permlane16_swap_b32 v40, v41
    v_max_f32 v42, v40, v41
    v_max_f32 v43, v40, v41
    v_xor_b32 v33, 0x1000, v33
    v_xor_b32 v32, 0x1000, v32
    v_permlane32_swap_b32 v42, v43
    v_max_f32 v40, v42, v43
    v_mul_f32 v40, s54, v40
    s_add_u32 m0, s30, 6144
    s_add_u32 s34, s31, 32896
    buffer_load_dwordx4 v5, s[12:15], s34 offen lds
    v_fma_f32 v56, v56, s54, -v40
    v_fma_f32 v57, v57, s54, -v40
    v_fma_f32 v58, v58, s54, -v40
    v_fma_f32 v59, v59, s54, -v40
    v_fma_f32 v60, v60, s54, -v40
    v_fma_f32 v61, v61, s54, -v40
    v_fma_f32 v62, v62, s54, -v40
    v_fma_f32 v63, v63, s54, -v40
    v_fma_f32 v64, v64, s54, -v40
    v_fma_f32 v65, v65, s54, -v40
    s_add_u32 m0, s30, 7168
    s_add_u32 s34, s31, 49280
    buffer_load_dwordx4 v6, s[12:15], s34 offen lds
    v_exp_f32 v56, v56
    v_exp_f32 v57, v57
    v_exp_f32 v58, v58
    v_exp_f32 v59, v59
    v_exp_f32 v60, v60
    v_exp_f32 v61, v61
    v_exp_f32 v62, v62
    v_exp_f32 v63, v63
    v_exp_f32 v64, v64
    v_exp_f32 v65, v65
    v_cvt_pk_bf16_f32 v44, v56, v57
    v_cvt_pk_bf16_f32 v45, v58, v59
    v_cvt_pk_bf16_f32 v46, v60, v61
    v_cvt_pk_bf16_f32 v47, v62, v63
    v_cvt_pk_bf16_f32 v92, v64, v65
    s_setprio 3
    s_waitcnt lgkmcnt(0)
    v_mfma_f32_16x16x32_bf16 v[48:51], v[88:91], v[44:47], 0
    v_mfma_f32_16x16x32_bf16 v[48:51], v[88:91], v[92:95], v[48:51]
    v_mfma_f32_16x16x32_bf16 v[16:19], v[96:99], v[44:47], 0
    v_mfma_f32_16x16x32_bf16 v[16:19], v[112:115], v[92:95], v[16:19]
    v_mfma_f32_16x16x32_bf16 v[20:23], v[100:103], v[44:47], 0
    v_mfma_f32_16x16x32_bf16 v[20:23], v[114:117], v[92:95], v[20:23]
    v_mfma_f32_16x16x32_bf16 v[24:27], v[104:107], v[44:47], 0
    v_mfma_f32_16x16x32_bf16 v[24:27], v[116:119], v[92:95], v[24:27]
    v_mfma_f32_16x16x32_bf16 v[28:31], v[108:111], v[44:47], 0
    v_mfma_f32_16x16x32_bf16 v[28:31], v[118:121], v[92:95], v[28:31]
    v_rcp_f32 v40, v48
    s_setprio 0
    v_mul_f32 v16, v16, v40
    v_mul_f32 v17, v17, v40
    v_mul_f32 v18, v18, v40
    v_mul_f32 v19, v19, v40
    v_mul_f32 v20, v20, v40
    v_mul_f32 v21, v21, v40
    v_mul_f32 v22, v22, v40
    v_mul_f32 v23, v23, v40
    v_cvt_pk_bf16_f32 v120, v16, v17
    v_cvt_pk_bf16_f32 v121, v18, v19
    v_cvt_pk_bf16_f32 v122, v20, v21
    v_cvt_pk_bf16_f32 v123, v22, v23
    v_mul_f32 v24, v24, v40
    v_mul_f32 v25, v25, v40
    v_mul_f32 v26, v26, v40
    v_mul_f32 v27, v27, v40
    v_mul_f32 v28, v28, v40
    v_mul_f32 v29, v29, v40
    v_mul_f32 v30, v30, v40
    v_mul_f32 v31, v31, v40
    v_cvt_pk_bf16_f32 v124, v24, v25
    v_cvt_pk_bf16_f32 v125, v26, v27
    v_cvt_pk_bf16_f32 v126, v28, v29
    v_cvt_pk_bf16_f32 v127, v30, v31
    s_sub_u32 s32, s28, 7
    s_cmp_ge_i32 s59, s32
    s_cbranch_scc1 L_q_r1
    s_mov_b32 s48, 400000
L_q_r0:
    s_mov_b64 exec, 0xff
    buffer_load_dword v35, v34, s[4:7], s69 offen sc1
    s_mov_b64 exec, -1
    s_sub_u32 s48, s48, 1
    s_cbranch_scc1 L_abort
    s_waitcnt vmcnt(0)
    v_min_u32_dpp v35, v35, v35 quad_perm:[1,0,3,2] row_mask:0xf bank_mask:0xf
    s_nop 1
    v_min_u32_dpp v35, v35, v35 quad_perm:[2,3,0,1] row_mask:0xf bank_mask:0xf
    s_nop 1
    v_min_u32_dpp v35, v35, v35 row_half_mirror row_mask:0xf bank_mask:0xf
    s_nop 1
    v_readfirstlane_b32 s59, v35
    s_nop 3
    s_cmp_lt_i32 s59, s32
    s_cbranch_scc1 L_q_r0
L_q_r1:
    s_cmp_lg_u32 s27, 0
    s_cbranch_scc1 L_q_far
    buffer_store_dwordx4 v[120:123], v9, s[4:7], s49 offen offset:0
    buffer_store_dwordx4 v[124:127], v9, s[4:7], s49 offen offset:1024
L_q_st:
    s_waitcnt vmcnt(2)
    v_min_u32_dpp v11, v11, v11 quad_perm:[1,0,3,2] row_mask:0xf bank_mask:0xf
    s_nop 1
    v_min_u32_dpp v11, v11, v11 quad_perm:[2,3,0,1] row_mask:0xf bank_mask:0xf
    s_nop 0
    v_readfirstlane_b32 s58, v11
    s_nop 3
    v_min_u32_dpp v35, v35, v35 quad_perm:[1,0,3,2] row_mask:0xf bank_mask:0xf
    s_nop 1
    v_min_u32_dpp v35, v35, v35 quad_perm:[2,3,0,1] row_mask:0xf bank_mask:0xf
    s_nop 1
    v_min_u32_dpp v35, v35, v35 row_half_mirror row_mask:0xf bank_mask:0xf
    s_nop 1
    v_readfirstlane_b32 s59, v35
    s_nop 3
    s_waitcnt vmcnt(0)
    s_add_u32 s28, s28, 1
    s_cmp_lt_u32 s28, 64
    s_cbranch_scc1 L_q_x
    s_waitcnt vmcnt(0)
    s_barrier
    s_branch L_done
L_q_far:
    buffer_store_dwordx4 v[120:123], v9, s[4:7], s49 offen offset:0 sc1
    buffer_store_dwordx4 v[124:127], v9, s[4:7], s49 offen offset:1024 sc1
    s_branch L_q_st
L_o:
    v_and_b32 v40, 63, v0
    v_mov_b32 v10, 0
    s_and_b32 s60, s24, 3
    s_lshr_b32 s61, s24, 2
    s_bfe_u32 s47, s25, 0x20000
    s_mul_i32 s62, s47, 1
    s_bfe_u32 s47, s26, 0x30000
    s_mul_i32 s47, s47, 4
    s_add_u32 s62, s62, s47
    s_mul_i32 s51, s62, 128
    s_add_u32 s51, s51, 98615296
    s_lshr_b32 s47, s62, 2
    s_mul_i32 s32, s47, 65536
    s_mul_i32 s47, s60, 16384
    s_add_u32 s32, s32, s47
    s_bfe_u32 s47, s62, 0x20000
    s_mul_i32 s47, s47, 4096
    s_add_u32 s32, s32, s47
    s_mul_i32 s47, s61, 2048
    s_add_u32 s32, s32, s47
    s_add_u32 s32, s32, 95944704
    v_lshlrev_b32 v9, 4, v40
    v_add_u32 v9, s32, v9
    v_mov_b32 v16, -1
    v_mov_b32 v17, -1
    v_mov_b32 v18, -1
    v_mov_b32 v19, -1
    buffer_store_dwordx4 v[16:19], v9, s[4:7], 0 offen sc1
    buffer_store_dwordx4 v[16:19], v9, s[4:7], 0 offen offset:1024 sc1
    s_waitcnt vmcnt(0)
    s_mul_i32 s3, s25, 128
    s_add_u32 s3, s3, 98568192
    s_cmp_lg_u32 s24, 0
    s_cbranch_scc1 GC_28
    s_mov_b64 exec, 1
    buffer_store_dword v10, v10, s[4:7], s3 offen sc1
    buffer_store_dword v10, v10, s[4:7], s51 offen offset:0 sc1
    s_mov_b64 exec, -1
GC_28:
    s_bfe_u32 s47, s24, 0x20000
    s_mul_i32 s36, s47, 1
    s_bfe_u32 s47, s62, 0x10002
    s_mul_i32 s47, s47, 4
    s_add_u32 s36, s36, s47
    s_mul_i32 s37, s36, 2097152
    s_mul_i32 s47, s62, 256
    s_add_u32 s37, s37, s47
    s_add_u32 s37, s37, 102498304
    v_bfe_u32 v41, v40, 5, 1
    v_lshlrev_b32 v76, 13, v41
    v_and_b32 v41, 31, v40
    v_lshl_add_u32 v76, v41, 3, v76
    s_cmp_ge_u32 s24, 4
    s_cbranch_scc1 PS_29
    v_mov_b32 v72, -1
    v_mov_b32 v73, -1
    buffer_store_dwordx2 v[72:73], v76, s[4:7], s37 offen sc1
PS_29:
    s_barrier
    s_waitcnt vmcnt(0)
    s_cmp_lt_u32 s24, 4
    s_cbranch_scc1 WP_30
    s_cmp_eq_u32 s62, 0
    s_cbranch_scc1 WP_30
    s_load_dwordx4 s[64:67], s[0:1], 16
    s_load_dwordx4 s[68:71], s[0:1], 32
    s_bfe_u32 s47, s26, 0x20002
    s_mul_i32 s32, s47, 2097152
    s_bfe_u32 s47, s26, 0x20000
    s_mul_i32 s47, s47, 131072
    s_add_u32 s32, s32, s47
    s_bfe_u32 s47, s24, 0x20000
    s_mul_i32 s47, s47, 32768
    s_add_u32 s32, s32, s47
    s_bfe_u32 s47, s25, 0x20000
    s_mul_i32 s47, s47, 2048
    s_add_u32 s32, s32, s47
    v_bfe_u32 v41, v40, 4, 2
    v_lshlrev_b32 v77, 13, v41
    v_and_b32 v41, 15, v40
    v_lshl_add_u32 v77, v41, 7, v77
    v_add_u32 v77, s32, v77
    s_bfe_u32 s47, s26, 0x40000
    s_mul_i32 s32, s47, 32768
    s_bfe_u32 s47, s24, 0x20000
    s_mul_i32 s47, s47, 8192
    s_add_u32 s32, s32, s47
    s_bfe_u32 s47, s25, 0x20000
    s_mul_i32 s47, s47, 2097152
    s_add_u32 s32, s32, s47
    v_lshlrev_b32 v78, 7, v40
    v_add_u32 v78, s32, v78
    s_waitcnt lgkmcnt(0)
    s_mov_b32 s8, s66
    s_and_b32 s9, s67, 0xffff
    s_mov_b32 s10, 8388608
    s_mov_b32 s11, 0x20000
    s_mov_b32 s12, s68
    s_and_b32 s13, s69, 0xffff
    s_mov_b32 s14, 8388608
    s_mov_b32 s15, 0x20000
    s_mov_b32 s32, 0
    buffer_load_dword v79, v77, s[8:11], s32 offen
    s_mov_b32 s32, 0
    buffer_load_dword v79, v77, s[12:15], s32 offen
    s_mov_b32 s32, 524288
    buffer_load_dword v79, v77, s[8:11], s32 offen
    s_mov_b32 s32, 524288
    buffer_load_dword v79, v77, s[12:15], s32 offen
    s_mov_b32 s32, 1048576
    buffer_load_dword v79, v77, s[8:11], s32 offen
    s_mov_b32 s32, 1048576
    buffer_load_dword v79, v77, s[12:15], s32 offen
    s_mov_b32 s32, 1572864
    buffer_load_dword v79, v77, s[8:11], s32 offen
    s_mov_b32 s32, 1572864
    buffer_load_dword v79, v77, s[12:15], s32 offen
    s_mov_b32 s8, s64
    s_and_b32 s9, s65, 0xffff
    s_mov_b32 s10, 8388608
    s_mov_b32 s11, 0x20000
    s_mov_b32 s12, s70
    s_and_b32 s13, s71, 0xffff
    s_mov_b32 s14, 8388608
    s_mov_b32 s15, 0x20000
    s_mov_b32 s32, 0
    buffer_load_dword v79, v77, s[8:11], s32 offen
    s_mov_b32 s32, 524288
    buffer_load_dword v79, v77, s[8:11], s32 offen
    s_mov_b32 s32, 1048576
    buffer_load_dword v79, v77, s[8:11], s32 offen
    s_mov_b32 s32, 1572864
    buffer_load_dword v79, v77, s[8:11], s32 offen
WP_30:
    s_cmp_ge_u32 s24, 4
    s_cbranch_scc1 PS_31
    s_mov_b64 s[38:39], 0
    s_setprio 3
    s_mov_b32 s33, 0
PO_33:
    s_bfe_u32 s47, s33, 0x10000
    s_mul_i32 s32, s47, 8192
    s_lshr_b32 s47, s33, 1
    s_mul_i32 s47, s47, 64
    s_add_u32 s32, s32, s47
    s_mul_i32 s47, s37, 1
    s_add_u32 s32, s32, s47
    s_mov_b32 s34, 0
    s_mov_b32 s35, 0xffff
    s_buffer_load_dword s34, s[4:7], s32
PL_32:
    s_sub_u32 s35, s35, 1
    s_cmp_lt_u32 s34, s35
    s_cbranch_scc1 PL_32
    s_waitcnt lgkmcnt(0)
    s_max_u32 s35, s38, s35
    s_mov_b32 s38, s39
    s_mov_b32 s39, s35
    s_add_u32 s33, s33, 1
    s_cmp_lt_u32 s33, 8
    s_cbranch_scc1 PO_33
    s_setprio 0
    s_mul_i32 s32, s36, 32
    s_add_u32 s32, s32, 16
    s_add_u32 s33, s32, 4
    s_atomic_umax s38, s[20:21], s32 glc
    s_atomic_umax s39, s[20:21], s33 glc
    s_waitcnt lgkmcnt(0)
    v_mov_b32 v72, 1
    v_mov_b32 v41, 163832
    s_mov_b64 exec, 1
    ds_add_rtn_u32 v72, v41, v72
    s_waitcnt lgkmcnt(0)
    v_readfirstlane_b32 s32, v72
    s_mov_b64 exec, -1
    s_nop 2
    s_cmp_lg_u32 s32, 3
    s_cbranch_scc1 PS_31
    s_mov_b32 s72, 1
    s_atomic_add s72, s[20:21], 4
    s_cmp_lg_u32 s62, 0
    s_cbranch_scc1 PS_31
    s_waitcnt lgkmcnt(0)
    s_mov_b32 s48, 400000
IM_34:
    s_mov_b32 s72, 0
    s_atomic_add s72, s[20:21], 4 glc
    s_sub_u32 s48, s48, 1
    s_cbranch_scc1 L_abort
    s_waitcnt lgkmcnt(0)
    s_cmp_lt_u32 s72, 256
    s_cbranch_scc1 IM_34
    v_mbcnt_lo_u32_b32 v73, -1, 0
    v_mbcnt_hi_u32_b32 v73, -1, v73
    v_lshlrev_b32 v73, 2, v73
    buffer_load_dword v72, v73, s[20:23], 0 offen sc1
    s_waitcnt vmcnt(0)
    v_readlane_b32 s72, v72, 2
    s_nop 3
    s_cmp_lg_u32 s72, 0
    s_cselect_b32 s29, 0x300, 0
    s_or_b32 s29, s29, 0x200
    v_readlane_b32 s72, v72, 4
    v_readlane_b32 s73, v72, 5
    s_nop 3
    s_cmp_gt_u32 s72, s73
    s_cselect_b32 s72, 1, 0
    s_or_b32 s29, s29, s72
    v_readlane_b32 s72, v72, 12
    v_readlane_b32 s73, v72, 13
    s_nop 3
    s_cmp_gt_u32 s72, s73
    s_cselect_b32 s72, 2, 0
    s_or_b32 s29, s29, s72
    v_readlane_b32 s72, v72, 20
    v_readlane_b32 s73, v72, 21
    s_nop 3
    s_cmp_gt_u32 s72, s73
    s_cselect_b32 s72, 4, 0
    s_or_b32 s29, s29, s72
    v_readlane_b32 s72, v72, 28
    v_readlane_b32 s73, v72, 29
    s_nop 3
    s_cmp_gt_u32 s72, s73
    s_cselect_b32 s72, 8, 0
    s_or_b32 s29, s29, s72
    v_readlane_b32 s72, v72, 36
    v_readlane_b32 s73, v72, 37
    s_nop 3
    s_cmp_gt_u32 s72, s73
    s_cselect_b32 s72, 16, 0
    s_or_b32 s29, s29, s72
    v_readlane_b32 s72, v72, 44
    v_readlane_b32 s73, v72, 45
    s_nop 3
    s_cmp_gt_u32 s72, s73
    s_cselect_b32 s72, 32, 0
    s_or_b32 s29, s29, s72
    v_readlane_b32 s72, v72, 52
    v_readlane_b32 s73, v72, 53
    s_nop 3
    s_cmp_gt_u32 s72, s73
    s_cselect_b32 s72, 64, 0
    s_or_b32 s29, s29, s72
    v_readlane_b32 s72, v72, 60
    v_readlane_b32 s73, v72, 61
    s_nop 3
    s_cmp_gt_u32 s72, s73
    s_cselect_b32 s72, 128, 0
    s_or_b32 s29, s29, s72
    v_lshlrev_b32 v73, 5, v73
    v_mov_b32 v72, s29
    s_mov_b32 s72, 98568192
    s_mov_b64 exec, 0xff
    buffer_store_dword v72, v73, s[4:7], s72 offen sc1
    s_mov_b64 exec, -1
PS_31:
    s_barrier
    s_mov_b32 s48, 400000
WI_35:
    buffer_load_dword v11, v10, s[4:7], s3 offen sc1
    s_sub_u32 s48, s48, 1
    s_cbranch_scc1 L_abort
    s_waitcnt vmcnt(0)
    v_readfirstlane_b32 s29, v11
    s_nop 3
    s_cmp_lg_u32 s29, 0
    s_cbranch_scc1 WE_36
    s_sleep 8
    s_branch WI_35
WE_36:
    s_bfe_u32 s27, s29, 0x10008
    s_load_dwordx2 s[40:41], s[0:1], 40
    s_waitcnt lgkmcnt(0)
    s_mul_i32 s32, s61, 1048576
    s_bfe_u32 s47, s62, 0x20000
    s_mul_i32 s47, s47, 2097152
    s_add_u32 s32, s32, s47
    s_lshr_b32 s47, s62, 2
    s_mul_i32 s47, s47, 256
    s_add_u32 s32, s32, s47
    s_mul_i32 s47, s60, 65536
    s_add_u32 s32, s32, s47
    s_mov_b32 s8, s40
    s_and_b32 s9, s41, 0xffff
    s_mov_b32 s10, 8388608
    s_mov_b32 s11, 0x20000
    v_lshrrev_b32 v42, 4, v40
    v_lshlrev_b32 v42, 2, v42
    v_xor_b32 v45, v42, v40
    v_bfe_u32 v41, v40, 4, 2
    v_lshlrev_b32 v42, 11, v41
    v_and_b32 v41, 15, v45
    v_lshl_add_u32 v42, v41, 4, v42
    v_add_u32 v42, s32, v42
    v_bfe_u32 v41, v40, 2, 2
    v_xor_b32 v46, s60, v41
    s_mul_i32 s32, s61, 32768
    v_bfe_u32 v41, v40, 4, 2
    v_lshlrev_b32 v45, 10, v41
    v_bfe_u32 v41, v40, 2, 2
    v_lshl_add_u32 v45, v41, 8, v45
    v_lshl_add_u32 v45, v46, 6, v45
    v_and_b32 v41, 3, v40
    v_lshl_add_u32 v45, v41, 4, v45
    v_add_u32 v45, s32, v45
    s_lshl_b32 s56, s24, 13
    s_load_dwordx2 s[42:43], s[0:1], 0
    s_mul_i32 s32, s62, 8192
    s_mul_i32 s47, s24, 262144
    s_add_u32 s32, s32, s47
    v_lshlrev_b32 v73, 7, v40
    v_add_u32 v73, s32, v73
    s_waitcnt lgkmcnt(0)
    s_mov_b32 s16, s42
    s_and_b32 s17, s43, 0xffff
    s_mov_b32 s18, 4194304
    s_mov_b32 s19, 0x20000
    buffer_load_dword v72, v73, s[16:19], 0 offen
    s_mov_b32 s32, 2097152
    buffer_load_dword v72, v73, s[16:19], s32 offen
    s_add_u32 m0, s56, 0
    s_mov_b32 s40, 0
    buffer_load_dwordx4 v42, s[8:11], s40 offen nt lds
    s_add_u32 m0, s56, 1024
    s_mov_b32 s40, 8192
    buffer_load_dwordx4 v42, s[8:11], s40 offen nt lds
    s_add_u32 m0, s56, 2048
    s_mov_b32 s40, 16384
    buffer_load_dwordx4 v42, s[8:11], s40 offen nt lds
    s_add_u32 m0, s56, 3072
    s_mov_b32 s40, 24576
    buffer_load_dwordx4 v42, s[8:11], s40 offen nt lds
    s_add_u32 m0, s56, 4096
    s_mov_b32 s40, 32768
    buffer_load_dwordx4 v42, s[8:11], s40 offen nt lds
    s_add_u32 m0, s56, 5120
    s_mov_b32 s40, 40960
    buffer_load_dwordx4 v42, s[8:11], s40 offen nt lds
    s_add_u32 m0, s56, 6144
    s_mov_b32 s40, 49152
    buffer_load_dwordx4 v42, s[8:11], s40 offen nt lds
    s_add_u32 m0, s56, 7168
    s_mov_b32 s40, 57344
    buffer_load_dwordx4 v42, s[8:11], s40 offen nt lds
    s_add_u32 m0, s56, 65536
    s_mov_b32 s40, 262144
    buffer_load_dwordx4 v42, s[8:11], s40 offen nt lds
    s_add_u32 m0, s56, 66560
    s_mov_b32 s40, 270336
    buffer_load_dwordx4 v42, s[8:11], s40 offen nt lds
    s_add_u32 m0, s56, 67584
    s_mov_b32 s40, 278528
    buffer_load_dwordx4 v42, s[8:11], s40 offen nt lds
    s_add_u32 m0, s56, 68608
    s_mov_b32 s40, 286720
    buffer_load_dwordx4 v42, s[8:11], s40 offen nt lds
    s_add_u32 m0, s56, 69632
    s_mov_b32 s40, 294912
    buffer_load_dwordx4 v42, s[8:11], s40 offen nt lds
    s_add_u32 m0, s56, 70656
    s_mov_b32 s40, 303104
    buffer_load_dwordx4 v42, s[8:11], s40 offen nt lds
    s_add_u32 m0, s56, 71680
    s_mov_b32 s40, 311296
    buffer_load_dwordx4 v42, s[8:11], s40 offen nt lds
    s_add_u32 m0, s56, 72704
    s_mov_b32 s40, 319488
    buffer_load_dwordx4 v42, s[8:11], s40 offen nt lds
    s_load_dwordx2 s[42:43], s[0:1], 104
    s_mul_i32 s32, s61, 32768
    v_lshlrev_b32 v1, 4, v40
    v_add_u32 v1, s32, v1
    v_mov_b32 v2, 0
    s_lshl_b32 s30, s60, 13
    s_mov_b32 s31, 0
    s_bfe_u32 s47, s62, 0x20000
    s_mul_i32 s32, s47, 65536
    s_mul_i32 s47, s60, 8192
    s_add_u32 s32, s32, s47
    s_add_u32 s32, s32, 46137344
    v_lshlrev_b32 v5, 4, v40
    v_add_u32 v5, s32, v5
    s_waitcnt lgkmcnt(0)
    s_mov_b32 s12, s42
    s_and_b32 s13, s43, 0xffff
    s_mov_b32 s14, 8388608
    s_mov_b32 s15, 0x20000
    s_mul_i32 s32, s60, 4096
    s_add_u32 s32, s32, 131072
    v_lshlrev_b32 v7, 4, v40
    v_add_u32 v7, s32, v7
    v_xor_b32 v8, 0x2000, v7
    v_and_b32 v41, 3, v40
    v_lshlrev_b32 v0, 7, v41
    s_lshr_b32 s47, s62, 2
    s_mul_i32 s32, s47, 65536
    s_mul_i32 s47, s60, 16384
    s_add_u32 s32, s32, s47
    s_bfe_u32 s47, s62, 0x20000
    s_mul_i32 s47, s47, 4096
    s_add_u32 s32, s32, s47
    s_add_u32 s32, s32, 62914560
    v_lshlrev_b32 v9, 4, v40
    v_add_u32 v9, s32, v9
    s_mul_i32 s32, s62, 16384
    s_bfe_u32 s47, s24, 0x10000
    s_mul_i32 s47, s47, 2048
    s_add_u32 s32, s32, s47
    s_add_u32 s32, s32, 62914560
    v_lshlrev_b32 v12, 4, v40
    v_add_u32 v12, s32, v12
    s_bfe_u32 s47, s24, 0x10000
    s_mul_i32 s32, s47, 65536
    s_mul_i32 s47, s62, 64
    s_add_u32 s32, s32, s47
    v_and_b32 v41, 15, v40
    v_lshlrev_b32 v13, 12, v41
    v_bfe_u32 v41, v40, 4, 2
    v_lshl_add_u32 v13, v41, 4, v13
    v_add_u32 v13, s32, v13
    s_bfe_u32 s47, s62, 0x20000
    s_mul_i32 s32, s47, 65536
    s_lshr_b32 s47, s62, 2
    s_mul_i32 s47, s47, 8192
    s_add_u32 s32, s32, s47
    s_mul_i32 s47, s24, 262144
    s_add_u32 s32, s32, s47
    s_add_u32 s32, s32, 46137344
    v_lshlrev_b32 v14, 7, v40
    v_add_u32 v14, s32, v14
    buffer_load_dword v32, v14, s[4:7], 0 offen sc1
    s_bfe_u32 s47, s62, 0x20000
    s_mul_i32 s68, s47, 1024
    s_add_u32 s68, s68, 98598912
    s_lshr_b32 s47, s62, 2
    s_mul_i32 s69, s47, 512
    s_add_u32 s69, s69, 98615296
    s_mul_i32 s32, s60, 128
    v_and_b32 v41, 1, v40
    v_lshlrev_b32 v15, 9, v41
    v_add_u32 v15, s32, v15
    s_mov_b32 s58, 0
    s_mov_b32 s28, 0
    s_waitcnt vmcnt(8)
    s_barrier
    ds_read_b64_tr_b16 v[128:129], v45 offset:0
    ds_read_b64_tr_b16 v[130:131], v45 offset:4096
    ds_read_b64_tr_b16 v[132:133], v45 offset:8
    ds_read_b64_tr_b16 v[134:135], v45 offset:4104
    ds_read_b64_tr_b16 v[136:137], v45 offset:8192
    ds_read_b64_tr_b16 v[138:139], v45 offset:12288
    ds_read_b64_tr_b16 v[140:141], v45 offset:8200
    ds_read_b64_tr_b16 v[142:143], v45 offset:12296
    ds_read_b64_tr_b16 v[144:145], v45 offset:16384
    ds_read_b64_tr_b16 v[146:147], v45 offset:20480
    ds_read_b64_tr_b16 v[148:149], v45 offset:16392
    ds_read_b64_tr_b16 v[150:151], v45 offset:20488
    ds_read_b64_tr_b16 v[152:153], v45 offset:24576
    ds_read_b64_tr_b16 v[154:155], v45 offset:28672
    ds_read_b64_tr_b16 v[156:157], v45 offset:24584
    ds_read_b64_tr_b16 v[158:159], v45 offset:28680
    v_xor_b32 v45, 0x10000, v45
    s_waitcnt lgkmcnt(0)
    s_barrier
    s_add_u32 m0, s56, 0
    s_mov_b32 s40, 524288
    buffer_load_dwordx4 v42, s[8:11], s40 offen nt lds
    s_add_u32 m0, s56, 1024
    s_mov_b32 s40, 532480
    buffer_load_dwordx4 v42, s[8:11], s40 offen nt lds
    s_add_u32 m0, s56, 2048
    s_mov_b32 s40, 540672
    buffer_load_dwordx4 v42, s[8:11], s40 offen nt lds
    s_add_u32 m0, s56, 3072
    s_mov_b32 s40, 548864
    buffer_load_dwordx4 v42, s[8:11], s40 offen nt lds
    s_add_u32 m0, s56, 4096
    s_mov_b32 s40, 557056
    buffer_load_dwordx4 v42, s[8:11], s40 offen nt lds
    s_add_u32 m0, s56, 5120
    s_mov_b32 s40, 565248
    buffer_load_dwordx4 v42, s[8:11], s40 offen nt lds
    s_add_u32 m0, s56, 6144
    s_mov_b32 s40, 573440
    buffer_load_dwordx4 v42, s[8:11], s40 offen nt lds
    s_add_u32 m0, s56, 7168
    s_mov_b32 s40, 581632
    buffer_load_dwordx4 v42, s[8:11], s40 offen nt lds
    s_waitcnt vmcnt(8)
    s_barrier
    ds_read_b64_tr_b16 v[160:161], v45 offset:0
    ds_read_b64_tr_b16 v[162:163], v45 offset:4096
    ds_read_b64_tr_b16 v[164:165], v45 offset:8
    ds_read_b64_tr_b16 v[166:167], v45 offset:4104
    ds_read_b64_tr_b16 v[168:169], v45 offset:8192
    ds_read_b64_tr_b16 v[170:171], v45 offset:12288
    ds_read_b64_tr_b16 v[172:173], v45 offset:8200
    ds_read_b64_tr_b16 v[174:175], v45 offset:12296
    ds_read_b64_tr_b16 v[176:177], v45 offset:16384
    ds_read_b64_tr_b16 v[178:179], v45 offset:20480
    ds_read_b64_tr_b16 v[180:181], v45 offset:16392
    ds_read_b64_tr_b16 v[182:183], v45 offset:20488
    ds_read_b64_tr_b16 v[184:185], v45 offset:24576
    ds_read_b64_tr_b16 v[186:187], v45 offset:28672
    ds_read_b64_tr_b16 v[188:189], v45 offset:24584
    ds_read_b64_tr_b16 v[190:191], v45 offset:28680
    v_xor_b32 v45, 0x10000, v45
    s_waitcnt lgkmcnt(0)
    s_barrier
    s_add_u32 m0, s56, 65536
    s_mov_b32 s40, 786432
    buffer_load_dwordx4 v42, s[8:11], s40 offen nt lds
    s_add_u32 m0, s56, 66560
    s_mov_b32 s40, 794624
    buffer_load_dwordx4 v42, s[8:11], s40 offen nt lds
    s_add_u32 m0, s56, 67584
    s_mov_b32 s40, 802816
    buffer_load_dwordx4 v42, s[8:11], s40 offen nt lds
    s_add_u32 m0, s56, 68608
    s_mov_b32 s40, 811008
    buffer_load_dwordx4 v42, s[8:11], s40 offen nt lds
    s_add_u32 m0, s56, 69632
    s_mov_b32 s40, 819200
    buffer_load_dwordx4 v42, s[8:11], s40 offen nt lds
    s_add_u32 m0, s56, 70656
    s_mov_b32 s40, 827392
    buffer_load_dwordx4 v42, s[8:11], s40 offen nt lds
    s_add_u32 m0, s56, 71680
    s_mov_b32 s40, 835584
    buffer_load_dwordx4 v42, s[8:11], s40 offen nt lds
    s_add_u32 m0, s56, 72704
    s_mov_b32 s40, 843776
    buffer_load_dwordx4 v42, s[8:11], s40 offen nt lds
    s_waitcnt vmcnt(8)
    s_barrier
    ds_read_b64_tr_b16 v[192:193], v45 offset:0
    ds_read_b64_tr_b16 v[194:195], v45 offset:4096
    ds_read_b64_tr_b16 v[196:197], v45 offset:8
    ds_read_b64_tr_b16 v[198:199], v45 offset:4104
    ds_read_b64_tr_b16 v[200:201], v45 offset:8192
    ds_read_b64_tr_b16 v[202:203], v45 offset:12288
    ds_read_b64_tr_b16 v[204:205], v45 offset:8200
    ds_read_b64_tr_b16 v[206:207], v45 offset:12296
    ds_read_b64_tr_b16 v[208:209], v45 offset:16384
    ds_read_b64_tr_b16 v[210:211], v45 offset:20480
    ds_read_b64_tr_b16 v[212:213], v45 offset:16392
    ds_read_b64_tr_b16 v[214:215], v45 offset:20488
    ds_read_b64_tr_b16 v[216:217], v45 offset:24576
    ds_read_b64_tr_b16 v[218:219], v45 offset:28672
    ds_read_b64_tr_b16 v[220:221], v45 offset:24584
    ds_read_b64_tr_b16 v[222:223], v45 offset:28680
    v_xor_b32 v45, 0x10000, v45
    s_waitcnt lgkmcnt(0)
    s_barrier
    s_waitcnt vmcnt(0)
    s_barrier
    ds_read_b64_tr_b16 v[224:225], v45 offset:0
    ds_read_b64_tr_b16 v[226:227], v45 offset:4096
    ds_read_b64_tr_b16 v[228:229], v45 offset:8
    ds_read_b64_tr_b16 v[230:231], v45 offset:4104
    ds_read_b64_tr_b16 v[232:233], v45 offset:8192
    ds_read_b64_tr_b16 v[234:235], v45 offset:12288
    ds_read_b64_tr_b16 v[236:237], v45 offset:8200
    ds_read_b64_tr_b16 v[238:239], v45 offset:12296
    ds_read_b64_tr_b16 v[240:241], v45 offset:16384
    ds_read_b64_tr_b16 v[242:243], v45 offset:20480
    ds_read_b64_tr_b16 v[244:245], v45 offset:16392
    ds_read_b64_tr_b16 v[246:247], v45 offset:20488
    ds_read_b64_tr_b16 v[248:249], v45 offset:24576
    ds_read_b64_tr_b16 v[250:251], v45 offset:28672
    ds_read_b64_tr_b16 v[252:253], v45 offset:24584
    ds_read_b64_tr_b16 v[254:255], v45 offset:28680
    v_xor_b32 v45, 0x10000, v45
    s_waitcnt lgkmcnt(0)
    s_barrier
    s_cmp_eq_u32 s61, 0
    s_cbranch_scc1 L_o_x0
L_o_y:
    s_add_u32 s32, s28, 1
    s_cmp_ge_i32 s58, s32
    s_cbranch_scc1 PD_38
    s_mov_b32 s48, 400000
PW_37:
    s_mov_b64 exec, 0xf
    buffer_load_dword v11, v15, s[4:7], s68 offen sc1
    s_mov_b64 exec, -1
    s_sub_u32 s48, s48, 1
    s_cbranch_scc1 L_abort
    s_waitcnt vmcnt(0)
    v_min_u32_dpp v11, v11, v11 quad_perm:[1,0,3,2] row_mask:0xf bank_mask:0xf
    s_nop 1
    v_min_u32_dpp v11, v11, v11 quad_perm:[2,3,0,1] row_mask:0xf bank_mask:0xf
    s_nop 0
    v_readfirstlane_b32 s58, v11
    s_nop 3
    s_cmp_ge_i32 s58, s32
    s_cbranch_scc1 PD_38
    s_sleep 2
    s_branch PW_37
PD_38:
    s_xor_b32 m0, s30, 32768
    s_add_u32 s34, s31, 32768
    buffer_load_dwordx4 v5, s[4:7], s34 offen offset:0 sc1 lds
    buffer_load_dwordx4 v5, s[4:7], s34 offen offset:1024 sc1 lds
    buffer_load_dwordx4 v5, s[4:7], s34 offen offset:2048 sc1 lds
    buffer_load_dwordx4 v5, s[4:7], s34 offen offset:3072 sc1 lds
    s_xor_b32 m0, s30, 36864
    s_add_u32 s34, s31, 36864
    buffer_load_dwordx4 v5, s[4:7], s34 offen offset:0 sc1 lds
    buffer_load_dwordx4 v5, s[4:7], s34 offen offset:1024 sc1 lds
    buffer_load_dwordx4 v5, s[4:7], s34 offen offset:2048 sc1 lds
    buffer_load_dwordx4 v5, s[4:7], s34 offen offset:3072 sc1 lds
    s_xor_b32 m0, s30, 0
    s_add_u32 s34, s31, 0
    buffer_load_dwordx4 v5, s[4:7], s34 offen offset:0 sc1 lds
    buffer_load_dwordx4 v5, s[4:7], s34 offen offset:1024 sc1 lds
    buffer_load_dwordx4 v5, s[4:7], s34 offen offset:2048 sc1 lds
    buffer_load_dwordx4 v5, s[4:7], s34 offen offset:3072 sc1 lds
    s_xor_b32 m0, s30, 4096
    s_add_u32 s34, s31, 4096
    buffer_load_dwordx4 v5, s[4:7], s34 offen offset:0 sc1 lds
    buffer_load_dwordx4 v5, s[4:7], s34 offen offset:1024 sc1 lds
    buffer_load_dwordx4 v5, s[4:7], s34 offen offset:2048 sc1 lds
    buffer_load_dwordx4 v5, s[4:7], s34 offen offset:3072 sc1 lds
    s_waitcnt vmcnt(8)
    s_barrier
    ds_read_b128 v[40:43], v1 offset:0
    ds_read_b128 v[44:47], v1 offset:1024
    ds_read_b128 v[48:51], v1 offset:2048
    ds_read_b128 v[52:55], v1 offset:3072
    ds_read_b128 v[56:59], v1 offset:8192
    ds_read_b128 v[60:63], v1 offset:9216
    ds_read_b128 v[64:67], v1 offset:10240
    s_waitcnt lgkmcnt(6)
    v_mfma_f32_16x16x32_bf16 v[16:19], v[128:131], v[40:43], 0
    ds_read_b128 v[68:71], v1 offset:11264
    v_mfma_f32_16x16x32_bf16 v[20:23], v[132:135], v[40:43], 0
    s_waitcnt lgkmcnt(6)
    v_mfma_f32_16x16x32_bf16 v[16:19], v[136:139], v[44:47], v[16:19]
    ds_read_b128 v[40:43], v1 offset:16384
    v_mfma_f32_16x16x32_bf16 v[20:23], v[140:143], v[44:47], v[20:23]
    s_waitcnt lgkmcnt(6)
    v_mfma_f32_16x16x32_bf16 v[16:19], v[144:147], v[48:51], v[16:19]
    ds_read_b128 v[44:47], v1 offset:17408
    v_mfma_f32_16x16x32_bf16 v[20:23], v[148:151], v[48:51], v[20:23]
    s_waitcnt lgkmcnt(6)
    v_mfma_f32_16x16x32_bf16 v[16:19], v[152:155], v[52:55], v[16:19]
    ds_read_b128 v[48:51], v1 offset:18432
    v_mfma_f32_16x16x32_bf16 v[20:23], v[156:159], v[52:55], v[20:23]
    s_waitcnt lgkmcnt(6)
    v_mfma_f32_16x16x32_bf16 v[16:19], v[160:163], v[56:59], v[16:19]
    ds_read_b128 v[52:55], v1 offset:19456
    v_mfma_f32_16x16x32_bf16 v[20:23], v[164:167], v[56:59], v[20:23]
    s_waitcnt lgkmcnt(6)
    v_mfma_f32_16x16x32_bf16 v[16:19], v[168:171], v[60:63], v[16:19]
    ds_read_b128 v[56:59], v1 offset:24576
    v_mfma_f32_16x16x32_bf16 v[20:23], v[172:175], v[60:63], v[20:23]
    s_waitcnt lgkmcnt(6)
    v_mfma_f32_16x16x32_bf16 v[16:19], v[176:179], v[64:67], v[16:19]
    ds_read_b128 v[60:63], v1 offset:25600
    v_mfma_f32_16x16x32_bf16 v[20:23], v[180:183], v[64:67], v[20:23]
    s_waitcnt lgkmcnt(6)
    v_mfma_f32_16x16x32_bf16 v[16:19], v[184:187], v[68:71], v[16:19]
    ds_read_b128 v[64:67], v1 offset:26624
    v_mfma_f32_16x16x32_bf16 v[20:23], v[188:191], v[68:71], v[20:23]
    s_waitcnt lgkmcnt(6)
    v_mfma_f32_16x16x32_bf16 v[16:19], v[192:195], v[40:43], v[16:19]
    ds_read_b128 v[68:71], v1 offset:27648
    v_mfma_f32_16x16x32_bf16 v[20:23], v[196:199], v[40:43], v[20:23]
    s_waitcnt lgkmcnt(6)
    v_mfma_f32_16x16x32_bf16 v[16:19], v[200:203], v[44:47], v[16:19]
    ds_read_b128 v[40:43], v1 offset:4096
    v_mfma_f32_16x16x32_bf16 v[20:23], v[204:207], v[44:47], v[20:23]
    s_waitcnt lgkmcnt(6)
    v_mfma_f32_16x16x32_bf16 v[16:19], v[208:211], v[48:51], v[16:19]
    ds_read_b128 v[44:47], v1 offset:5120
    v_mfma_f32_16x16x32_bf16 v[20:23], v[212:215], v[48:51], v[20:23]
    s_waitcnt lgkmcnt(6)
    v_mfma_f32_16x16x32_bf16 v[16:19], v[216:219], v[52:55], v[16:19]
    ds_read_b128 v[48:51], v1 offset:6144
    v_mfma_f32_16x16x32_bf16 v[20:23], v[220:223], v[52:55], v[20:23]
    s_waitcnt lgkmcnt(6)
    v_mfma_f32_16x16x32_bf16 v[16:19], v[224:227], v[56:59], v[16:19]
    ds_read_b128 v[52:55], v1 offset:7168
    v_mfma_f32_16x16x32_bf16 v[20:23], v[228:231], v[56:59], v[20:23]
    s_waitcnt lgkmcnt(6)
    v_mfma_f32_16x16x32_bf16 v[16:19], v[232:235], v[60:63], v[16:19]
    ds_read_b128 v[56:59], v1 offset:12288
    v_mfma_f32_16x16x32_bf16 v[20:23], v[236:239], v[60:63], v[20:23]
    s_waitcnt lgkmcnt(6)
    v_mfma_f32_16x16x32_bf16 v[16:19], v[240:243], v[64:67], v[16:19]
    ds_read_b128 v[60:63], v1 offset:13312
    v_mfma_f32_16x16x32_bf16 v[20:23], v[244:247], v[64:67], v[20:23]
    s_waitcnt lgkmcnt(6)
    v_mfma_f32_16x16x32_bf16 v[16:19], v[248:251], v[68:71], v[16:19]
    ds_read_b128 v[64:67], v1 offset:14336
    v_mfma_f32_16x16x32_bf16 v[20:23], v[252:255], v[68:71], v[20:23]
    s_waitcnt lgkmcnt(6)
    v_mfma_f32_16x16x32_bf16 v[24:27], v[128:131], v[40:43], 0
    ds_read_b128 v[68:71], v1 offset:15360
    v_mfma_f32_16x16x32_bf16 v[28:31], v[132:135], v[40:43], 0
    s_waitcnt lgkmcnt(6)
    v_mfma_f32_16x16x32_bf16 v[24:27], v[136:139], v[44:47], v[24:27]
    ds_read_b128 v[40:43], v1 offset:20480
    v_mfma_f32_16x16x32_bf16 v[28:31], v[140:143], v[44:47], v[28:31]
    s_waitcnt lgkmcnt(6)
    v_mfma_f32_16x16x32_bf16 v[24:27], v[144:147], v[48:51], v[24:27]
    ds_read_b128 v[44:47], v1 offset:21504
    v_mfma_f32_16x16x32_bf16 v[28:31], v[148:151], v[48:51], v[28:31]
    s_waitcnt lgkmcnt(6)
    v_mfma_f32_16x16x32_bf16 v[24:27], v[152:155], v[52:55], v[24:27]
    ds_read_b128 v[48:51], v1 offset:22528
    v_mfma_f32_16x16x32_bf16 v[28:31], v[156:159], v[52:55], v[28:31]
    ds_write_b128 v7, v[16:19] offset:0
    ds_write_b128 v7, v[20:23] offset:1024
    s_waitcnt lgkmcnt(8)
    v_mfma_f32_16x16x32_bf16 v[24:27], v[160:163], v[56:59], v[24:27]
    ds_read_b128 v[52:55], v1 offset:23552
    v_mfma_f32_16x16x32_bf16 v[28:31], v[164:167], v[56:59], v[28:31]
    s_waitcnt lgkmcnt(8)
    v_mfma_f32_16x16x32_bf16 v[24:27], v[168:171], v[60:63], v[24:27]
    ds_read_b128 v[56:59], v1 offset:28672
    v_mfma_f32_16x16x32_bf16 v[28:31], v[172:175], v[60:63], v[28:31]
    s_waitcnt lgkmcnt(8)
    v_mfma_f32_16x16x32_bf16 v[24:27], v[176:179], v[64:67], v[24:27]
    ds_read_b128 v[60:63], v1 offset:29696
    v_mfma_f32_16x16x32_bf16 v[28:31], v[180:183], v[64:67], v[28:31]
    s_waitcnt lgkmcnt(8)
    v_mfma_f32_16x16x32_bf16 v[24:27], v[184:187], v[68:71], v[24:27]
    ds_read_b128 v[64:67], v1 offset:30720
    v_mfma_f32_16x16x32_bf16 v[28:31], v[188:191], v[68:71], v[28:31]
    s_waitcnt lgkmcnt(8)
    v_mfma_f32_16x16x32_bf16 v[24:27], v[192:195], v[40:43], v[24:27]
    ds_read_b128 v[68:71], v1 offset:31744
    v_mfma_f32_16x16x32_bf16 v[28:31], v[196:199], v[40:43], v[28:31]
    s_waitcnt lgkmcnt(8)
    v_mfma_f32_16x16x32_bf16 v[24:27], v[200:203], v[44:47], v[24:27]
    v_mfma_f32_16x16x32_bf16 v[28:31], v[204:207], v[44:47], v[28:31]
    s_waitcnt lgkmcnt(7)
    v_mfma_f32_16x16x32_bf16 v[24:27], v[208:211], v[48:51], v[24:27]
    v_mfma_f32_16x16x32_bf16 v[28:31], v[212:215], v[48:51], v[28:31]
    s_waitcnt lgkmcnt(4)
    v_mfma_f32_16x16x32_bf16 v[24:27], v[216:219], v[52:55], v[24:27]
    v_mfma_f32_16x16x32_bf16 v[28:31], v[220:223], v[52:55], v[28:31]
    s_waitcnt lgkmcnt(3)
    v_mfma_f32_16x16x32_bf16 v[24:27], v[224:227], v[56:59], v[24:27]
    v_mfma_f32_16x16x32_bf16 v[28:31], v[228:231], v[56:59], v[28:31]
    s_waitcnt lgkmcnt(2)
    v_mfma_f32_16x16x32_bf16 v[24:27], v[232:235], v[60:63], v[24:27]
    v_mfma_f32_16x16x32_bf16 v[28:31], v[236:239], v[60:63], v[28:31]
    s_waitcnt lgkmcnt(1)
    v_mfma_f32_16x16x32_bf16 v[24:27], v[240:243], v[64:67], v[24:27]
    v_mfma_f32_16x16x32_bf16 v[28:31], v[244:247], v[64:67], v[28:31]
    s_waitcnt lgkmcnt(0)
    v_mfma_f32_16x16x32_bf16 v[24:27], v[248:251], v[68:71], v[24:27]
    v_mfma_f32_16x16x32_bf16 v[28:31], v[252:255], v[68:71], v[28:31]
    v_xor_b32 v1, 0x10000, v1
    v_xor_b32 v2, 0x10000, v2
    s_add_u32 s31, s31, 262144
    s_and_b32 s31, s31, 2097151
    s_xor_b32 s30, s30, 0x10000
    s_nop 2
    ds_write_b128 v7, v[24:27] offset:2048
    ds_write_b128 v7, v[28:31] offset:3072
    s_waitcnt vmcnt(0) lgkmcnt(0)
    s_barrier
    s_cmp_lg_u32 s24, 4
    s_cbranch_scc1 FA_39
    s_add_u32 s74, s28, 0
    s_atomic_smax s74, s[4:5], s51
FA_39:
    s_add_u32 s28, s28, 1
    s_cmp_lt_u32 s28, 64
    s_cbranch_scc1 L_o_y
    s_mov_b32 s58, 0
    s_branch L_o_end
L_o_x0:
    s_barrier
L_o_x:
    s_barrier
    ds_read_b128 v[16:19], v7 offset:0
    ds_read_b128 v[20:23], v7 offset:1024
    ds_read_b128 v[40:43], v1 offset:0
    ds_read_b128 v[44:47], v1 offset:1024
    ds_read_b128 v[48:51], v1 offset:2048
    ds_read_b128 v[52:55], v1 offset:3072
    ds_read_b128 v[56:59], v1 offset:8192
    ds_read_b128 v[60:63], v1 offset:9216
    ds_read_b128 v[64:67], v1 offset:10240
    ds_read_b128 v[24:27], v7 offset:2048
    ds_read_b128 v[28:31], v7 offset:3072
    s_waitcnt lgkmcnt(8)
    v_mfma_f32_16x16x32_bf16 v[16:19], v[128:131], v[40:43], v[16:19]
    ds_read_b128 v[68:71], v1 offset:11264
    v_mfma_f32_16x16x32_bf16 v[20:23], v[132:135], v[40:43], v[20:23]
    s_waitcnt lgkmcnt(8)
    v_mfma_f32_16x16x32_bf16 v[16:19], v[136:139], v[44:47], v[16:19]
    ds_read_b128 v[40:43], v1 offset:16384
    v_mfma_f32_16x16x32_bf16 v[20:23], v[140:143], v[44:47], v[20:23]
    s_waitcnt lgkmcnt(8)
    v_mfma_f32_16x16x32_bf16 v[16:19], v[144:147], v[48:51], v[16:19]
    ds_read_b128 v[44:47], v1 offset:17408
    v_mfma_f32_16x16x32_bf16 v[20:23], v[148:151], v[48:51], v[20:23]
    s_waitcnt lgkmcnt(8)
    v_mfma_f32_16x16x32_bf16 v[16:19], v[152:155], v[52:55], v[16:19]
    ds_read_b128 v[48:51], v1 offset:18432
    v_mfma_f32_16x16x32_bf16 v[20:23], v[156:159], v[52:55], v[20:23]
    s_waitcnt lgkmcnt(8)
    v_mfma_f32_16x16x32_bf16 v[16:19], v[160:163], v[56:59], v[16:19]
    ds_read_b128 v[52:55], v1 offset:19456
    v_mfma_f32_16x16x32_bf16 v[20:23], v[164:167], v[56:59], v[20:23]
    s_waitcnt lgkmcnt(8)
    v_mfma_f32_16x16x32_bf16 v[16:19], v[168:171], v[60:63], v[16:19]
    ds_read_b128 v[56:59], v1 offset:24576
    v_mfma_f32_16x16x32_bf16 v[20:23], v[172:175], v[60:63], v[20:23]
    s_waitcnt lgkmcnt(8)
    v_mfma_f32_16x16x32_bf16 v[16:19], v[176:179], v[64:67], v[16:19]
    ds_read_b128 v[60:63], v1 offset:25600
    v_mfma_f32_16x16x32_bf16 v[20:23], v[180:183], v[64:67], v[20:23]
    s_waitcnt lgkmcnt(6)
    v_mfma_f32_16x16x32_bf16 v[16:19], v[184:187], v[68:71], v[16:19]
    ds_read_b128 v[64:67], v1 offset:26624
    v_mfma_f32_16x16x32_bf16 v[20:23], v[188:191], v[68:71], v[20:23]
    s_waitcnt lgkmcnt(6)
    v_mfma_f32_16x16x32_bf16 v[16:19], v[192:195], v[40:43], v[16:19]
    ds_read_b128 v[68:71], v1 offset:27648
    v_mfma_f32_16x16x32_bf16 v[20:23], v[196:199], v[40:43], v[20:23]
    s_waitcnt lgkmcnt(6)
    v_mfma_f32_16x16x32_bf16 v[16:19], v[200:203], v[44:47], v[16:19]
    ds_read_b128 v[40:43], v1 offset:4096
    v_mfma_f32_16x16x32_bf16 v[20:23], v[204:207], v[44:47], v[20:23]
    s_waitcnt lgkmcnt(6)
    v_mfma_f32_16x16x32_bf16 v[16:19], v[208:211], v[48:51], v[16:19]
    ds_read_b128 v[44:47], v1 offset:5120
    v_mfma_f32_16x16x32_bf16 v[20:23], v[212:215], v[48:51], v[20:23]
    s_waitcnt lgkmcnt(6)
    v_mfma_f32_16x16x32_bf16 v[16:19], v[216:219], v[52:55], v[16:19]
    ds_read_b128 v[48:51], v1 offset:6144
    v_mfma_f32_16x16x32_bf16 v[20:23], v[220:223], v[52:55], v[20:23]
    s_waitcnt lgkmcnt(6)
    v_mfma_f32_16x16x32_bf16 v[16:19], v[224:227], v[56:59], v[16:19]
    ds_read_b128 v[52:55], v1 offset:7168
    v_mfma_f32_16x16x32_bf16 v[20:23], v[228:231], v[56:59], v[20:23]
    s_waitcnt lgkmcnt(6)
    v_mfma_f32_16x16x32_bf16 v[16:19], v[232:235], v[60:63], v[16:19]
    ds_read_b128 v[56:59], v1 offset:12288
    v_mfma_f32_16x16x32_bf16 v[20:23], v[236:239], v[60:63], v[20:23]
    s_waitcnt lgkmcnt(6)
    v_mfma_f32_16x16x32_bf16 v[16:19], v[240:243], v[64:67], v[16:19]
    ds_read_b128 v[60:63], v1 offset:13312
    v_mfma_f32_16x16x32_bf16 v[20:23], v[244:247], v[64:67], v[20:23]
    s_waitcnt lgkmcnt(6)
    v_mfma_f32_16x16x32_bf16 v[16:19], v[248:251], v[68:71], v[16:19]
    ds_read_b128 v[64:67], v1 offset:14336
    v_mfma_f32_16x16x32_bf16 v[20:23], v[252:255], v[68:71], v[20:23]
    s_waitcnt lgkmcnt(6)
    v_mfma_f32_16x16x32_bf16 v[24:27], v[128:131], v[40:43], v[24:27]
    ds_read_b128 v[68:71], v1 offset:15360
    v_mfma_f32_16x16x32_bf16 v[28:31], v[132:135], v[40:43], v[28:31]
    s_waitcnt lgkmcnt(6)
    v_mfma_f32_16x16x32_bf16 v[24:27], v[136:139], v[44:47], v[24:27]
    ds_read_b128 v[40:43], v1 offset:20480
    v_mfma_f32_16x16x32_bf16 v[28:31], v[140:143], v[44:47], v[28:31]
    s_waitcnt lgkmcnt(6)
    v_mfma_f32_16x16x32_bf16 v[24:27], v[144:147], v[48:51], v[24:27]
    ds_read_b128 v[44:47], v1 offset:21504
    v_mfma_f32_16x16x32_bf16 v[28:31], v[148:151], v[48:51], v[28:31]
    s_waitcnt lgkmcnt(6)
    v_mfma_f32_16x16x32_bf16 v[24:27], v[152:155], v[52:55], v[24:27]
    ds_read_b128 v[48:51], v1 offset:22528
    v_mfma_f32_16x16x32_bf16 v[28:31], v[156:159], v[52:55], v[28:31]
    s_waitcnt lgkmcnt(6)
    v_mfma_f32_16x16x32_bf16 v[24:27], v[160:163], v[56:59], v[24:27]
    ds_read_b128 v[52:55], v1 offset:23552
    v_mfma_f32_16x16x32_bf16 v[28:31], v[164:167], v[56:59], v[28:31]
    s_waitcnt lgkmcnt(6)
    v_mfma_f32_16x16x32_bf16 v[24:27], v[168:171], v[60:63], v[24:27]
    ds_read_b128 v[56:59], v1 offset:28672
    v_mfma_f32_16x16x32_bf16 v[28:31], v[172:175], v[60:63], v[28:31]
    s_waitcnt lgkmcnt(6)
    v_mfma_f32_16x16x32_bf16 v[24:27], v[176:179], v[64:67], v[24:27]
    ds_read_b128 v[60:63], v1 offset:29696
    v_mfma_f32_16x16x32_bf16 v[28:31], v[180:183], v[64:67], v[28:31]
    s_waitcnt lgkmcnt(6)
    v_mfma_f32_16x16x32_bf16 v[24:27], v[184:187], v[68:71], v[24:27]
    ds_read_b128 v[64:67], v1 offset:30720
    v_mfma_f32_16x16x32_bf16 v[28:31], v[188:191], v[68:71], v[28:31]
    s_waitcnt lgkmcnt(6)
    v_mfma_f32_16x16x32_bf16 v[24:27], v[192:195], v[40:43], v[24:27]
    ds_read_b128 v[68:71], v1 offset:31744
    v_mfma_f32_16x16x32_bf16 v[28:31], v[196:199], v[40:43], v[28:31]
    s_waitcnt lgkmcnt(6)
    v_mfma_f32_16x16x32_bf16 v[24:27], v[200:203], v[44:47], v[24:27]
    v_mfma_f32_16x16x32_bf16 v[28:31], v[204:207], v[44:47], v[28:31]
    s_waitcnt lgkmcnt(5)
    v_mfma_f32_16x16x32_bf16 v[24:27], v[208:211], v[48:51], v[24:27]
    v_mfma_f32_16x16x32_bf16 v[28:31], v[212:215], v[48:51], v[28:31]
    s_waitcnt lgkmcnt(4)
    v_mfma_f32_16x16x32_bf16 v[24:27], v[216:219], v[52:55], v[24:27]
    v_mfma_f32_16x16x32_bf16 v[28:31], v[220:223], v[52:55], v[28:31]
    s_waitcnt lgkmcnt(3)
    v_mfma_f32_16x16x32_bf16 v[24:27], v[224:227], v[56:59], v[24:27]
    v_mfma_f32_16x16x32_bf16 v[28:31], v[228:231], v[56:59], v[28:31]
    s_waitcnt lgkmcnt(2)
    v_mfma_f32_16x16x32_bf16 v[24:27], v[232:235], v[60:63], v[24:27]
    v_mfma_f32_16x16x32_bf16 v[28:31], v[236:239], v[60:63], v[28:31]
    s_waitcnt lgkmcnt(1)
    v_mfma_f32_16x16x32_bf16 v[24:27], v[240:243], v[64:67], v[24:27]
    v_mfma_f32_16x16x32_bf16 v[28:31], v[244:247], v[64:67], v[28:31]
    s_waitcnt lgkmcnt(0)
    v_mfma_f32_16x16x32_bf16 v[24:27], v[248:251], v[68:71], v[24:27]
    v_mfma_f32_16x16x32_bf16 v[28:31], v[252:255], v[68:71], v[28:31]
    v_xor_b32 v1, 0x10000, v1
    v_xor_b32 v2, 0x10000, v2
    s_lshl_b32 s49, s28, 19
    s_cmp_eq_u32 s28, 63
    s_cbranch_scc1 L_o_last
    s_barrier
    s_cmp_ge_u32 s24, 2
    s_cbranch_scc1 L_o_nf
    s_sub_u32 s66, s28, 2
    s_add_u32 s32, s66, 1
    s_cmp_ge_i32 s58, s32
    s_cbranch_scc1 PD_41
    s_mov_b32 s48, 400000
PW_40:
    s_mov_b64 exec, 0xf
    buffer_load_dword v11, v0, s[4:7], s69 offen sc1
    s_mov_b64 exec, -1
    s_sub_u32 s48, s48, 1
    s_cbranch_scc1 L_abort
    s_waitcnt vmcnt(0)
    v_min_u32_dpp v11, v11, v11 quad_perm:[1,0,3,2] row_mask:0xf bank_mask:0xf
    s_nop 1
    v_min_u32_dpp v11, v11, v11 quad_perm:[2,3,0,1] row_mask:0xf bank_mask:0xf
    s_nop 0
    v_readfirstlane_b32 s58, v11
    s_nop 3
    s_cmp_ge_i32 s58, s32
    s_cbranch_scc1 PD_41
    s_sleep 2
    s_branch PW_40
PD_41:
    s_lshl_b32 s53, s66, 19
    s_lshl_b32 s55, s66, 17
    s_cmp_lt_i32 s66, 0
    s_cselect_b32 s53, 2147418096, s53
    s_cselect_b32 s55, 2147418096, s55
    s_add_u32 s37, s53, 0
    buffer_load_dwordx4 v[72:75], v12, s[4:7], s37 offen offset:0 sc1
    s_add_u32 s37, s53, 0
    buffer_load_dwordx4 v[76:79], v12, s[4:7], s37 offen offset:1024 sc1
    s_add_u32 s37, s53, 4096
    buffer_load_dwordx4 v[80:83], v12, s[4:7], s37 offen offset:0 sc1
    s_add_u32 s37, s53, 4096
    buffer_load_dwordx4 v[84:87], v12, s[4:7], s37 offen offset:1024 sc1
    s_add_u32 s37, s53, 8192
    buffer_load_dwordx4 v[88:91], v12, s[4:7], s37 offen offset:0 sc1
    s_add_u32 s37, s53, 8192
    buffer_load_dwordx4 v[92:95], v12, s[4:7], s37 offen offset:1024 sc1
    s_add_u32 s37, s53, 12288
    buffer_load_dwordx4 v[96:99], v12, s[4:7], s37 offen offset:0 sc1
    s_add_u32 s37, s53, 12288
    buffer_load_dwordx4 v[100:103], v12, s[4:7], s37 offen offset:1024 sc1
    s_mov_b64 exec, 0xf
    buffer_load_dword v11, v0, s[4:7], s69 offen sc1
    s_mov_b64 exec, -1
    buffer_store_dwordx4 v[16:19], v9, s[4:7], s49 offen offset:0 sc1
    buffer_store_dwordx4 v[20:23], v9, s[4:7], s49 offen offset:1024 sc1
    buffer_store_dwordx4 v[24:27], v9, s[4:7], s49 offen offset:2048 sc1
    buffer_store_dwordx4 v[28:31], v9, s[4:7], s49 offen offset:3072 sc1
    s_waitcnt vmcnt(4)
    v_min_u32_dpp v11, v11, v11 quad_perm:[1,0,3,2] row_mask:0xf bank_mask:0xf
    s_nop 1
    v_min_u32_dpp v11, v11, v11 quad_perm:[2,3,0,1] row_mask:0xf bank_mask:0xf
    s_nop 0
    v_readfirstlane_b32 s58, v11
    s_nop 3
    v_add_f32 v72, v72, v80
    v_add_f32 v73, v73, v81
    v_add_f32 v74, v74, v82
    v_add_f32 v75, v75, v83
    v_add_f32 v76, v76, v84
    v_add_f32 v77, v77, v85
    v_add_f32 v78, v78, v86
    v_add_f32 v79, v79, v87
    v_add_f32 v88, v88, v96
    v_add_f32 v89, v89, v97
    v_add_f32 v90, v90, v98
    v_add_f32 v91, v91, v99
    v_add_f32 v92, v92, v100
    v_add_f32 v93, v93, v101
    v_add_f32 v94, v94, v102
    v_add_f32 v95, v95, v103
    v_add_f32 v72, v72, v88
    v_add_f32 v73, v73, v89
    v_add_f32 v74, v74, v90
    v_add_f32 v75, v75, v91
    v_add_f32 v76, v76, v92
    v_add_f32 v77, v77, v93
    v_add_f32 v78, v78, v94
    v_add_f32 v79, v79, v95
    v_cvt_pk_bf16_f32 v104, v72, v73
    v_cvt_pk_bf16_f32 v105, v74, v75
    v_cvt_pk_bf16_f32 v106, v76, v77
    v_cvt_pk_bf16_f32 v107, v78, v79
    buffer_store_dwordx4 v[104:107], v13, s[12:15], s55 offen
    s_waitcnt vmcnt(1)
    s_branch L_o_n2
L_o_nf:
    buffer_store_dwordx4 v[16:19], v9, s[4:7], s49 offen offset:0 sc1
    buffer_store_dwordx4 v[20:23], v9, s[4:7], s49 offen offset:1024 sc1
    buffer_store_dwordx4 v[24:27], v9, s[4:7], s49 offen offset:2048 sc1
    buffer_store_dwordx4 v[28:31], v9, s[4:7], s49 offen offset:3072 sc1
    s_waitcnt vmcnt(0)
L_o_n2:
    s_add_u32 s28, s28, 1
    s_branch L_o_x
L_o_last:
    s_nop 2
    buffer_store_dwordx4 v[16:19], v9, s[4:7], s49 offen offset:0 sc1
    buffer_store_dwordx4 v[20:23], v9, s[4:7], s49 offen offset:1024 sc1
    buffer_store_dwordx4 v[24:27], v9, s[4:7], s49 offen offset:2048 sc1
    buffer_store_dwordx4 v[28:31], v9, s[4:7], s49 offen offset:3072 sc1
    s_cmp_ge_u32 s24, 2
    s_cbranch_scc1 L_done
    s_mov_b32 s53, 33030144
    s_mov_b32 s55, 8257536
    s_mov_b32 s48, 400000
    s_waitcnt vmcnt(2)
L_o_poll:
    s_add_u32 s37, s53, 0
    buffer_load_dwordx4 v[72:75], v12, s[4:7], s37 offen offset:0 sc1
    s_add_u32 s37, s53, 0
    buffer_load_dwordx4 v[76:79], v12, s[4:7], s37 offen offset:1024 sc1
    s_add_u32 s37, s53, 4096
    buffer_load_dwordx4 v[80:83], v12, s[4:7], s37 offen offset:0 sc1
    s_add_u32 s37, s53, 4096
    buffer_load_dwordx4 v[84:87], v12, s[4:7], s37 offen offset:1024 sc1
    s_add_u32 s37, s53, 8192
    buffer_load_dwordx4 v[88:91], v12, s[4:7], s37 offen offset:0 sc1
    s_add_u32 s37, s53, 8192
    buffer_load_dwordx4 v[92:95], v12, s[4:7], s37 offen offset:1024 sc1
    s_add_u32 s37, s53, 12288
    buffer_load_dwordx4 v[96:99], v12, s[4:7], s37 offen offset:0 sc1
    s_add_u32 s37, s53, 12288
    buffer_load_dwordx4 v[100:103], v12, s[4:7], s37 offen offset:1024 sc1
    s_sub_u32 s48, s48, 1
    s_cbranch_scc1 L_abort
    s_waitcnt vmcnt(0)
    v_max_u32 v11, v72, v73
    v_max3_u32 v11, v11, v74, v75
    v_max3_u32 v11, v11, v76, v77
    v_max3_u32 v11, v11, v78, v79
    v_max3_u32 v11, v11, v80, v81
    v_max3_u32 v11, v11, v82, v83
    v_max3_u32 v11, v11, v84, v85
    v_max3_u32 v11, v11, v86, v87
    v_max3_u32 v11, v11, v88, v89
    v_max3_u32 v11, v11, v90, v91
    v_max3_u32 v11, v11, v92, v93
    v_max3_u32 v11, v11, v94, v95
    v_max3_u32 v11, v11, v96, v97
    v_max3_u32 v11, v11, v98, v99
    v_max3_u32 v11, v11, v100, v101
    v_max3_u32 v11, v11, v102, v103
    v_cmp_eq_u32 vcc, -1, v11
    s_cbranch_vccnz L_o_poll
    v_add_f32 v72, v72, v80
    v_add_f32 v73, v73, v81
    v_add_f32 v74, v74, v82
    v_add_f32 v75, v75, v83
    v_add_f32 v76, v76, v84
    v_add_f32 v77, v77, v85
    v_add_f32 v78, v78, v86
    v_add_f32 v79, v79, v87
    v_add_f32 v88, v88, v96
    v_add_f32 v89, v89, v97
    v_add_f32 v90, v90, v98
    v_add_f32 v91, v91, v99
    v_add_f32 v92, v92, v100
    v_add_f32 v93, v93, v101
    v_add_f32 v94, v94, v102
    v_add_f32 v95, v95, v103
    v_add_f32 v72, v72, v88
    v_add_f32 v73, v73, v89
    v_add_f32 v74, v74, v90
    v_add_f32 v75, v75, v91
    v_add_f32 v76, v76, v92
    v_add_f32 v77, v77, v93
    v_add_f32 v78, v78, v94
    v_add_f32 v79, v79, v95
    v_cvt_pk_bf16_f32 v104, v72, v73
    v_cvt_pk_bf16_f32 v105, v74, v75
    v_cvt_pk_bf16_f32 v106, v76, v77
    v_cvt_pk_bf16_f32 v107, v78, v79
    buffer_store_dwordx4 v[104:107], v13, s[12:15], s55 offen
    s_branch L_done
L_o_end:
    s_lshr_b32 s66, s24, 1
    s_sub_u32 s66, 64, s66
    s_add_u32 s32, s66, 1
    s_cmp_ge_i32 s58, s32
    s_cbranch_scc1 PD_43
    s_mov_b32 s48, 400000
PW_42:
    s_mov_b64 exec, 0xf
    buffer_load_dword v11, v0, s[4:7], s69 offen sc1
    s_mov_b64 exec, -1
    s_sub_u32 s48, s48, 1
    s_cbranch_scc1 L_abort
    s_waitcnt vmcnt(0)
    v_min_u32_dpp v11, v11, v11 quad_perm:[1,0,3,2] row_mask:0xf bank_mask:0xf
    s_nop 1
    v_min_u32_dpp v11, v11, v11 quad_perm:[2,3,0,1] row_mask:0xf bank_mask:0xf
    s_nop 0
    v_readfirstlane_b32 s58, v11
    s_nop 3
    s_cmp_ge_i32 s58, s32
    s_cbranch_scc1 PD_43
    s_sleep 2
    s_branch PW_42
PD_43:
    s_lshl_b32 s53, s66, 19
    s_lshl_b32 s55, s66, 17
    s_cmp_lt_i32 s66, 0
    s_cselect_b32 s53, 2147418096, s53
    s_cselect_b32 s55, 2147418096, s55
    s_add_u32 s37, s53, 0
    buffer_load_dwordx4 v[72:75], v12, s[4:7], s37 offen offset:0 sc1
    s_add_u32 s37, s53, 0
    buffer_load_dwordx4 v[76:79], v12, s[4:7], s37 offen offset:1024 sc1
    s_add_u32 s37, s53, 4096
    buffer_load_dwordx4 v[80:83], v12, s[4:7], s37 offen offset:0 sc1
    s_add_u32 s37, s53, 4096
    buffer_load_dwordx4 v[84:87], v12, s[4:7], s37 offen offset:1024 sc1
    s_add_u32 s37, s53, 8192
    buffer_load_dwordx4 v[88:91], v12, s[4:7], s37 offen offset:0 sc1
    s_add_u32 s37, s53, 8192
    buffer_load_dwordx4 v[92:95], v12, s[4:7], s37 offen offset:1024 sc1
    s_add_u32 s37, s53, 12288
    buffer_load_dwordx4 v[96:99], v12, s[4:7], s37 offen offset:0 sc1
    s_add_u32 s37, s53, 12288
    buffer_load_dwordx4 v[100:103], v12, s[4:7], s37 offen offset:1024 sc1
    s_waitcnt vmcnt(0)
    v_add_f32 v72, v72, v80
    v_add_f32 v73, v73, v81
    v_add_f32 v74, v74, v82
    v_add_f32 v75, v75, v83
    v_add_f32 v76, v76, v84
    v_add_f32 v77, v77, v85
    v_add_f32 v78, v78, v86
    v_add_f32 v79, v79, v87
    v_add_f32 v88, v88, v96
    v_add_f32 v89, v89, v97
    v_add_f32 v90, v90, v98
    v_add_f32 v91, v91, v99
    v_add_f32 v92, v92, v100
    v_add_f32 v93, v93, v101
    v_add_f32 v94, v94, v102
    v_add_f32 v95, v95, v103
    v_add_f32 v72, v72, v88
    v_add_f32 v73, v73, v89
    v_add_f32 v74, v74, v90
    v_add_f32 v75, v75, v91
    v_add_f32 v76, v76, v92
    v_add_f32 v77, v77, v93
    v_add_f32 v78, v78, v94
    v_add_f32 v79, v79, v95
    v_cvt_pk_bf16_f32 v104, v72, v73
    v_cvt_pk_bf16_f32 v105, v74, v75
    v_cvt_pk_bf16_f32 v106, v76, v77
    v_cvt_pk_bf16_f32 v107, v78, v79
    buffer_store_dwordx4 v[104:107], v13, s[12:15], s55 offen
    s_branch L_done
L_abort:
L_done:
L_end:
    s_endpgm
L_rec:
    s_and_b32 s60, s24, 3
    s_lshr_b32 s61, s26, 4
    s_and_b32 s62, s26, 15
    s_mul_i32 s71, s25, 8
    s_lshr_b32 s47, s26, 2
    s_mul_i32 s47, s47, 1
    s_add_u32 s71, s71, s47
    s_cmp_ge_u32 s24, 4
    s_cbranch_scc1 L_rec_B
    v_and_b32 v24, 63, v0
    v_mov_b32 v10, 0
    s_load_dwordx4 s[40:43], s[0:1], 16
    s_load_dwordx2 s[44:45], s[0:1], 32
    s_mul_i32 s32, s60, 2097152
    s_mul_i32 s47, s25, 2048
    s_add_u32 s32, s32, s47
    s_mul_i32 s47, s26, 64
    s_add_u32 s32, s32, s47
    v_bfe_u32 v25, v24, 5, 1
    v_lshlrev_b32 v28, 17, v25
    v_bfe_u32 v25, v24, 4, 1
    v_lshl_add_u32 v28, v25, 13, v28
    v_and_b32 v25, 15, v24
    v_lshl_add_u32 v28, v25, 2, v28
    v_add_u32 v28, s32, v28
    s_mov_b32 s56, 0x05040100
    s_mov_b32 s57, 0x07060302
    s_waitcnt lgkmcnt(0)
    s_mov_b32 s8, s40
    s_and_b32 s9, s41, 0xffff
    s_mov_b32 s10, 8388608
    s_mov_b32 s11, 0x20000
    s_mov_b32 s12, s42
    s_and_b32 s13, s43, 0xffff
    s_mov_b32 s14, 8388608
    s_mov_b32 s15, 0x20000
    s_mov_b32 s16, s44
    s_and_b32 s17, s45, 0xffff
    s_mov_b32 s18, 8388608
    s_mov_b32 s19, 0x20000
    s_barrier
    s_mov_b32 s40, 0
    buffer_load_dword v80, v28, s[12:15], s40 offen
    s_mov_b32 s40, 32768
    buffer_load_dword v88, v28, s[12:15], s40 offen
    s_mov_b32 s40, 16384
    buffer_load_dword v81, v28, s[12:15], s40 offen
    s_mov_b32 s40, 49152
    buffer_load_dword v89, v28, s[12:15], s40 offen
    s_mov_b32 s40, 65536
    buffer_load_dword v82, v28, s[12:15], s40 offen
    s_mov_b32 s40, 98304
    buffer_load_dword v90, v28, s[12:15], s40 offen
    s_mov_b32 s40, 81920
    buffer_load_dword v83, v28, s[12:15], s40 offen
    s_mov_b32 s40, 114688
    buffer_load_dword v91, v28, s[12:15], s40 offen
    s_mov_b32 s40, 262144
    buffer_load_dword v84, v28, s[12:15], s40 offen
    s_mov_b32 s40, 294912
    buffer_load_dword v92, v28, s[12:15], s40 offen
    s_mov_b32 s40, 278528
    buffer_load_dword v85, v28, s[12:15], s40 offen
    s_mov_b32 s40, 311296
    buffer_load_dword v93, v28, s[12:15], s40 offen
    s_mov_b32 s40, 327680
    buffer_load_dword v86, v28, s[12:15], s40 offen
    s_mov_b32 s40, 360448
    buffer_load_dword v94, v28, s[12:15], s40 offen
    s_mov_b32 s40, 344064
    buffer_load_dword v87, v28, s[12:15], s40 offen
    s_mov_b32 s40, 376832
    buffer_load_dword v95, v28, s[12:15], s40 offen
    s_mov_b32 s40, 0
    buffer_load_dword v96, v28, s[16:19], s40 offen
    s_mov_b32 s40, 32768
    buffer_load_dword v104, v28, s[16:19], s40 offen
    s_mov_b32 s40, 16384
    buffer_load_dword v97, v28, s[16:19], s40 offen
    s_mov_b32 s40, 49152
    buffer_load_dword v105, v28, s[16:19], s40 offen
    s_mov_b32 s40, 65536
    buffer_load_dword v98, v28, s[16:19], s40 offen
    s_mov_b32 s40, 98304
    buffer_load_dword v106, v28, s[16:19], s40 offen
    s_mov_b32 s40, 81920
    buffer_load_dword v99, v28, s[16:19], s40 offen
    s_mov_b32 s40, 114688
    buffer_load_dword v107, v28, s[16:19], s40 offen
    s_mov_b32 s40, 262144
    buffer_load_dword v100, v28, s[16:19], s40 offen
    s_mov_b32 s40, 294912
    buffer_load_dword v108, v28, s[16:19], s40 offen
    s_mov_b32 s40, 278528
    buffer_load_dword v101, v28, s[16:19], s40 offen
    s_mov_b32 s40, 311296
    buffer_load_dword v109, v28, s[16:19], s40 offen
    s_mov_b32 s40, 327680
    buffer_load_dword v102, v28, s[16:19], s40 offen
    s_mov_b32 s40, 360448
    buffer_load_dword v110, v28, s[16:19], s40 offen
    s_mov_b32 s40, 344064
    buffer_load_dword v103, v28, s[16:19], s40 offen
    s_mov_b32 s40, 376832
    buffer_load_dword v111, v28, s[16:19], s40 offen
    s_mov_b32 s40, 524288
    buffer_load_dword v128, v28, s[12:15], s40 offen
    s_mov_b32 s40, 557056
    buffer_load_dword v136, v28, s[12:15], s40 offen
    s_mov_b32 s40, 540672
    buffer_load_dword v129, v28, s[12:15], s40 offen
    s_mov_b32 s40, 573440
    buffer_load_dword v137, v28, s[12:15], s40 offen
    s_mov_b32 s40, 589824
    buffer_load_dword v130, v28, s[12:15], s40 offen
    s_mov_b32 s40, 622592
    buffer_load_dword v138, v28, s[12:15], s40 offen
    s_mov_b32 s40, 606208
    buffer_load_dword v131, v28, s[12:15], s40 offen
    s_mov_b32 s40, 638976
    buffer_load_dword v139, v28, s[12:15], s40 offen
    s_mov_b32 s40, 786432
    buffer_load_dword v132, v28, s[12:15], s40 offen
    s_mov_b32 s40, 819200
    buffer_load_dword v140, v28, s[12:15], s40 offen
    s_mov_b32 s40, 802816
    buffer_load_dword v133, v28, s[12:15], s40 offen
    s_mov_b32 s40, 835584
    buffer_load_dword v141, v28, s[12:15], s40 offen
    s_mov_b32 s40, 851968
    buffer_load_dword v134, v28, s[12:15], s40 offen
    s_mov_b32 s40, 884736
    buffer_load_dword v142, v28, s[12:15], s40 offen
    s_mov_b32 s40, 868352
    buffer_load_dword v135, v28, s[12:15], s40 offen
    s_mov_b32 s40, 901120
    buffer_load_dword v143, v28, s[12:15], s40 offen
    s_mul_i32 s32, s25, 16384
    s_mul_i32 s47, s26, 512
    s_add_u32 s32, s32, s47
    s_mul_i32 s33, s71, 6144
    s_bfe_u32 s47, s26, 0x20000
    s_mul_i32 s47, s47, 1024
    s_add_u32 s33, s33, s47
    s_add_u32 s33, s33, 65024
    s_mul_i32 s34, s71, 6144
    s_bfe_u32 s47, s26, 0x20000
    s_mul_i32 s47, s47, 512
    s_add_u32 s34, s34, s47
    s_add_u32 s34, s34, 68096
    v_mov_b32 v25, s32
    v_mov_b32 v26, s33
    v_cmp_le_u32 vcc, 32, v0
    s_nop 1
    v_cndmask_b32 v25, v25, v26, vcc
    v_mov_b32 v26, s34
    v_cmp_le_u32 vcc, 0x60, v0
    s_nop 1
    v_cndmask_b32 v25, v25, v26, vcc
    v_lshl_add_u32 v9, v0, 4, v25
    s_mul_i32 s32, s25, 2
    s_mul_i32 s47, s61, 1
    s_add_u32 s32, s32, s47
    s_mul_i32 s33, s62, 8
    s_mul_i32 s47, s60, 2
    s_add_u32 s33, s33, s47
    v_mov_b32 v25, s32
    v_bfe_u32 v27, v24, 5, 1
    v_lshlrev_b32 v26, 0, v27
    v_add_u32 v26, s33, v26
    v_lshlrev_b32 v26, 7, v26
    v_lshl_add_u32 v26, v25, 12, v26
    v_and_b32 v26, 0x3fff, v26
    v_lshl_add_u32 v26, v25, 14, v26
    v_lshrrev_b32 v25, 13, v26
    v_lshlrev_b32 v25, 14, v25
    v_and_b32 v26, 0x1fff, v26
    v_add_u32 v5, v25, v26
    v_and_b32 v25, 31, v24
    v_lshl_add_u32 v5, v25, 2, v5
    s_mul_i32 s33, s26, 4
    s_mul_i32 s47, s60, 1
    s_add_u32 s33, s33, s47
    v_lshrrev_b32 v25, 3, v24
    v_mov_b32 v26, s33
    v_lshlrev_b32 v26, 7, v26
    v_lshl_add_u32 v26, v25, 12, v26
    v_and_b32 v26, 0x3fff, v26
    v_lshl_add_u32 v26, v25, 14, v26
    v_lshrrev_b32 v25, 13, v26
    v_lshlrev_b32 v25, 14, v25
    v_and_b32 v26, 0x1fff, v26
    v_add_u32 v4, v25, v26
    v_and_b32 v25, 7, v24
    v_lshl_add_u32 v4, v25, 4, v4
    s_mul_i32 s32, s25, 16384
    s_mul_i32 s47, s26, 512
    s_add_u32 s32, s32, s47
    s_mul_i32 s47, s60, 128
    s_add_u32 s32, s32, s47
    v_and_b32 v25, 7, v24
    v_lshlrev_b32 v3, 4, v25
    v_bfe_u32 v25, v24, 4, 2
    v_lshl_add_u32 v3, v25, 2, v3
    v_add_u32 v3, s32, v3
    s_mul_i32 s32, s25, 16384
    s_mul_i32 s47, s60, 4096
    s_add_u32 s32, s32, s47
    v_lshlrev_b32 v2, 4, v24
    v_add_u32 v2, s32, v2
    s_mul_i32 s32, s71, 6144
    s_bfe_u32 s47, s26, 0x20000
    s_mul_i32 s47, s47, 512
    s_add_u32 s32, s32, s47
    s_mul_i32 s47, s60, 256
    s_add_u32 s32, s32, s47
    s_add_u32 s32, s32, 69632
    v_lshlrev_b32 v14, 2, v24
    v_add_u32 v14, s32, v14
    s_mul_i32 s32, s71, 4096
    s_bfe_u32 s47, s26, 0x20000
    s_mul_i32 s47, s47, 512
    s_add_u32 s32, s32, s47
    s_mul_i32 s47, s60, 256
    s_add_u32 s32, s32, s47
    s_add_u32 s32, s32, 2048
    s_cmp_ge_u32 s60, 2
    s_cselect_b32 s32, 2147483120, s32
    v_bfe_u32 v25, v24, 1, 1
    v_lshlrev_b32 v13, 7, v25
    v_bfe_u32 v25, v24, 4, 2
    v_lshl_add_u32 v13, v25, 5, v13
    v_bfe_u32 v25, v24, 2, 1
    v_lshl_add_u32 v13, v25, 4, v13
    v_and_b32 v25, 1, v24
    v_lshl_add_u32 v13, v25, 3, v13
    v_bfe_u32 v25, v24, 3, 1
    v_lshl_add_u32 v13, v25, 2, v13
    v_add_u32 v13, s32, v13
    s_mul_i32 s32, s71, 4096
    s_bfe_u32 s47, s26, 0x20000
    s_mul_i32 s47, s47, 512
    s_add_u32 s32, s32, s47
    s_mul_i32 s47, s60, 128
    s_add_u32 s32, s32, s47
    v_bfe_u32 v25, v24, 4, 2
    v_lshlrev_b32 v21, 5, v25
    v_bfe_u32 v25, v24, 2, 1
    v_lshl_add_u32 v21, v25, 4, v21
    v_and_b32 v25, 3, v24
    v_lshl_add_u32 v21, v25, 2, v21
    v_add_u32 v21, s32, v21
    v_and_b32 v25, 8, v24
    v_cmp_eq_u32 vcc, 0, v25
    v_mov_b32 v26, 2147483632
    s_nop 0
    v_cndmask_b32 v21, v21, v26, vcc
    v_lshlrev_b32 v22, 2, v24
    v_mov_b32 v23, 1
    s_mul_i32 s51, s71, 512
    s_bfe_u32 s47, s26, 0x20000
    s_mul_i32 s47, s47, 128
    s_add_u32 s51, s51, s47
    s_add_u32 s51, s51, 98582528
    s_mul_i32 s50, s25, 131072
    s_mul_i32 s47, s61, 65536
    s_add_u32 s50, s50, s47
    s_mul_i32 s47, s62, 4096
    s_add_u32 s50, s50, s47
    s_mul_i32 s47, s60, 1024
    s_add_u32 s50, s50, s47
    s_add_u32 s50, s50, 1048576
    v_and_b32 v25, 2, v24
    v_cmp_eq_u32 vcc, 0, v25
    v_mov_b32 v1, 0xeeee
    v_mov_b32 v26, 0x4444
    v_cndmask_b32 v1, v1, v26, vcc
    v_and_b32 v25, 1, v24
    v_lshlrev_b32 v25, 4, v25
    v_mov_b32 v26, 0x3f80
    v_lshlrev_b32 v26, v25, v26
    v_cndmask_b32 v26, 0, v26, vcc
    v_bfe_u32 v25, v24, 2, 2
    v_cmp_eq_u32 vcc, 0, v25
    s_nop 1
    v_cndmask_b32 v16, 0, v26, vcc
    v_cmp_eq_u32 vcc, 1, v25
    s_nop 1
    v_cndmask_b32 v17, 0, v26, vcc
    v_cmp_eq_u32 vcc, 2, v25
    s_nop 1
    v_cndmask_b32 v18, 0, v26, vcc
    v_cmp_eq_u32 vcc, 3, v25
    s_nop 1
    v_cndmask_b32 v19, 0, v26, vcc
    s_mul_i32 s32, s60, 3264
    s_add_u32 s32, s32, 1536
    v_bfe_u32 v25, v24, 2, 2
    v_mul_u32_u24 v25, 544, v25
    v_mov_b32 v6, v25
    v_bfe_u32 v25, v24, 4, 2
    v_lshl_add_u32 v6, v25, 7, v6
    v_and_b32 v25, 3, v24
    v_lshl_add_u32 v6, v25, 3, v6
    v_add_u32 v6, s32, v6
    v_bfe_u32 v25, v24, 3, 1
    v_mul_u32_u24 v25, 544, v25
    v_mov_b32 v20, v25
    v_bfe_u32 v25, v24, 4, 2
    v_lshl_add_u32 v20, v25, 7, v20
    v_and_b32 v25, 1, v24
    v_lshl_add_u32 v20, v25, 6, v20
    v_bfe_u32 v25, v24, 1, 2
    v_lshl_add_u32 v20, v25, 3, v20
    v_add_u32 v20, s32, v20
    v_add_u32 v20, 2176, v20
    s_mul_i32 s32, s60, 256
    s_add_u32 s32, s32, 14592
    v_bfe_u32 v25, v24, 3, 1
    v_mul_u32_u24 v25, 1152, v25
    v_mov_b32 v7, v25
    v_bfe_u32 v25, v24, 4, 2
    v_lshl_add_u32 v7, v25, 6, v7
    v_bfe_u32 v25, v24, 1, 1
    v_lshl_add_u32 v7, v25, 5, v7
    v_bfe_u32 v25, v24, 2, 1
    v_lshl_add_u32 v7, v25, 4, v7
    v_and_b32 v25, 1, v24
    v_lshl_add_u32 v7, v25, 3, v7
    v_add_u32 v7, s32, v7
    s_mul_i32 s32, s25, 131072
    s_mul_i32 s47, s61, 65536
    s_add_u32 s32, s32, s47
    s_mul_i32 s47, s60, 16384
    s_add_u32 s32, s32, s47
    v_lshlrev_b32 v8, 4, v24
    v_add_u32 v8, s32, v8
    s_mul_i32 s32, s60, 8192
    s_add_u32 s32, s32, 23808
    v_lshlrev_b32 v15, 4, v24
    v_add_u32 v15, s32, v15
    s_bfe_u32 s47, s60, 0x10000
    s_mul_i32 s32, s47, 544
    s_add_u32 s32, s32, 3712
    v_lshlrev_b32 v0, 3, v24
    v_add_u32 v0, s32, v0
    s_waitcnt vmcnt(32)
    v_perm_b32 v11, v88, v80, s56
    v_perm_b32 v88, v88, v80, s57
    v_mov_b32 v80, v11
    v_perm_b32 v11, v89, v81, s56
    v_perm_b32 v89, v89, v81, s57
    v_mov_b32 v81, v11
    v_perm_b32 v11, v90, v82, s56
    v_perm_b32 v90, v90, v82, s57
    v_mov_b32 v82, v11
    v_perm_b32 v11, v91, v83, s56
    v_perm_b32 v91, v91, v83, s57
    v_mov_b32 v83, v11
    v_perm_b32 v11, v92, v84, s56
    v_perm_b32 v92, v92, v84, s57
    v_mov_b32 v84, v11
    v_perm_b32 v11, v93, v85, s56
    v_perm_b32 v93, v93, v85, s57
    v_mov_b32 v85, v11
    v_perm_b32 v11, v94, v86, s56
    v_perm_b32 v94, v94, v86, s57
    v_mov_b32 v86, v11
    v_perm_b32 v11, v95, v87, s56
    v_perm_b32 v95, v95, v87, s57
    v_mov_b32 v87, v11
    s_mov_b32 s40, 524288
    buffer_load_dword v144, v28, s[16:19], s40 offen
    s_mov_b32 s40, 557056
    buffer_load_dword v152, v28, s[16:19], s40 offen
    s_mov_b32 s40, 540672
    buffer_load_dword v145, v28, s[16:19], s40 offen
    s_mov_b32 s40, 573440
    buffer_load_dword v153, v28, s[16:19], s40 offen
    s_mov_b32 s40, 589824
    buffer_load_dword v146, v28, s[16:19], s40 offen
    s_mov_b32 s40, 622592
    buffer_load_dword v154, v28, s[16:19], s40 offen
    s_mov_b32 s40, 606208
    buffer_load_dword v147, v28, s[16:19], s40 offen
    s_mov_b32 s40, 638976
    buffer_load_dword v155, v28, s[16:19], s40 offen
    s_mov_b32 s40, 786432
    buffer_load_dword v148, v28, s[16:19], s40 offen
    s_mov_b32 s40, 819200
    buffer_load_dword v156, v28, s[16:19], s40 offen
    s_mov_b32 s40, 802816
    buffer_load_dword v149, v28, s[16:19], s40 offen
    s_mov_b32 s40, 835584
    buffer_load_dword v157, v28, s[16:19], s40 offen
    s_mov_b32 s40, 851968
    buffer_load_dword v150, v28, s[16:19], s40 offen
    s_mov_b32 s40, 884736
    buffer_load_dword v158, v28, s[16:19], s40 offen
    s_mov_b32 s40, 868352
    buffer_load_dword v151, v28, s[16:19], s40 offen
    s_mov_b32 s40, 901120
    buffer_load_dword v159, v28, s[16:19], s40 offen
    s_waitcnt vmcnt(32)
    v_perm_b32 v11, v104, v96, s56
    v_perm_b32 v104, v104, v96, s57
    v_mov_b32 v96, v11
    v_perm_b32 v11, v105, v97, s56
    v_perm_b32 v105, v105, v97, s57
    v_mov_b32 v97, v11
    v_perm_b32 v11, v106, v98, s56
    v_perm_b32 v106, v106, v98, s57
    v_mov_b32 v98, v11
    v_perm_b32 v11, v107, v99, s56
    v_perm_b32 v107, v107, v99, s57
    v_mov_b32 v99, v11
    v_perm_b32 v11, v108, v100, s56
    v_perm_b32 v108, v108, v100, s57
    v_mov_b32 v100, v11
    v_perm_b32 v11, v109, v101, s56
    v_perm_b32 v109, v109, v101, s57
    v_mov_b32 v101, v11
    v_perm_b32 v11, v110, v102, s56
    v_perm_b32 v110, v110, v102, s57
    v_mov_b32 v102, v11
    v_perm_b32 v11, v111, v103, s56
    v_perm_b32 v111, v111, v103, s57
    v_mov_b32 v103, v11
    s_mov_b32 s40, 1048576
    buffer_load_dword v176, v28, s[12:15], s40 offen
    s_mov_b32 s40, 1081344
    buffer_load_dword v184, v28, s[12:15], s40 offen
    s_mov_b32 s40, 1064960
    buffer_load_dword v177, v28, s[12:15], s40 offen
    s_mov_b32 s40, 1097728
    buffer_load_dword v185, v28, s[12:15], s40 offen
    s_mov_b32 s40, 1114112
    buffer_load_dword v178, v28, s[12:15], s40 offen
    s_mov_b32 s40, 1146880
    buffer_load_dword v186, v28, s[12:15], s40 offen
    s_mov_b32 s40, 1130496
    buffer_load_dword v179, v28, s[12:15], s40 offen
    s_mov_b32 s40, 1163264
    buffer_load_dword v187, v28, s[12:15], s40 offen
    s_mov_b32 s40, 1310720
    buffer_load_dword v180, v28, s[12:15], s40 offen
    s_mov_b32 s40, 1343488
    buffer_load_dword v188, v28, s[12:15], s40 offen
    s_mov_b32 s40, 1327104
    buffer_load_dword v181, v28, s[12:15], s40 offen
    s_mov_b32 s40, 1359872
    buffer_load_dword v189, v28, s[12:15], s40 offen
    s_mov_b32 s40, 1376256
    buffer_load_dword v182, v28, s[12:15], s40 offen
    s_mov_b32 s40, 1409024
    buffer_load_dword v190, v28, s[12:15], s40 offen
    s_mov_b32 s40, 1392640
    buffer_load_dword v183, v28, s[12:15], s40 offen
    s_mov_b32 s40, 1425408
    buffer_load_dword v191, v28, s[12:15], s40 offen
    s_waitcnt vmcnt(32)
    v_perm_b32 v11, v136, v128, s56
    v_perm_b32 v136, v136, v128, s57
    v_mov_b32 v128, v11
    v_perm_b32 v11, v137, v129, s56
    v_perm_b32 v137, v137, v129, s57
    v_mov_b32 v129, v11
    v_perm_b32 v11, v138, v130, s56
    v_perm_b32 v138, v138, v130, s57
    v_mov_b32 v130, v11
    v_perm_b32 v11, v139, v131, s56
    v_perm_b32 v139, v139, v131, s57
    v_mov_b32 v131, v11
    v_perm_b32 v11, v140, v132, s56
    v_perm_b32 v140, v140, v132, s57
    v_mov_b32 v132, v11
    v_perm_b32 v11, v141, v133, s56
    v_perm_b32 v141, v141, v133, s57
    v_mov_b32 v133, v11
    v_perm_b32 v11, v142, v134, s56
    v_perm_b32 v142, v142, v134, s57
    v_mov_b32 v134, v11
    v_perm_b32 v11, v143, v135, s56
    v_perm_b32 v143, v143, v135, s57
    v_mov_b32 v135, v11
    s_mov_b32 s40, 1048576
    buffer_load_dword v192, v28, s[16:19], s40 offen
    s_mov_b32 s40, 1081344
    buffer_load_dword v200, v28, s[16:19], s40 offen
    s_mov_b32 s40, 1064960
    buffer_load_dword v193, v28, s[16:19], s40 offen
    s_mov_b32 s40, 1097728
    buffer_load_dword v201, v28, s[16:19], s40 offen
    s_mov_b32 s40, 1114112
    buffer_load_dword v194, v28, s[16:19], s40 offen
    s_mov_b32 s40, 1146880
    buffer_load_dword v202, v28, s[16:19], s40 offen
    s_mov_b32 s40, 1130496
    buffer_load_dword v195, v28, s[16:19], s40 offen
    s_mov_b32 s40, 1163264
    buffer_load_dword v203, v28, s[16:19], s40 offen
    s_mov_b32 s40, 1310720
    buffer_load_dword v196, v28, s[16:19], s40 offen
    s_mov_b32 s40, 1343488
    buffer_load_dword v204, v28, s[16:19], s40 offen
    s_mov_b32 s40, 1327104
    buffer_load_dword v197, v28, s[16:19], s40 offen
    s_mov_b32 s40, 1359872
    buffer_load_dword v205, v28, s[16:19], s40 offen
    s_mov_b32 s40, 1376256
    buffer_load_dword v198, v28, s[16:19], s40 offen
    s_mov_b32 s40, 1409024
    buffer_load_dword v206, v28, s[16:19], s40 offen
    s_mov_b32 s40, 1392640
    buffer_load_dword v199, v28, s[16:19], s40 offen
    s_mov_b32 s40, 1425408
    buffer_load_dword v207, v28, s[16:19], s40 offen
    s_waitcnt vmcnt(32)
    v_perm_b32 v11, v152, v144, s56
    v_perm_b32 v152, v152, v144, s57
    v_mov_b32 v144, v11
    v_perm_b32 v11, v153, v145, s56
    v_perm_b32 v153, v153, v145, s57
    v_mov_b32 v145, v11
    v_perm_b32 v11, v154, v146, s56
    v_perm_b32 v154, v154, v146, s57
    v_mov_b32 v146, v11
    v_perm_b32 v11, v155, v147, s56
    v_perm_b32 v155, v155, v147, s57
    v_mov_b32 v147, v11
    v_perm_b32 v11, v156, v148, s56
    v_perm_b32 v156, v156, v148, s57
    v_mov_b32 v148, v11
    v_perm_b32 v11, v157, v149, s56
    v_perm_b32 v157, v157, v149, s57
    v_mov_b32 v149, v11
    v_perm_b32 v11, v158, v150, s56
    v_perm_b32 v158, v158, v150, s57
    v_mov_b32 v150, v11
    v_perm_b32 v11, v159, v151, s56
    v_perm_b32 v159, v159, v151, s57
    v_mov_b32 v151, v11
    s_mov_b32 s40, 1572864
    buffer_load_dword v224, v28, s[12:15], s40 offen
    s_mov_b32 s40, 1605632
    buffer_load_dword v232, v28, s[12:15], s40 offen
    s_mov_b32 s40, 1589248
    buffer_load_dword v225, v28, s[12:15], s40 offen
    s_mov_b32 s40, 1622016
    buffer_load_dword v233, v28, s[12:15], s40 offen
    s_mov_b32 s40, 1638400
    buffer_load_dword v226, v28, s[12:15], s40 offen
    s_mov_b32 s40, 1671168
    buffer_load_dword v234, v28, s[12:15], s40 offen
    s_mov_b32 s40, 1654784
    buffer_load_dword v227, v28, s[12:15], s40 offen
    s_mov_b32 s40, 1687552
    buffer_load_dword v235, v28, s[12:15], s40 offen
    s_mov_b32 s40, 1835008
    buffer_load_dword v228, v28, s[12:15], s40 offen
    s_mov_b32 s40, 1867776
    buffer_load_dword v236, v28, s[12:15], s40 offen
    s_mov_b32 s40, 1851392
    buffer_load_dword v229, v28, s[12:15], s40 offen
    s_mov_b32 s40, 1884160
    buffer_load_dword v237, v28, s[12:15], s40 offen
    s_mov_b32 s40, 1900544
    buffer_load_dword v230, v28, s[12:15], s40 offen
    s_mov_b32 s40, 1933312
    buffer_load_dword v238, v28, s[12:15], s40 offen
    s_mov_b32 s40, 1916928
    buffer_load_dword v231, v28, s[12:15], s40 offen
    s_mov_b32 s40, 1949696
    buffer_load_dword v239, v28, s[12:15], s40 offen
    s_waitcnt vmcnt(32)
    v_perm_b32 v11, v184, v176, s56
    v_perm_b32 v184, v184, v176, s57
    v_mov_b32 v176, v11
    v_perm_b32 v11, v185, v177, s56
    v_perm_b32 v185, v185, v177, s57
    v_mov_b32 v177, v11
    v_perm_b32 v11, v186, v178, s56
    v_perm_b32 v186, v186, v178, s57
    v_mov_b32 v178, v11
    v_perm_b32 v11, v187, v179, s56
    v_perm_b32 v187, v187, v179, s57
    v_mov_b32 v179, v11
    v_perm_b32 v11, v188, v180, s56
    v_perm_b32 v188, v188, v180, s57
    v_mov_b32 v180, v11
    v_perm_b32 v11, v189, v181, s56
    v_perm_b32 v189, v189, v181, s57
    v_mov_b32 v181, v11
    v_perm_b32 v11, v190, v182, s56
    v_perm_b32 v190, v190, v182, s57
    v_mov_b32 v182, v11
    v_perm_b32 v11, v191, v183, s56
    v_perm_b32 v191, v191, v183, s57
    v_mov_b32 v183, v11
    s_mov_b32 s40, 1572864
    buffer_load_dword v240, v28, s[16:19], s40 offen
    s_mov_b32 s40, 1605632
    buffer_load_dword v248, v28, s[16:19], s40 offen
    s_mov_b32 s40, 1589248
    buffer_load_dword v241, v28, s[16:19], s40 offen
    s_mov_b32 s40, 1622016
    buffer_load_dword v249, v28, s[16:19], s40 offen
    s_mov_b32 s40, 1638400
    buffer_load_dword v242, v28, s[16:19], s40 offen
    s_mov_b32 s40, 1671168
    buffer_load_dword v250, v28, s[16:19], s40 offen
    s_mov_b32 s40, 1654784
    buffer_load_dword v243, v28, s[16:19], s40 offen
    s_mov_b32 s40, 1687552
    buffer_load_dword v251, v28, s[16:19], s40 offen
    s_mov_b32 s40, 1835008
    buffer_load_dword v244, v28, s[16:19], s40 offen
    s_mov_b32 s40, 1867776
    buffer_load_dword v252, v28, s[16:19], s40 offen
    s_mov_b32 s40, 1851392
    buffer_load_dword v245, v28, s[16:19], s40 offen
    s_mov_b32 s40, 1884160
    buffer_load_dword v253, v28, s[16:19], s40 offen
    s_mov_b32 s40, 1900544
    buffer_load_dword v246, v28, s[16:19], s40 offen
    s_mov_b32 s40, 1933312
    buffer_load_dword v254, v28, s[16:19], s40 offen
    s_mov_b32 s40, 1916928
    buffer_load_dword v247, v28, s[16:19], s40 offen
    s_mov_b32 s40, 1949696
    buffer_load_dword v255, v28, s[16:19], s40 offen
    s_waitcnt vmcnt(32)
    v_perm_b32 v11, v200, v192, s56
    v_perm_b32 v200, v200, v192, s57
    v_mov_b32 v192, v11
    v_perm_b32 v11, v201, v193, s56
    v_perm_b32 v201, v201, v193, s57
    v_mov_b32 v193, v11
    v_perm_b32 v11, v202, v194, s56
    v_perm_b32 v202, v202, v194, s57
    v_mov_b32 v194, v11
    v_perm_b32 v11, v203, v195, s56
    v_perm_b32 v203, v203, v195, s57
    v_mov_b32 v195, v11
    v_perm_b32 v11, v204, v196, s56
    v_perm_b32 v204, v204, v196, s57
    v_mov_b32 v196, v11
    v_perm_b32 v11, v205, v197, s56
    v_perm_b32 v205, v205, v197, s57
    v_mov_b32 v197, v11
    v_perm_b32 v11, v206, v198, s56
    v_perm_b32 v206, v206, v198, s57
    v_mov_b32 v198, v11
    v_perm_b32 v11, v207, v199, s56
    v_perm_b32 v207, v207, v199, s57
    v_mov_b32 v199, v11
    s_mov_b32 s40, 0
    buffer_load_dword v64, v28, s[8:11], s40 offen
    s_mov_b32 s40, 32768
    buffer_load_dword v72, v28, s[8:11], s40 offen
    s_mov_b32 s40, 16384
    buffer_load_dword v65, v28, s[8:11], s40 offen
    s_mov_b32 s40, 49152
    buffer_load_dword v73, v28, s[8:11], s40 offen
    s_mov_b32 s40, 65536
    buffer_load_dword v66, v28, s[8:11], s40 offen
    s_mov_b32 s40, 98304
    buffer_load_dword v74, v28, s[8:11], s40 offen
    s_mov_b32 s40, 81920
    buffer_load_dword v67, v28, s[8:11], s40 offen
    s_mov_b32 s40, 114688
    buffer_load_dword v75, v28, s[8:11], s40 offen
    s_mov_b32 s40, 262144
    buffer_load_dword v68, v28, s[8:11], s40 offen
    s_mov_b32 s40, 294912
    buffer_load_dword v76, v28, s[8:11], s40 offen
    s_mov_b32 s40, 278528
    buffer_load_dword v69, v28, s[8:11], s40 offen
    s_mov_b32 s40, 311296
    buffer_load_dword v77, v28, s[8:11], s40 offen
    s_mov_b32 s40, 327680
    buffer_load_dword v70, v28, s[8:11], s40 offen
    s_mov_b32 s40, 360448
    buffer_load_dword v78, v28, s[8:11], s40 offen
    s_mov_b32 s40, 344064
    buffer_load_dword v71, v28, s[8:11], s40 offen
    s_mov_b32 s40, 376832
    buffer_load_dword v79, v28, s[8:11], s40 offen
    s_waitcnt vmcnt(32)
    v_perm_b32 v11, v232, v224, s56
    v_perm_b32 v232, v232, v224, s57
    v_mov_b32 v224, v11
    v_perm_b32 v11, v233, v225, s56
    v_perm_b32 v233, v233, v225, s57
    v_mov_b32 v225, v11
    v_perm_b32 v11, v234, v226, s56
    v_perm_b32 v234, v234, v226, s57
    v_mov_b32 v226, v11
    v_perm_b32 v11, v235, v227, s56
    v_perm_b32 v235, v235, v227, s57
    v_mov_b32 v227, v11
    v_perm_b32 v11, v236, v228, s56
    v_perm_b32 v236, v236, v228, s57
    v_mov_b32 v228, v11
    v_perm_b32 v11, v237, v229, s56
    v_perm_b32 v237, v237, v229, s57
    v_mov_b32 v229, v11
    v_perm_b32 v11, v238, v230, s56
    v_perm_b32 v238, v238, v230, s57
    v_mov_b32 v230, v11
    v_perm_b32 v11, v239, v231, s56
    v_perm_b32 v239, v239, v231, s57
    v_mov_b32 v231, v11
    s_mov_b32 s40, 524288
    buffer_load_dword v112, v28, s[8:11], s40 offen
    s_mov_b32 s40, 557056
    buffer_load_dword v120, v28, s[8:11], s40 offen
    s_mov_b32 s40, 540672
    buffer_load_dword v113, v28, s[8:11], s40 offen
    s_mov_b32 s40, 573440
    buffer_load_dword v121, v28, s[8:11], s40 offen
    s_mov_b32 s40, 589824
    buffer_load_dword v114, v28, s[8:11], s40 offen
    s_mov_b32 s40, 622592
    buffer_load_dword v122, v28, s[8:11], s40 offen
    s_mov_b32 s40, 606208
    buffer_load_dword v115, v28, s[8:11], s40 offen
    s_mov_b32 s40, 638976
    buffer_load_dword v123, v28, s[8:11], s40 offen
    s_mov_b32 s40, 786432
    buffer_load_dword v116, v28, s[8:11], s40 offen
    s_mov_b32 s40, 819200
    buffer_load_dword v124, v28, s[8:11], s40 offen
    s_mov_b32 s40, 802816
    buffer_load_dword v117, v28, s[8:11], s40 offen
    s_mov_b32 s40, 835584
    buffer_load_dword v125, v28, s[8:11], s40 offen
    s_mov_b32 s40, 851968
    buffer_load_dword v118, v28, s[8:11], s40 offen
    s_mov_b32 s40, 884736
    buffer_load_dword v126, v28, s[8:11], s40 offen
    s_mov_b32 s40, 868352
    buffer_load_dword v119, v28, s[8:11], s40 offen
    s_mov_b32 s40, 901120
    buffer_load_dword v127, v28, s[8:11], s40 offen
    s_waitcnt vmcnt(32)
    v_perm_b32 v11, v248, v240, s56
    v_perm_b32 v248, v248, v240, s57
    v_mov_b32 v240, v11
    v_perm_b32 v11, v249, v241, s56
    v_perm_b32 v249, v249, v241, s57
    v_mov_b32 v241, v11
    v_perm_b32 v11, v250, v242, s56
    v_perm_b32 v250, v250, v242, s57
    v_mov_b32 v242, v11
    v_perm_b32 v11, v251, v243, s56
    v_perm_b32 v251, v251, v243, s57
    v_mov_b32 v243, v11
    v_perm_b32 v11, v252, v244, s56
    v_perm_b32 v252, v252, v244, s57
    v_mov_b32 v244, v11
    v_perm_b32 v11, v253, v245, s56
    v_perm_b32 v253, v253, v245, s57
    v_mov_b32 v245, v11
    v_perm_b32 v11, v254, v246, s56
    v_perm_b32 v254, v254, v246, s57
    v_mov_b32 v246, v11
    v_perm_b32 v11, v255, v247, s56
    v_perm_b32 v255, v255, v247, s57
    v_mov_b32 v247, v11
    s_mov_b32 s40, 1048576
    buffer_load_dword v160, v28, s[8:11], s40 offen
    s_mov_b32 s40, 1081344
    buffer_load_dword v168, v28, s[8:11], s40 offen
    s_mov_b32 s40, 1064960
    buffer_load_dword v161, v28, s[8:11], s40 offen
    s_mov_b32 s40, 1097728
    buffer_load_dword v169, v28, s[8:11], s40 offen
    s_mov_b32 s40, 1114112
    buffer_load_dword v162, v28, s[8:11], s40 offen
    s_mov_b32 s40, 1146880
    buffer_load_dword v170, v28, s[8:11], s40 offen
    s_mov_b32 s40, 1130496
    buffer_load_dword v163, v28, s[8:11], s40 offen
    s_mov_b32 s40, 1163264
    buffer_load_dword v171, v28, s[8:11], s40 offen
    s_mov_b32 s40, 1310720
    buffer_load_dword v164, v28, s[8:11], s40 offen
    s_mov_b32 s40, 1343488
    buffer_load_dword v172, v28, s[8:11], s40 offen
    s_mov_b32 s40, 1327104
    buffer_load_dword v165, v28, s[8:11], s40 offen
    s_mov_b32 s40, 1359872
    buffer_load_dword v173, v28, s[8:11], s40 offen
    s_mov_b32 s40, 1376256
    buffer_load_dword v166, v28, s[8:11], s40 offen
    s_mov_b32 s40, 1409024
    buffer_load_dword v174, v28, s[8:11], s40 offen
    s_mov_b32 s40, 1392640
    buffer_load_dword v167, v28, s[8:11], s40 offen
    s_mov_b32 s40, 1425408
    buffer_load_dword v175, v28, s[8:11], s40 offen
    s_waitcnt vmcnt(32)
    v_perm_b32 v11, v72, v64, s56
    v_perm_b32 v72, v72, v64, s57
    v_mov_b32 v64, v11
    v_perm_b32 v11, v73, v65, s56
    v_perm_b32 v73, v73, v65, s57
    v_mov_b32 v65, v11
    v_perm_b32 v11, v74, v66, s56
    v_perm_b32 v74, v74, v66, s57
    v_mov_b32 v66, v11
    v_perm_b32 v11, v75, v67, s56
    v_perm_b32 v75, v75, v67, s57
    v_mov_b32 v67, v11
    v_perm_b32 v11, v76, v68, s56
    v_perm_b32 v76, v76, v68, s57
    v_mov_b32 v68, v11
    v_perm_b32 v11, v77, v69, s56
    v_perm_b32 v77, v77, v69, s57
    v_mov_b32 v69, v11
    v_perm_b32 v11, v78, v70, s56
    v_perm_b32 v78, v78, v70, s57
    v_mov_b32 v70, v11
    v_perm_b32 v11, v79, v71, s56
    v_perm_b32 v79, v79, v71, s57
    v_mov_b32 v71, v11
    s_mov_b32 s40, 1572864
    buffer_load_dword v208, v28, s[8:11], s40 offen
    s_mov_b32 s40, 1605632
    buffer_load_dword v216, v28, s[8:11], s40 offen
    s_mov_b32 s40, 1589248
    buffer_load_dword v209, v28, s[8:11], s40 offen
    s_mov_b32 s40, 1622016
    buffer_load_dword v217, v28, s[8:11], s40 offen
    s_mov_b32 s40, 1638400
    buffer_load_dword v210, v28, s[8:11], s40 offen
    s_mov_b32 s40, 1671168
    buffer_load_dword v218, v28, s[8:11], s40 offen
    s_mov_b32 s40, 1654784
    buffer_load_dword v211, v28, s[8:11], s40 offen
    s_mov_b32 s40, 1687552
    buffer_load_dword v219, v28, s[8:11], s40 offen
    s_mov_b32 s40, 1835008
    buffer_load_dword v212, v28, s[8:11], s40 offen
    s_mov_b32 s40, 1867776
    buffer_load_dword v220, v28, s[8:11], s40 offen
    s_mov_b32 s40, 1851392
    buffer_load_dword v213, v28, s[8:11], s40 offen
    s_mov_b32 s40, 1884160
    buffer_load_dword v221, v28, s[8:11], s40 offen
    s_mov_b32 s40, 1900544
    buffer_load_dword v214, v28, s[8:11], s40 offen
    s_mov_b32 s40, 1933312
    buffer_load_dword v222, v28, s[8:11], s40 offen
    s_mov_b32 s40, 1916928
    buffer_load_dword v215, v28, s[8:11], s40 offen
    s_mov_b32 s40, 1949696
    buffer_load_dword v223, v28, s[8:11], s40 offen
    s_waitcnt vmcnt(32)
    v_perm_b32 v11, v120, v112, s56
    v_perm_b32 v120, v120, v112, s57
    v_mov_b32 v112, v11
    v_perm_b32 v11, v121, v113, s56
    v_perm_b32 v121, v121, v113, s57
    v_mov_b32 v113, v11
    v_perm_b32 v11, v122, v114, s56
    v_perm_b32 v122, v122, v114, s57
    v_mov_b32 v114, v11
    v_perm_b32 v11, v123, v115, s56
    v_perm_b32 v123, v123, v115, s57
    v_mov_b32 v115, v11
    v_perm_b32 v11, v124, v116, s56
    v_perm_b32 v124, v124, v116, s57
    v_mov_b32 v116, v11
    v_perm_b32 v11, v125, v117, s56
    v_perm_b32 v125, v125, v117, s57
    v_mov_b32 v117, v11
    v_perm_b32 v11, v126, v118, s56
    v_perm_b32 v126, v126, v118, s57
    v_mov_b32 v118, v11
    v_perm_b32 v11, v127, v119, s56
    v_perm_b32 v127, v127, v119, s57
    v_mov_b32 v119, v11
    s_waitcnt vmcnt(16)
    v_perm_b32 v11, v168, v160, s56
    v_perm_b32 v168, v168, v160, s57
    v_mov_b32 v160, v11
    v_perm_b32 v11, v169, v161, s56
    v_perm_b32 v169, v169, v161, s57
    v_mov_b32 v161, v11
    v_perm_b32 v11, v170, v162, s56
    v_perm_b32 v170, v170, v162, s57
    v_mov_b32 v162, v11
    v_perm_b32 v11, v171, v163, s56
    v_perm_b32 v171, v171, v163, s57
    v_mov_b32 v163, v11
    v_perm_b32 v11, v172, v164, s56
    v_perm_b32 v172, v172, v164, s57
    v_mov_b32 v164, v11
    v_perm_b32 v11, v173, v165, s56
    v_perm_b32 v173, v173, v165, s57
    v_mov_b32 v165, v11
    v_perm_b32 v11, v174, v166, s56
    v_perm_b32 v174, v174, v166, s57
    v_mov_b32 v166, v11
    v_perm_b32 v11, v175, v167, s56
    v_perm_b32 v175, v175, v167, s57
    v_mov_b32 v167, v11
    s_waitcnt vmcnt(0)
    v_perm_b32 v11, v216, v208, s56
    v_perm_b32 v216, v216, v208, s57
    v_mov_b32 v208, v11
    v_perm_b32 v11, v217, v209, s56
    v_perm_b32 v217, v217, v209, s57
    v_mov_b32 v209, v11
    v_perm_b32 v11, v218, v210, s56
    v_perm_b32 v218, v218, v210, s57
    v_mov_b32 v210, v11
    v_perm_b32 v11, v219, v211, s56
    v_perm_b32 v219, v219, v211, s57
    v_mov_b32 v211, v11
    v_perm_b32 v11, v220, v212, s56
    v_perm_b32 v220, v220, v212, s57
    v_mov_b32 v212, v11
    v_perm_b32 v11, v221, v213, s56
    v_perm_b32 v221, v221, v213, s57
    v_mov_b32 v213, v11
    v_perm_b32 v11, v222, v214, s56
    v_perm_b32 v222, v222, v214, s57
    v_mov_b32 v214, v11
    v_perm_b32 v11, v223, v215, s56
    v_perm_b32 v223, v223, v215, s57
    v_mov_b32 v215, v11
    s_barrier
    v_mov_b32 v25, 163824
    ds_read_b32 v25, v25 offset:4
    s_mov_b32 s28, 0
    s_mov_b32 s48, 400000
    s_waitcnt lgkmcnt(0)
    v_readfirstlane_b32 s29, v25
    s_nop 3
    s_bfe_u32 s27, s29, 0x10008
    s_add_u32 s30, s28, 0
    s_and_b32 s30, s30, 3
    s_lshl_b32 s30, s30, 18
    s_add_u32 s30, s30, 96468992
    s_mov_b32 s64, 64
    s_mov_b32 s56, 0x00ff00ff
    s_mov_b32 s57, 0x00ff00ff
    s_setprio 3
    s_cmp_lg_u32 s27, 0
    s_cbranch_scc1 An_entry
    s_branch Al_entry
    .p2align 6
Al_o3:
    v_smfmac_f32_16x16x64_bf16 v[24:27], v[60:63], v[208:215], v1
    s_nop 0
    v_smfmac_f32_16x16x64_bf16 v[28:31], v[60:63], v[216:223], v1
    v_smfmac_f32_16x16x64_bf16 v[32:35], v[60:63], v[224:231], v1
    v_smfmac_f32_16x16x64_bf16 v[36:39], v[60:63], v[232:239], v1
Al_tail:
    v_smfmac_f32_16x16x64_bf16 v[40:43], v[48:51], v[96:103], v1
    v_smfmac_f32_16x16x64_bf16 v[44:47], v[48:51], v[104:111], v1
    s_nop 1
    v_add_f32 v24, v24, v26
    v_add_f32 v26, v25, v27
    v_smfmac_f32_16x16x64_bf16 v[40:43], v[52:55], v[144:151], v1
    v_add_f32 v25, v28, v30
    v_add_f32 v27, v29, v31
    v_smfmac_f32_16x16x64_bf16 v[44:47], v[52:55], v[152:159], v1
    ds_write2_b64 v6, v[24:25], v[26:27] offset0:0 offset1:4
    v_smfmac_f32_16x16x64_bf16 v[40:43], v[56:59], v[192:199], v1
    v_add_f32 v32, v32, v34
    v_add_f32 v34, v33, v35
    v_smfmac_f32_16x16x64_bf16 v[44:47], v[56:59], v[200:207], v1
    v_add_f32 v33, v36, v38
    v_add_f32 v35, v37, v39
    v_smfmac_f32_16x16x64_bf16 v[40:43], v[60:63], v[240:247], v1
    ds_write2_b64 v6, v[32:33], v[34:35] offset0:8 offset1:12
    v_smfmac_f32_16x16x64_bf16 v[44:47], v[60:63], v[248:255], v1
    s_nop 5
    v_add_f32 v40, v40, v42
    v_add_f32 v42, v41, v43
    v_add_f32 v41, v44, v46
    v_add_f32 v43, v45, v47
    ds_write2_b64 v20, v[40:41], v[42:43] offset0:0 offset1:4
    s_setprio 0
    s_cmp_ge_u32 s60, 2
    s_waitcnt vmcnt(0) lgkmcnt(0)
    s_barrier
    s_cbranch_scc1 Al_v2
    ds_read_b64 v[48:49], v0 offset:0
    ds_read_b64 v[50:51], v0 offset:3264
    ds_read_b64 v[52:53], v0 offset:6528
    ds_read_b64 v[54:55], v0 offset:9792
    s_waitcnt lgkmcnt(2)
    v_pk_add_f32 v[48:49], v[48:49], v[50:51]
    s_waitcnt lgkmcnt(0)
    v_pk_add_f32 v[52:53], v[52:53], v[54:55]
    v_pk_add_f32 v[48:49], v[48:49], v[52:53]
    v_cvt_pk_bf16_f32 v12, v48, v49
    buffer_store_dword v12, v14, s[4:7], s30 offen
Al_v2:
    s_lshl_b32 s59, s28, 17
    s_add_u32 s59, s59, 37748736
    s_cmp_lg_u32 s60, 3
    s_cbranch_scc1 Al_nf
    s_mov_b32 s35, s28
    s_atomic_smax s35, s[4:5], s51
Al_nf:
    s_cmp_eq_u32 s28, 63
    s_cbranch_scc1 L_rec_lastA
    s_add_u32 s49, s28, 3
    s_and_b32 s49, s49, 3
    s_lshl_b32 s49, s49, 18
    s_add_u32 s49, s49, 96468992
    s_lshr_b32 s47, s28, 3
    s_lshr_b32 s47, s29, s47
    s_and_b32 s47, s47, 1
    s_lshl_b32 s47, s47, 13
    s_lshl_b32 s31, s28, 18
    s_add_u32 s31, s31, s47
    s_add_u32 s31, s31, 100663296
    s_add_u32 s66, s31, 16777216
    s_add_u32 s30, s28, 1
    s_and_b32 s30, s30, 3
    s_lshl_b32 s30, s30, 18
    s_add_u32 s30, s30, 96468992
    s_add_u32 s68, s28, 1
    s_lshl_b32 s68, s68, 19
    s_add_u32 s69, s68, 532480
    s_cmp_ge_i32 s28, 62
    s_cselect_b32 s69, 2146435056, s69
    s_mov_b32 s48, 400000
    s_lshl_b32 s33, s28, 2
    s_add_u32 s33, s33, 4
    s_sleep 6
    v_mov_b32 v48, -1
    v_mov_b32 v49, -1
    v_mov_b32 v50, -1
    v_mov_b32 v51, -1
    s_setprio 3
Al_wb:
    ds_read_b32 v11, v10 offset:0
    s_sub_u32 s48, s48, 1
    s_cbranch_scc1 L_abort
    s_waitcnt lgkmcnt(0)
    v_cmp_gt_u32 vcc, s33, v11
    s_cbranch_vccnz Al_wb
    s_cmp_ge_u32 s60, 2
    s_cbranch_scc1 Al_h2
    buffer_store_dwordx4 v[48:51], v9, s[4:7], s49 offen
Al_h2:
    buffer_load_dwordx4 v[24:27], v8, s[4:7], s68 offen offset:0 sc1
    buffer_load_dwordx4 v[28:31], v8, s[4:7], s68 offen offset:1024 sc1
    buffer_load_dwordx4 v[32:35], v8, s[4:7], s68 offen offset:2048 sc1
    buffer_load_dwordx4 v[36:39], v8, s[4:7], s68 offen offset:3072 sc1
    buffer_load_dwordx4 v[40:43], v8, s[4:7], s69 offen offset:0 sc1
    buffer_load_dwordx4 v[44:47], v8, s[4:7], s69 offen offset:1024 sc1
    buffer_load_dwordx4 v[56:59], v8, s[4:7], s69 offen offset:2048 sc1
    buffer_load_dwordx4 v[60:63], v8, s[4:7], s69 offen offset:3072 sc1
    s_add_u32 s28, s28, 1
    s_mov_b32 s48, 400000
    s_barrier
    ds_read_b64 v[48:49], v7 offset:0
    ds_read_b64 v[50:51], v7 offset:2304
    ds_read_b64 v[52:53], v7 offset:4608
    ds_read_b64 v[54:55], v7 offset:6912
    s_waitcnt lgkmcnt(2)
    v_pk_add_f32 v[48:49], v[48:49], v[50:51]
    s_waitcnt lgkmcnt(0)
    v_pk_add_f32 v[52:53], v[52:53], v[54:55]
    v_pk_add_f32 v[48:49], v[48:49], v[52:53]
    v_cvt_pk_bf16_f32 v11, v48, v49
    buffer_store_dword v11, v5, s[4:7], s31 offen sc1
    buffer_store_dword v12, v13, s[4:7], s59 offen sc1
    s_nop 15
    s_nop 15
    s_nop 15
    s_nop 15
    s_nop 15
    buffer_load_dwordx4 v[48:51], v4, s[4:7], s31 offen sc1
    s_waitcnt vmcnt(3)
    ds_write_b128 v15, v[24:27] offset:0
    ds_write_b128 v15, v[28:31] offset:1024
    ds_write_b128 v15, v[32:35] offset:2048
    ds_write_b128 v15, v[36:39] offset:3072
    ds_write_b128 v15, v[40:43] offset:4096
    ds_write_b128 v15, v[44:47] offset:5120
    ds_write_b128 v15, v[56:59] offset:6144
    ds_write_b128 v15, v[60:63] offset:7168
    s_waitcnt vmcnt(0)
Al_r3:
    v_mfma_f32_16x16x32_bf16 v[52:55], v[16:19], v[48:51], 0
    v_max3_u32 v11, v48, v49, v50
    v_max_u32 v11, v11, v51
    v_cmp_eq_u32 vcc, -1, v11
    s_cbranch_vccnz Al_slow3
Al_r4:
    s_nop 3
    v_add_f32_dpp v52, v52, v52 row_ror:8 row_mask:0xf bank_mask:0xf
    v_add_f32_dpp v53, v53, v53 row_ror:8 row_mask:0xf bank_mask:0xf
    v_cvt_pk_bf16_f32 v12, v52, v53
    buffer_store_dword v12, v3, s[4:7], s30 offen
Al_entry:
    s_waitcnt lgkmcnt(0)
    v_mov_b64 v[24:25], 0
    v_mov_b64 v[26:27], 0
    v_mov_b64 v[28:29], 0
    v_mov_b64 v[30:31], 0
    v_mov_b64 v[32:33], 0
    v_mov_b64 v[34:35], 0
    v_mov_b64 v[36:37], 0
    v_mov_b64 v[38:39], 0
    v_mov_b64 v[40:41], 0
    v_mov_b64 v[42:43], 0
    v_mov_b64 v[44:45], 0
    v_mov_b64 v[46:47], 0
    s_cmp_le_u32 s28, 54
    s_cbranch_scc1 Al_t6
    ds_add_u32 v22, v23 offset:256
Al_t6:
    s_nop 15
    s_nop 1
    buffer_load_dwordx4 v[48:51], v2, s[4:7], s30 offen offset:0 sc1
    s_nop 10
    buffer_load_dwordx4 v[52:55], v2, s[4:7], s30 offen offset:1024 sc1
    s_nop 10
    buffer_load_dwordx4 v[56:59], v2, s[4:7], s30 offen offset:2048 sc1
    s_nop 10
    buffer_load_dwordx4 v[60:63], v2, s[4:7], s30 offen offset:3072 sc1
    s_waitcnt vmcnt(3)
    v_smfmac_f32_16x16x64_bf16 v[24:27], v[48:51], v[64:71], v1
    v_max3_u32 v11, v48, v49, v50
    v_smfmac_f32_16x16x64_bf16 v[28:31], v[48:51], v[72:79], v1
    v_max_u32 v11, v11, v51
    v_cmp_eq_u32 vcc, -1, v11
    v_smfmac_f32_16x16x64_bf16 v[32:35], v[48:51], v[80:87], v1
    v_smfmac_f32_16x16x64_bf16 v[36:39], v[48:51], v[88:95], v1
    s_cbranch_vccnz Al_z
    s_waitcnt vmcnt(2)
    v_max3_u32 v11, v52, v53, v54
    v_max_u32 v11, v11, v55
    v_cmp_eq_u32 vcc, -1, v11
    s_cbranch_vccnz Al_f123
    v_smfmac_f32_16x16x64_bf16 v[24:27], v[52:55], v[112:119], v1
    s_waitcnt vmcnt(1)
    v_max3_u32 v11, v56, v57, v58
    v_smfmac_f32_16x16x64_bf16 v[28:31], v[52:55], v[120:127], v1
    v_max_u32 v11, v11, v59
    v_cmp_eq_u32 vcc, -1, v11
    v_smfmac_f32_16x16x64_bf16 v[32:35], v[52:55], v[128:135], v1
    v_smfmac_f32_16x16x64_bf16 v[36:39], v[52:55], v[136:143], v1
    s_cbranch_vccnz Al_f23
    v_smfmac_f32_16x16x64_bf16 v[24:27], v[56:59], v[160:167], v1
    s_waitcnt vmcnt(0)
    v_max3_u32 v11, v60, v61, v62
    v_smfmac_f32_16x16x64_bf16 v[28:31], v[56:59], v[168:175], v1
    v_max_u32 v11, v11, v63
    v_cmp_eq_u32 vcc, -1, v11
    v_smfmac_f32_16x16x64_bf16 v[32:35], v[56:59], v[176:183], v1
    v_smfmac_f32_16x16x64_bf16 v[36:39], v[56:59], v[184:191], v1
    s_cbranch_vccz Al_o3
    s_branch Al_f3
Al_f3012:
    buffer_load_dwordx4 v[60:63], v2, s[4:7], s30 offen offset:3072 sc1
    s_sub_u32 s48, s48, 1
    s_cbranch_scc1 L_abort
    s_waitcnt vmcnt(3)
    v_max3_u32 v11, v48, v49, v50
    v_max_u32 v11, v11, v51
    v_cmp_eq_u32 vcc, -1, v11
    s_cbranch_vccnz Al_f0123
Al_o0123:
    v_smfmac_f32_16x16x64_bf16 v[24:27], v[48:51], v[64:71], v1
    s_waitcnt vmcnt(2)
    v_max3_u32 v11, v52, v53, v54
    v_smfmac_f32_16x16x64_bf16 v[28:31], v[48:51], v[72:79], v1
    v_max_u32 v11, v11, v55
    v_cmp_eq_u32 vcc, -1, v11
    v_smfmac_f32_16x16x64_bf16 v[32:35], v[48:51], v[80:87], v1
    v_smfmac_f32_16x16x64_bf16 v[36:39], v[48:51], v[88:95], v1
    s_cbranch_vccz Al_o123
    s_branch Al_f123
Al_f312:
    buffer_load_dwordx4 v[60:63], v2, s[4:7], s30 offen offset:3072 sc1
    s_sub_u32 s48, s48, 1
    s_cbranch_scc1 L_abort
    s_waitcnt vmcnt(2)
    v_max3_u32 v11, v52, v53, v54
    v_max_u32 v11, v11, v55
    v_cmp_eq_u32 vcc, -1, v11
    s_cbranch_vccnz Al_f123
Al_o123:
    v_smfmac_f32_16x16x64_bf16 v[24:27], v[52:55], v[112:119], v1
    s_waitcnt vmcnt(1)
    v_max3_u32 v11, v56, v57, v58
    v_smfmac_f32_16x16x64_bf16 v[28:31], v[52:55], v[120:127], v1
    v_max_u32 v11, v11, v59
    v_cmp_eq_u32 vcc, -1, v11
    v_smfmac_f32_16x16x64_bf16 v[32:35], v[52:55], v[128:135], v1
    v_smfmac_f32_16x16x64_bf16 v[36:39], v[52:55], v[136:143], v1
    s_cbranch_vccz Al_o23
    s_branch Al_f23
Al_f32:
    buffer_load_dwordx4 v[60:63], v2, s[4:7], s30 offen offset:3072 sc1
    s_sub_u32 s48, s48, 1
    s_cbranch_scc1 L_abort
    s_waitcnt vmcnt(1)
    v_max3_u32 v11, v56, v57, v58
    v_max_u32 v11, v11, v59
    v_cmp_eq_u32 vcc, -1, v11
    s_cbranch_vccnz Al_f23
Al_o23:
    v_smfmac_f32_16x16x64_bf16 v[24:27], v[56:59], v[160:167], v1
    s_waitcnt vmcnt(0)
    v_max3_u32 v11, v60, v61, v62
    v_smfmac_f32_16x16x64_bf16 v[28:31], v[56:59], v[168:175], v1
    v_max_u32 v11, v11, v63
    v_cmp_eq_u32 vcc, -1, v11
    v_smfmac_f32_16x16x64_bf16 v[32:35], v[56:59], v[176:183], v1
    v_smfmac_f32_16x16x64_bf16 v[36:39], v[56:59], v[184:191], v1
    s_cbranch_vccz Al_o3
    s_branch Al_f3
Al_f0123:
    buffer_load_dwordx4 v[48:51], v2, s[4:7], s30 offen offset:0 sc1
    s_sub_u32 s48, s48, 1
    s_cbranch_scc1 L_abort
    s_waitcnt vmcnt(3)
    v_max3_u32 v11, v52, v53, v54
    v_max_u32 v11, v11, v55
    v_cmp_eq_u32 vcc, -1, v11
    s_cbranch_vccnz Al_f1230
Al_o1230:
    v_smfmac_f32_16x16x64_bf16 v[24:27], v[52:55], v[112:119], v1
    s_waitcnt vmcnt(2)
    v_max3_u32 v11, v56, v57, v58
    v_smfmac_f32_16x16x64_bf16 v[28:31], v[52:55], v[120:127], v1
    v_max_u32 v11, v11, v59
    v_cmp_eq_u32 vcc, -1, v11
    v_smfmac_f32_16x16x64_bf16 v[32:35], v[52:55], v[128:135], v1
    v_smfmac_f32_16x16x64_bf16 v[36:39], v[52:55], v[136:143], v1
    s_cbranch_vccz Al_o230
    s_branch Al_f230
Al_f023:
    buffer_load_dwordx4 v[48:51], v2, s[4:7], s30 offen offset:0 sc1
    s_sub_u32 s48, s48, 1
    s_cbranch_scc1 L_abort
    s_waitcnt vmcnt(2)
    v_max3_u32 v11, v56, v57, v58
    v_max_u32 v11, v11, v59
    v_cmp_eq_u32 vcc, -1, v11
    s_cbranch_vccnz Al_f230
Al_o230:
    v_smfmac_f32_16x16x64_bf16 v[24:27], v[56:59], v[160:167], v1
    s_waitcnt vmcnt(1)
    v_max3_u32 v11, v60, v61, v62
    v_smfmac_f32_16x16x64_bf16 v[28:31], v[56:59], v[168:175], v1
    v_max_u32 v11, v11, v63
    v_cmp_eq_u32 vcc, -1, v11
    v_smfmac_f32_16x16x64_bf16 v[32:35], v[56:59], v[176:183], v1
    v_smfmac_f32_16x16x64_bf16 v[36:39], v[56:59], v[184:191], v1
    s_cbranch_vccz Al_o30
    s_branch Al_f30
Al_f03:
    buffer_load_dwordx4 v[48:51], v2, s[4:7], s30 offen offset:0 sc1
    s_sub_u32 s48, s48, 1
    s_cbranch_scc1 L_abort
    s_waitcnt vmcnt(1)
    v_max3_u32 v11, v60, v61, v62
    v_max_u32 v11, v11, v63
    v_cmp_eq_u32 vcc, -1, v11
    s_cbranch_vccnz Al_f30
Al_o30:
    v_smfmac_f32_16x16x64_bf16 v[24:27], v[60:63], v[208:215], v1
    s_waitcnt vmcnt(0)
    v_max3_u32 v11, v48, v49, v50
    v_smfmac_f32_16x16x64_bf16 v[28:31], v[60:63], v[216:223], v1
    v_max_u32 v11, v11, v51
    v_cmp_eq_u32 vcc, -1, v11
    v_smfmac_f32_16x16x64_bf16 v[32:35], v[60:63], v[224:231], v1
    v_smfmac_f32_16x16x64_bf16 v[36:39], v[60:63], v[232:239], v1
    s_cbranch_vccz Al_o0
    s_branch Al_f0
Al_f1230:
    buffer_load_dwordx4 v[52:55], v2, s[4:7], s30 offen offset:1024 sc1
    s_sub_u32 s48, s48, 1
    s_cbranch_scc1 L_abort
    s_waitcnt vmcnt(3)
    v_max3_u32 v11, v56, v57, v58
    v_max_u32 v11, v11, v59
    v_cmp_eq_u32 vcc, -1, v11
    s_cbranch_vccnz Al_f2301
Al_o2301:
    v_smfmac_f32_16x16x64_bf16 v[24:27], v[56:59], v[160:167], v1
    s_waitcnt vmcnt(2)
    v_max3_u32 v11, v60, v61, v62
    v_smfmac_f32_16x16x64_bf16 v[28:31], v[56:59], v[168:175], v1
    v_max_u32 v11, v11, v63
    v_cmp_eq_u32 vcc, -1, v11
    v_smfmac_f32_16x16x64_bf16 v[32:35], v[56:59], v[176:183], v1
    v_smfmac_f32_16x16x64_bf16 v[36:39], v[56:59], v[184:191], v1
    s_cbranch_vccz Al_o301
    s_branch Al_f301
Al_f130:
    buffer_load_dwordx4 v[52:55], v2, s[4:7], s30 offen offset:1024 sc1
    s_sub_u32 s48, s48, 1
    s_cbranch_scc1 L_abort
    s_waitcnt vmcnt(2)
    v_max3_u32 v11, v60, v61, v62
    v_max_u32 v11, v11, v63
    v_cmp_eq_u32 vcc, -1, v11
    s_cbranch_vccnz Al_f301
Al_o301:
    v_smfmac_f32_16x16x64_bf16 v[24:27], v[60:63], v[208:215], v1
    s_waitcnt vmcnt(1)
    v_max3_u32 v11, v48, v49, v50
    v_smfmac_f32_16x16x64_bf16 v[28:31], v[60:63], v[216:223], v1
    v_max_u32 v11, v11, v51
    v_cmp_eq_u32 vcc, -1, v11
    v_smfmac_f32_16x16x64_bf16 v[32:35], v[60:63], v[224:231], v1
    v_smfmac_f32_16x16x64_bf16 v[36:39], v[60:63], v[232:239], v1
    s_cbranch_vccz Al_o01
    s_branch Al_f01
Al_f10:
    buffer_load_dwordx4 v[52:55], v2, s[4:7], s30 offen offset:1024 sc1
    s_sub_u32 s48, s48, 1
    s_cbranch_scc1 L_abort
    s_waitcnt vmcnt(1)
    v_max3_u32 v11, v48, v49, v50
    v_max_u32 v11, v11, v51
    v_cmp_eq_u32 vcc, -1, v11
    s_cbranch_vccnz Al_f01
Al_o01:
    v_smfmac_f32_16x16x64_bf16 v[24:27], v[48:51], v[64:71], v1
    s_waitcnt vmcnt(0)
    v_max3_u32 v11, v52, v53, v54
    v_smfmac_f32_16x16x64_bf16 v[28:31], v[48:51], v[72:79], v1
    v_max_u32 v11, v11, v55
    v_cmp_eq_u32 vcc, -1, v11
    v_smfmac_f32_16x16x64_bf16 v[32:35], v[48:51], v[80:87], v1
    v_smfmac_f32_16x16x64_bf16 v[36:39], v[48:51], v[88:95], v1
    s_cbranch_vccz Al_o1
    s_branch Al_f1
Al_f2301:
    buffer_load_dwordx4 v[56:59], v2, s[4:7], s30 offen offset:2048 sc1
    s_sub_u32 s48, s48, 1
    s_cbranch_scc1 L_abort
    s_waitcnt vmcnt(3)
    v_max3_u32 v11, v60, v61, v62
    v_max_u32 v11, v11, v63
    v_cmp_eq_u32 vcc, -1, v11
    s_cbranch_vccnz Al_f3012
Al_o3012:
    v_smfmac_f32_16x16x64_bf16 v[24:27], v[60:63], v[208:215], v1
    s_waitcnt vmcnt(2)
    v_max3_u32 v11, v48, v49, v50
    v_smfmac_f32_16x16x64_bf16 v[28:31], v[60:63], v[216:223], v1
    v_max_u32 v11, v11, v51
    v_cmp_eq_u32 vcc, -1, v11
    v_smfmac_f32_16x16x64_bf16 v[32:35], v[60:63], v[224:231], v1
    v_smfmac_f32_16x16x64_bf16 v[36:39], v[60:63], v[232:239], v1
    s_cbranch_vccz Al_o012
    s_branch Al_f012
Al_f201:
    buffer_load_dwordx4 v[56:59], v2, s[4:7], s30 offen offset:2048 sc1
    s_sub_u32 s48, s48, 1
    s_cbranch_scc1 L_abort
    s_waitcnt vmcnt(2)
    v_max3_u32 v11, v48, v49, v50
    v_max_u32 v11, v11, v51
    v_cmp_eq_u32 vcc, -1, v11
    s_cbranch_vccnz Al_f012
Al_o012:
    v_smfmac_f32_16x16x64_bf16 v[24:27], v[48:51], v[64:71], v1
    s_waitcnt vmcnt(1)
    v_max3_u32 v11, v52, v53, v54
    v_smfmac_f32_16x16x64_bf16 v[28:31], v[48:51], v[72:79], v1
    v_max_u32 v11, v11, v55
    v_cmp_eq_u32 vcc, -1, v11
    v_smfmac_f32_16x16x64_bf16 v[32:35], v[48:51], v[80:87], v1
    v_smfmac_f32_16x16x64_bf16 v[36:39], v[48:51], v[88:95], v1
    s_cbranch_vccz Al_o12
    s_branch Al_f12
Al_f21:
    buffer_load_dwordx4 v[56:59], v2, s[4:7], s30 offen offset:2048 sc1
    s_sub_u32 s48, s48, 1
    s_cbranch_scc1 L_abort
    s_waitcnt vmcnt(1)
    v_max3_u32 v11, v52, v53, v54
    v_max_u32 v11, v11, v55
    v_cmp_eq_u32 vcc, -1, v11
    s_cbranch_vccnz Al_f12
Al_o12:
    v_smfmac_f32_16x16x64_bf16 v[24:27], v[52:55], v[112:119], v1
    s_waitcnt vmcnt(0)
    v_max3_u32 v11, v56, v57, v58
    v_smfmac_f32_16x16x64_bf16 v[28:31], v[52:55], v[120:127], v1
    v_max_u32 v11, v11, v59
    v_cmp_eq_u32 vcc, -1, v11
    v_smfmac_f32_16x16x64_bf16 v[32:35], v[52:55], v[128:135], v1
    v_smfmac_f32_16x16x64_bf16 v[36:39], v[52:55], v[136:143], v1
    s_cbranch_vccz Al_o2
    s_branch Al_f2
Al_f012:
    buffer_load_dwordx4 v[48:51], v2, s[4:7], s30 offen offset:0 sc1
    s_sub_u32 s48, s48, 1
    s_cbranch_scc1 L_abort
    s_waitcnt vmcnt(2)
    v_max3_u32 v11, v52, v53, v54
    v_max_u32 v11, v11, v55
    v_cmp_eq_u32 vcc, -1, v11
    s_cbranch_vccnz Al_f120
Al_o120:
    v_smfmac_f32_16x16x64_bf16 v[24:27], v[52:55], v[112:119], v1
    s_waitcnt vmcnt(1)
    v_max3_u32 v11, v56, v57, v58
    v_smfmac_f32_16x16x64_bf16 v[28:31], v[52:55], v[120:127], v1
    v_max_u32 v11, v11, v59
    v_cmp_eq_u32 vcc, -1, v11
    v_smfmac_f32_16x16x64_bf16 v[32:35], v[52:55], v[128:135], v1
    v_smfmac_f32_16x16x64_bf16 v[36:39], v[52:55], v[136:143], v1
    s_cbranch_vccz Al_o20
    s_branch Al_f20
Al_f120:
    buffer_load_dwordx4 v[52:55], v2, s[4:7], s30 offen offset:1024 sc1
    s_sub_u32 s48, s48, 1
    s_cbranch_scc1 L_abort
    s_waitcnt vmcnt(2)
    v_max3_u32 v11, v56, v57, v58
    v_max_u32 v11, v11, v59
    v_cmp_eq_u32 vcc, -1, v11
    s_cbranch_vccnz Al_f201
Al_o201:
    v_smfmac_f32_16x16x64_bf16 v[24:27], v[56:59], v[160:167], v1
    s_waitcnt vmcnt(1)
    v_max3_u32 v11, v48, v49, v50
    v_smfmac_f32_16x16x64_bf16 v[28:31], v[56:59], v[168:175], v1
    v_max_u32 v11, v11, v51
    v_cmp_eq_u32 vcc, -1, v11
    v_smfmac_f32_16x16x64_bf16 v[32:35], v[56:59], v[176:183], v1
    v_smfmac_f32_16x16x64_bf16 v[36:39], v[56:59], v[184:191], v1
    s_cbranch_vccz Al_o01
    s_branch Al_f01
Al_f301:
    buffer_load_dwordx4 v[60:63], v2, s[4:7], s30 offen offset:3072 sc1
    s_sub_u32 s48, s48, 1
    s_cbranch_scc1 L_abort
    s_waitcnt vmcnt(2)
    v_max3_u32 v11, v48, v49, v50
    v_max_u32 v11, v11, v51
    v_cmp_eq_u32 vcc, -1, v11
    s_cbranch_vccnz Al_f013
Al_o013:
    v_smfmac_f32_16x16x64_bf16 v[24:27], v[48:51], v[64:71], v1
    s_waitcnt vmcnt(1)
    v_max3_u32 v11, v52, v53, v54
    v_smfmac_f32_16x16x64_bf16 v[28:31], v[48:51], v[72:79], v1
    v_max_u32 v11, v11, v55
    v_cmp_eq_u32 vcc, -1, v11
    v_smfmac_f32_16x16x64_bf16 v[32:35], v[48:51], v[80:87], v1
    v_smfmac_f32_16x16x64_bf16 v[36:39], v[48:51], v[88:95], v1
    s_cbranch_vccz Al_o13
    s_branch Al_f13
Al_f013:
    buffer_load_dwordx4 v[48:51], v2, s[4:7], s30 offen offset:0 sc1
    s_sub_u32 s48, s48, 1
    s_cbranch_scc1 L_abort
    s_waitcnt vmcnt(2)
    v_max3_u32 v11, v52, v53, v54
    v_max_u32 v11, v11, v55
    v_cmp_eq_u32 vcc, -1, v11
    s_cbranch_vccnz Al_f130
Al_o130:
    v_smfmac_f32_16x16x64_bf16 v[24:27], v[52:55], v[112:119], v1
    s_waitcnt vmcnt(1)
    v_max3_u32 v11, v60, v61, v62
    v_smfmac_f32_16x16x64_bf16 v[28:31], v[52:55], v[120:127], v1
    v_max_u32 v11, v11, v63
    v_cmp_eq_u32 vcc, -1, v11
    v_smfmac_f32_16x16x64_bf16 v[32:35], v[52:55], v[128:135], v1
    v_smfmac_f32_16x16x64_bf16 v[36:39], v[52:55], v[136:143], v1
    s_cbranch_vccz Al_o30
    s_branch Al_f30
Al_f302:
    buffer_load_dwordx4 v[60:63], v2, s[4:7], s30 offen offset:3072 sc1
    s_sub_u32 s48, s48, 1
    s_cbranch_scc1 L_abort
    s_waitcnt vmcnt(2)
    v_max3_u32 v11, v48, v49, v50
    v_max_u32 v11, v11, v51
    v_cmp_eq_u32 vcc, -1, v11
    s_cbranch_vccnz Al_f023
Al_o023:
    v_smfmac_f32_16x16x64_bf16 v[24:27], v[48:51], v[64:71], v1
    s_waitcnt vmcnt(1)
    v_max3_u32 v11, v56, v57, v58
    v_smfmac_f32_16x16x64_bf16 v[28:31], v[48:51], v[72:79], v1
    v_max_u32 v11, v11, v59
    v_cmp_eq_u32 vcc, -1, v11
    v_smfmac_f32_16x16x64_bf16 v[32:35], v[48:51], v[80:87], v1
    v_smfmac_f32_16x16x64_bf16 v[36:39], v[48:51], v[88:95], v1
    s_cbranch_vccz Al_o23
    s_branch Al_f23
Al_f230:
    buffer_load_dwordx4 v[56:59], v2, s[4:7], s30 offen offset:2048 sc1
    s_sub_u32 s48, s48, 1
    s_cbranch_scc1 L_abort
    s_waitcnt vmcnt(2)
    v_max3_u32 v11, v60, v61, v62
    v_max_u32 v11, v11, v63
    v_cmp_eq_u32 vcc, -1, v11
    s_cbranch_vccnz Al_f302
Al_o302:
    v_smfmac_f32_16x16x64_bf16 v[24:27], v[60:63], v[208:215], v1
    s_waitcnt vmcnt(1)
    v_max3_u32 v11, v48, v49, v50
    v_smfmac_f32_16x16x64_bf16 v[28:31], v[60:63], v[216:223], v1
    v_max_u32 v11, v11, v51
    v_cmp_eq_u32 vcc, -1, v11
    v_smfmac_f32_16x16x64_bf16 v[32:35], v[60:63], v[224:231], v1
    v_smfmac_f32_16x16x64_bf16 v[36:39], v[60:63], v[232:239], v1
    s_cbranch_vccz Al_o02
    s_branch Al_f02
Al_f123:
    buffer_load_dwordx4 v[52:55], v2, s[4:7], s30 offen offset:1024 sc1
    s_sub_u32 s48, s48, 1
    s_cbranch_scc1 L_abort
    s_waitcnt vmcnt(2)
    v_max3_u32 v11, v56, v57, v58
    v_max_u32 v11, v11, v59
    v_cmp_eq_u32 vcc, -1, v11
    s_cbranch_vccnz Al_f231
Al_o231:
    v_smfmac_f32_16x16x64_bf16 v[24:27], v[56:59], v[160:167], v1
    s_waitcnt vmcnt(1)
    v_max3_u32 v11, v60, v61, v62
    v_smfmac_f32_16x16x64_bf16 v[28:31], v[56:59], v[168:175], v1
    v_max_u32 v11, v11, v63
    v_cmp_eq_u32 vcc, -1, v11
    v_smfmac_f32_16x16x64_bf16 v[32:35], v[56:59], v[176:183], v1
    v_smfmac_f32_16x16x64_bf16 v[36:39], v[56:59], v[184:191], v1
    s_cbranch_vccz Al_o31
    s_branch Al_f31
Al_f231:
    buffer_load_dwordx4 v[56:59], v2, s[4:7], s30 offen offset:2048 sc1
    s_sub_u32 s48, s48, 1
    s_cbranch_scc1 L_abort
    s_waitcnt vmcnt(2)
    v_max3_u32 v11, v60, v61, v62
    v_max_u32 v11, v11, v63
    v_cmp_eq_u32 vcc, -1, v11
    s_cbranch_vccnz Al_f312
Al_o312:
    v_smfmac_f32_16x16x64_bf16 v[24:27], v[60:63], v[208:215], v1
    s_waitcnt vmcnt(1)
    v_max3_u32 v11, v52, v53, v54
    v_smfmac_f32_16x16x64_bf16 v[28:31], v[60:63], v[216:223], v1
    v_max_u32 v11, v11, v55
    v_cmp_eq_u32 vcc, -1, v11
    v_smfmac_f32_16x16x64_bf16 v[32:35], v[60:63], v[224:231], v1
    v_smfmac_f32_16x16x64_bf16 v[36:39], v[60:63], v[232:239], v1
    s_cbranch_vccz Al_o12
    s_branch Al_f12
Al_f01:
    buffer_load_dwordx4 v[48:51], v2, s[4:7], s30 offen offset:0 sc1
    s_sub_u32 s48, s48, 1
    s_cbranch_scc1 L_abort
    s_waitcnt vmcnt(1)
    v_max3_u32 v11, v52, v53, v54
    v_max_u32 v11, v11, v55
    v_cmp_eq_u32 vcc, -1, v11
    s_cbranch_vccnz Al_f10
Al_o10:
    v_smfmac_f32_16x16x64_bf16 v[24:27], v[52:55], v[112:119], v1
    s_waitcnt vmcnt(0)
    v_max3_u32 v11, v48, v49, v50
    v_smfmac_f32_16x16x64_bf16 v[28:31], v[52:55], v[120:127], v1
    v_max_u32 v11, v11, v51
    v_cmp_eq_u32 vcc, -1, v11
    v_smfmac_f32_16x16x64_bf16 v[32:35], v[52:55], v[128:135], v1
    v_smfmac_f32_16x16x64_bf16 v[36:39], v[52:55], v[136:143], v1
    s_cbranch_vccz Al_o0
    s_branch Al_f0
Al_f20:
    buffer_load_dwordx4 v[56:59], v2, s[4:7], s30 offen offset:2048 sc1
    s_sub_u32 s48, s48, 1
    s_cbranch_scc1 L_abort
    s_waitcnt vmcnt(1)
    v_max3_u32 v11, v48, v49, v50
    v_max_u32 v11, v11, v51
    v_cmp_eq_u32 vcc, -1, v11
    s_cbranch_vccnz Al_f02
Al_o02:
    v_smfmac_f32_16x16x64_bf16 v[24:27], v[48:51], v[64:71], v1
    s_waitcnt vmcnt(0)
    v_max3_u32 v11, v56, v57, v58
    v_smfmac_f32_16x16x64_bf16 v[28:31], v[48:51], v[72:79], v1
    v_max_u32 v11, v11, v59
    v_cmp_eq_u32 vcc, -1, v11
    v_smfmac_f32_16x16x64_bf16 v[32:35], v[48:51], v[80:87], v1
    v_smfmac_f32_16x16x64_bf16 v[36:39], v[48:51], v[88:95], v1
    s_cbranch_vccz Al_o2
    s_branch Al_f2
Al_f02:
    buffer_load_dwordx4 v[48:51], v2, s[4:7], s30 offen offset:0 sc1
    s_sub_u32 s48, s48, 1
    s_cbranch_scc1 L_abort
    s_waitcnt vmcnt(1)
    v_max3_u32 v11, v56, v57, v58
    v_max_u32 v11, v11, v59
    v_cmp_eq_u32 vcc, -1, v11
    s_cbranch_vccnz Al_f20
Al_o20:
    v_smfmac_f32_16x16x64_bf16 v[24:27], v[56:59], v[160:167], v1
    s_waitcnt vmcnt(0)
    v_max3_u32 v11, v48, v49, v50
    v_smfmac_f32_16x16x64_bf16 v[28:31], v[56:59], v[168:175], v1
    v_max_u32 v11, v11, v51
    v_cmp_eq_u32 vcc, -1, v11
    v_smfmac_f32_16x16x64_bf16 v[32:35], v[56:59], v[176:183], v1
    v_smfmac_f32_16x16x64_bf16 v[36:39], v[56:59], v[184:191], v1
    s_cbranch_vccz Al_o0
    s_branch Al_f0
Al_f30:
    buffer_load_dwordx4 v[60:63], v2, s[4:7], s30 offen offset:3072 sc1
    s_sub_u32 s48, s48, 1
    s_cbranch_scc1 L_abort
    s_waitcnt vmcnt(1)
    v_max3_u32 v11, v48, v49, v50
    v_max_u32 v11, v11, v51
    v_cmp_eq_u32 vcc, -1, v11
    s_cbranch_vccnz Al_f03
Al_o03:
    v_smfmac_f32_16x16x64_bf16 v[24:27], v[48:51], v[64:71], v1
    s_waitcnt vmcnt(0)
    v_max3_u32 v11, v60, v61, v62
    v_smfmac_f32_16x16x64_bf16 v[28:31], v[48:51], v[72:79], v1
    v_max_u32 v11, v11, v63
    v_cmp_eq_u32 vcc, -1, v11
    v_smfmac_f32_16x16x64_bf16 v[32:35], v[48:51], v[80:87], v1
    v_smfmac_f32_16x16x64_bf16 v[36:39], v[48:51], v[88:95], v1
    s_cbranch_vccz Al_o3
    s_branch Al_f3
Al_f12:
    buffer_load_dwordx4 v[52:55], v2, s[4:7], s30 offen offset:1024 sc1
    s_sub_u32 s48, s48, 1
    s_cbranch_scc1 L_abort
    s_waitcnt vmcnt(1)
    v_max3_u32 v11, v56, v57, v58
    v_max_u32 v11, v11, v59
    v_cmp_eq_u32 vcc, -1, v11
    s_cbranch_vccnz Al_f21
Al_o21:
    v_smfmac_f32_16x16x64_bf16 v[24:27], v[56:59], v[160:167], v1
    s_waitcnt vmcnt(0)
    v_max3_u32 v11, v52, v53, v54
    v_smfmac_f32_16x16x64_bf16 v[28:31], v[56:59], v[168:175], v1
    v_max_u32 v11, v11, v55
    v_cmp_eq_u32 vcc, -1, v11
    v_smfmac_f32_16x16x64_bf16 v[32:35], v[56:59], v[176:183], v1
    v_smfmac_f32_16x16x64_bf16 v[36:39], v[56:59], v[184:191], v1
    s_cbranch_vccz Al_o1
    s_branch Al_f1
Al_f31:
    buffer_load_dwordx4 v[60:63], v2, s[4:7], s30 offen offset:3072 sc1
    s_sub_u32 s48, s48, 1
    s_cbranch_scc1 L_abort
    s_waitcnt vmcnt(1)
    v_max3_u32 v11, v52, v53, v54
    v_max_u32 v11, v11, v55
    v_cmp_eq_u32 vcc, -1, v11
    s_cbranch_vccnz Al_f13
Al_o13:
    v_smfmac_f32_16x16x64_bf16 v[24:27], v[52:55], v[112:119], v1
    s_waitcnt vmcnt(0)
    v_max3_u32 v11, v60, v61, v62
    v_smfmac_f32_16x16x64_bf16 v[28:31], v[52:55], v[120:127], v1
    v_max_u32 v11, v11, v63
    v_cmp_eq_u32 vcc, -1, v11
    v_smfmac_f32_16x16x64_bf16 v[32:35], v[52:55], v[128:135], v1
    v_smfmac_f32_16x16x64_bf16 v[36:39], v[52:55], v[136:143], v1
    s_cbranch_vccz Al_o3
    s_branch Al_f3
Al_f13:
    buffer_load_dwordx4 v[52:55], v2, s[4:7], s30 offen offset:1024 sc1
    s_sub_u32 s48, s48, 1
    s_cbranch_scc1 L_abort
    s_waitcnt vmcnt(1)
    v_max3_u32 v11, v60, v61, v62
    v_max_u32 v11, v11, v63
    v_cmp_eq_u32 vcc, -1, v11
    s_cbranch_vccnz Al_f31
Al_o31:
    v_smfmac_f32_16x16x64_bf16 v[24:27], v[60:63], v[208:215], v1
    s_waitcnt vmcnt(0)
    v_max3_u32 v11, v52, v53, v54
    v_smfmac_f32_16x16x64_bf16 v[28:31], v[60:63], v[216:223], v1
    v_max_u32 v11, v11, v55
    v_cmp_eq_u32 vcc, -1, v11
    v_smfmac_f32_16x16x64_bf16 v[32:35], v[60:63], v[224:231], v1
    v_smfmac_f32_16x16x64_bf16 v[36:39], v[60:63], v[232:239], v1
    s_cbranch_vccz Al_o1
    s_branch Al_f1
Al_f23:
    buffer_load_dwordx4 v[56:59], v2, s[4:7], s30 offen offset:2048 sc1
    s_sub_u32 s48, s48, 1
    s_cbranch_scc1 L_abort
    s_waitcnt vmcnt(1)
    v_max3_u32 v11, v60, v61, v62
    v_max_u32 v11, v11, v63
    v_cmp_eq_u32 vcc, -1, v11
    s_cbranch_vccnz Al_f32
Al_o32:
    v_smfmac_f32_16x16x64_bf16 v[24:27], v[60:63], v[208:215], v1
    s_waitcnt vmcnt(0)
    v_max3_u32 v11, v56, v57, v58
    v_smfmac_f32_16x16x64_bf16 v[28:31], v[60:63], v[216:223], v1
    v_max_u32 v11, v11, v59
    v_cmp_eq_u32 vcc, -1, v11
    v_smfmac_f32_16x16x64_bf16 v[32:35], v[60:63], v[224:231], v1
    v_smfmac_f32_16x16x64_bf16 v[36:39], v[60:63], v[232:239], v1
    s_cbranch_vccz Al_o2
    s_branch Al_f2
Al_f0:
    buffer_load_dwordx4 v[48:51], v2, s[4:7], s30 offen offset:0 sc1
    s_sub_u32 s48, s48, 1
    s_cbranch_scc1 L_abort
    s_waitcnt vmcnt(0)
    v_max3_u32 v11, v48, v49, v50
    v_max_u32 v11, v11, v51
    v_cmp_eq_u32 vcc, -1, v11
    s_cbranch_vccnz Al_f0
Al_o0:
    v_smfmac_f32_16x16x64_bf16 v[24:27], v[48:51], v[64:71], v1
    s_nop 0
    v_smfmac_f32_16x16x64_bf16 v[28:31], v[48:51], v[72:79], v1
    v_smfmac_f32_16x16x64_bf16 v[32:35], v[48:51], v[80:87], v1
    v_smfmac_f32_16x16x64_bf16 v[36:39], v[48:51], v[88:95], v1
    s_branch Al_tail
Al_f1:
    buffer_load_dwordx4 v[52:55], v2, s[4:7], s30 offen offset:1024 sc1
    s_sub_u32 s48, s48, 1
    s_cbranch_scc1 L_abort
    s_waitcnt vmcnt(0)
    v_max3_u32 v11, v52, v53, v54
    v_max_u32 v11, v11, v55
    v_cmp_eq_u32 vcc, -1, v11
    s_cbranch_vccnz Al_f1
Al_o1:
    v_smfmac_f32_16x16x64_bf16 v[24:27], v[52:55], v[112:119], v1
    s_nop 0
    v_smfmac_f32_16x16x64_bf16 v[28:31], v[52:55], v[120:127], v1
    v_smfmac_f32_16x16x64_bf16 v[32:35], v[52:55], v[128:135], v1
    v_smfmac_f32_16x16x64_bf16 v[36:39], v[52:55], v[136:143], v1
    s_branch Al_tail
Al_f2:
    buffer_load_dwordx4 v[56:59], v2, s[4:7], s30 offen offset:2048 sc1
    s_sub_u32 s48, s48, 1
    s_cbranch_scc1 L_abort
    s_waitcnt vmcnt(0)
    v_max3_u32 v11, v56, v57, v58
    v_max_u32 v11, v11, v59
    v_cmp_eq_u32 vcc, -1, v11
    s_cbranch_vccnz Al_f2
Al_o2:
    v_smfmac_f32_16x16x64_bf16 v[24:27], v[56:59], v[160:167], v1
    s_nop 0
    v_smfmac_f32_16x16x64_bf16 v[28:31], v[56:59], v[168:175], v1
    v_smfmac_f32_16x16x64_bf16 v[32:35], v[56:59], v[176:183], v1
    v_smfmac_f32_16x16x64_bf16 v[36:39], v[56:59], v[184:191], v1
    s_branch Al_tail
Al_f3:
    buffer_load_dwordx4 v[60:63], v2, s[4:7], s30 offen offset:3072 sc1
    s_sub_u32 s48, s48, 1
    s_cbranch_scc1 L_abort
    s_waitcnt vmcnt(0)
    v_max3_u32 v11, v60, v61, v62
    v_max_u32 v11, v11, v63
    v_cmp_eq_u32 vcc, -1, v11
    s_cbranch_vccnz Al_f3
    s_branch Al_o3
Al_z:
    buffer_load_dwordx4 v[48:51], v2, s[4:7], s30 offen offset:0 sc1
    s_sub_u32 s48, s48, 1
    s_cbranch_scc1 L_abort
    s_nop 3
    v_mov_b64 v[24:25], 0
    v_mov_b64 v[26:27], 0
    v_mov_b64 v[28:29], 0
    v_mov_b64 v[30:31], 0
    v_mov_b64 v[32:33], 0
    v_mov_b64 v[34:35], 0
    v_mov_b64 v[36:37], 0
    v_mov_b64 v[38:39], 0
    s_waitcnt vmcnt(3)
    v_max3_u32 v11, v52, v53, v54
    v_max_u32 v11, v11, v55
    v_cmp_eq_u32 vcc, -1, v11
    s_cbranch_vccz Al_o1230
    s_branch Al_f1230
Al_slow3:
    buffer_load_dwordx4 v[48:51], v4, s[4:7], s31 offen sc1
    s_sub_u32 s48, s48, 1
    s_cbranch_scc1 L_abort
    s_waitcnt vmcnt(0)
    v_max3_u32 v11, v48, v49, v50
    v_max_u32 v11, v11, v51
    v_cmp_eq_u32 vcc, -1, v11
    s_cbranch_vccnz Al_slow3
    v_mfma_f32_16x16x32_bf16 v[52:55], v[16:19], v[48:51], 0
    s_nop 2
    s_branch Al_r4
    .p2align 6
An_o3:
    v_smfmac_f32_16x16x64_bf16 v[24:27], v[60:63], v[208:215], v1
    s_nop 0
    v_smfmac_f32_16x16x64_bf16 v[28:31], v[60:63], v[216:223], v1
    v_smfmac_f32_16x16x64_bf16 v[32:35], v[60:63], v[224:231], v1
    v_smfmac_f32_16x16x64_bf16 v[36:39], v[60:63], v[232:239], v1
An_tail:
    v_smfmac_f32_16x16x64_bf16 v[40:43], v[48:51], v[96:103], v1
    v_smfmac_f32_16x16x64_bf16 v[44:47], v[48:51], v[104:111], v1
    s_nop 1
    v_add_f32 v24, v24, v26
    v_add_f32 v26, v25, v27
    v_smfmac_f32_16x16x64_bf16 v[40:43], v[52:55], v[144:151], v1
    v_add_f32 v25, v28, v30
    v_add_f32 v27, v29, v31
    v_smfmac_f32_16x16x64_bf16 v[44:47], v[52:55], v[152:159], v1
    ds_write2_b64 v6, v[24:25], v[26:27] offset0:0 offset1:4
    v_smfmac_f32_16x16x64_bf16 v[40:43], v[56:59], v[192:199], v1
    v_add_f32 v32, v32, v34
    v_add_f32 v34, v33, v35
    v_smfmac_f32_16x16x64_bf16 v[44:47], v[56:59], v[200:207], v1
    v_add_f32 v33, v36, v38
    v_add_f32 v35, v37, v39
    v_smfmac_f32_16x16x64_bf16 v[40:43], v[60:63], v[240:247], v1
    ds_write2_b64 v6, v[32:33], v[34:35] offset0:8 offset1:12
    v_smfmac_f32_16x16x64_bf16 v[44:47], v[60:63], v[248:255], v1
    s_nop 5
    v_add_f32 v40, v40, v42
    v_add_f32 v42, v41, v43
    v_add_f32 v41, v44, v46
    v_add_f32 v43, v45, v47
    ds_write2_b64 v20, v[40:41], v[42:43] offset0:0 offset1:4
    s_setprio 0
    s_cmp_ge_u32 s60, 2
    s_waitcnt vmcnt(0) lgkmcnt(0)
    s_barrier
    s_cbranch_scc1 An_v2
    ds_read_b64 v[48:49], v0 offset:0
    ds_read_b64 v[50:51], v0 offset:3264
    ds_read_b64 v[52:53], v0 offset:6528
    ds_read_b64 v[54:55], v0 offset:9792
    s_waitcnt lgkmcnt(2)
    v_pk_add_f32 v[48:49], v[48:49], v[50:51]
    s_waitcnt lgkmcnt(0)
    v_pk_add_f32 v[52:53], v[52:53], v[54:55]
    v_pk_add_f32 v[48:49], v[48:49], v[52:53]
    v_cvt_pk_bf16_f32 v12, v48, v49
    buffer_store_dword v12, v14, s[4:7], s30 offen sc1
An_v2:
    s_lshl_b32 s59, s28, 17
    s_add_u32 s59, s59, 37748736
    s_cmp_lg_u32 s60, 3
    s_cbranch_scc1 An_nf
    s_mov_b32 s35, s28
    s_atomic_smax s35, s[4:5], s51
An_nf:
    s_cmp_eq_u32 s28, 63
    s_cbranch_scc1 L_rec_lastA
    s_add_u32 s49, s28, 3
    s_and_b32 s49, s49, 3
    s_lshl_b32 s49, s49, 18
    s_add_u32 s49, s49, 96468992
    s_lshr_b32 s47, s28, 3
    s_lshr_b32 s47, s29, s47
    s_and_b32 s47, s47, 1
    s_lshl_b32 s47, s47, 13
    s_lshl_b32 s31, s28, 18
    s_add_u32 s31, s31, s47
    s_add_u32 s31, s31, 100663296
    s_add_u32 s66, s31, 16777216
    s_add_u32 s30, s28, 1
    s_and_b32 s30, s30, 3
    s_lshl_b32 s30, s30, 18
    s_add_u32 s30, s30, 96468992
    s_add_u32 s68, s28, 1
    s_lshl_b32 s68, s68, 19
    s_add_u32 s69, s68, 532480
    s_cmp_ge_i32 s28, 62
    s_cselect_b32 s69, 2146435056, s69
    s_mov_b32 s48, 400000
    s_lshl_b32 s33, s28, 2
    s_add_u32 s33, s33, 4
    s_sleep 6
    v_mov_b32 v48, -1
    v_mov_b32 v49, -1
    v_mov_b32 v50, -1
    v_mov_b32 v51, -1
    s_setprio 3
An_wb:
    ds_read_b32 v11, v10 offset:0
    s_sub_u32 s48, s48, 1
    s_cbranch_scc1 L_abort
    s_waitcnt lgkmcnt(0)
    v_cmp_gt_u32 vcc, s33, v11
    s_cbranch_vccnz An_wb
    s_cmp_ge_u32 s60, 2
    s_cbranch_scc1 An_h2
    buffer_store_dwordx4 v[48:51], v9, s[4:7], s49 offen sc1
An_h2:
    buffer_load_dwordx4 v[24:27], v8, s[4:7], s68 offen offset:0 sc1
    buffer_load_dwordx4 v[28:31], v8, s[4:7], s68 offen offset:1024 sc1
    buffer_load_dwordx4 v[32:35], v8, s[4:7], s68 offen offset:2048 sc1
    buffer_load_dwordx4 v[36:39], v8, s[4:7], s68 offen offset:3072 sc1
    buffer_load_dwordx4 v[40:43], v8, s[4:7], s69 offen offset:0 sc1
    buffer_load_dwordx4 v[44:47], v8, s[4:7], s69 offen offset:1024 sc1
    buffer_load_dwordx4 v[56:59], v8, s[4:7], s69 offen offset:2048 sc1
    buffer_load_dwordx4 v[60:63], v8, s[4:7], s69 offen offset:3072 sc1
    s_add_u32 s28, s28, 1
    s_mov_b32 s48, 400000
    s_barrier
    ds_read_b64 v[48:49], v7 offset:0
    ds_read_b64 v[50:51], v7 offset:2304
    ds_read_b64 v[52:53], v7 offset:4608
    ds_read_b64 v[54:55], v7 offset:6912
    s_waitcnt lgkmcnt(2)
    v_pk_add_f32 v[48:49], v[48:49], v[50:51]
    s_waitcnt lgkmcnt(0)
    v_pk_add_f32 v[52:53], v[52:53], v[54:55]
    v_pk_add_f32 v[48:49], v[48:49], v[52:53]
    v_cvt_pk_bf16_f32 v11, v48, v49
    buffer_store_dword v11, v5, s[4:7], s31 offen sc1
    buffer_store_dword v12, v13, s[4:7], s59 offen sc1
    s_nop 15
    s_nop 15
    s_nop 15
    s_nop 15
    s_nop 15
    buffer_load_dwordx4 v[48:51], v4, s[4:7], s31 offen sc1
    s_waitcnt vmcnt(3)
    ds_write_b128 v15, v[24:27] offset:0
    ds_write_b128 v15, v[28:31] offset:1024
    ds_write_b128 v15, v[32:35] offset:2048
    ds_write_b128 v15, v[36:39] offset:3072
    ds_write_b128 v15, v[40:43] offset:4096
    ds_write_b128 v15, v[44:47] offset:5120
    ds_write_b128 v15, v[56:59] offset:6144
    ds_write_b128 v15, v[60:63] offset:7168
    s_waitcnt vmcnt(0)
An_r3:
    v_mfma_f32_16x16x32_bf16 v[52:55], v[16:19], v[48:51], 0
    v_max3_u32 v11, v48, v49, v50
    v_max_u32 v11, v11, v51
    v_cmp_eq_u32 vcc, -1, v11
    s_cbranch_vccnz An_slow3
An_r4:
    s_nop 3
    v_add_f32_dpp v52, v52, v52 row_ror:8 row_mask:0xf bank_mask:0xf
    v_add_f32_dpp v53, v53, v53 row_ror:8 row_mask:0xf bank_mask:0xf
    v_cvt_pk_bf16_f32 v12, v52, v53
    buffer_store_dword v12, v3, s[4:7], s30 offen sc1
An_entry:
    s_waitcnt lgkmcnt(0)
    v_mov_b64 v[24:25], 0
    v_mov_b64 v[26:27], 0
    v_mov_b64 v[28:29], 0
    v_mov_b64 v[30:31], 0
    v_mov_b64 v[32:33], 0
    v_mov_b64 v[34:35], 0
    v_mov_b64 v[36:37], 0
    v_mov_b64 v[38:39], 0
    v_mov_b64 v[40:41], 0
    v_mov_b64 v[42:43], 0
    v_mov_b64 v[44:45], 0
    v_mov_b64 v[46:47], 0
    s_cmp_le_u32 s28, 54
    s_cbranch_scc1 An_t6
    ds_add_u32 v22, v23 offset:256
An_t6:
    s_nop 15
    s_nop 1
    buffer_load_dwordx4 v[48:51], v2, s[4:7], s30 offen offset:0 sc1
    s_nop 10
    buffer_load_dwordx4 v[52:55], v2, s[4:7], s30 offen offset:1024 sc1
    s_nop 10
    buffer_load_dwordx4 v[56:59], v2, s[4:7], s30 offen offset:2048 sc1
    s_nop 10
    buffer_load_dwordx4 v[60:63], v2, s[4:7], s30 offen offset:3072 sc1
    s_waitcnt vmcnt(3)
    v_smfmac_f32_16x16x64_bf16 v[24:27], v[48:51], v[64:71], v1
    v_max3_u32 v11, v48, v49, v50
    v_smfmac_f32_16x16x64_bf16 v[28:31], v[48:51], v[72:79], v1
    v_max_u32 v11, v11, v51
    v_cmp_eq_u32 vcc, -1, v11
    v_smfmac_f32_16x16x64_bf16 v[32:35], v[48:51], v[80:87], v1
    v_smfmac_f32_16x16x64_bf16 v[36:39], v[48:51], v[88:95], v1
    s_cbranch_vccnz An_z
    s_waitcnt vmcnt(2)
    v_max3_u32 v11, v52, v53, v54
    v_max_u32 v11, v11, v55
    v_cmp_eq_u32 vcc, -1, v11
    s_cbranch_vccnz An_f123
    v_smfmac_f32_16x16x64_bf16 v[24:27], v[52:55], v[112:119], v1
    s_waitcnt vmcnt(1)
    v_max3_u32 v11, v56, v57, v58
    v_smfmac_f32_16x16x64_bf16 v[28:31], v[52:55], v[120:127], v1
    v_max_u32 v11, v11, v59
    v_cmp_eq_u32 vcc, -1, v11
    v_smfmac_f32_16x16x64_bf16 v[32:35], v[52:55], v[128:135], v1
    v_smfmac_f32_16x16x64_bf16 v[36:39], v[52:55], v[136:143], v1
    s_cbranch_vccnz An_f23
    v_smfmac_f32_16x16x64_bf16 v[24:27], v[56:59], v[160:167], v1
    s_waitcnt vmcnt(0)
    v_max3_u32 v11, v60, v61, v62
    v_smfmac_f32_16x16x64_bf16 v[28:31], v[56:59], v[168:175], v1
    v_max_u32 v11, v11, v63
    v_cmp_eq_u32 vcc, -1, v11
    v_smfmac_f32_16x16x64_bf16 v[32:35], v[56:59], v[176:183], v1
    v_smfmac_f32_16x16x64_bf16 v[36:39], v[56:59], v[184:191], v1
    s_cbranch_vccz An_o3
    s_branch An_f3
An_f3012:
    buffer_load_dwordx4 v[60:63], v2, s[4:7], s30 offen offset:3072 sc1
    s_sub_u32 s48, s48, 1
    s_cbranch_scc1 L_abort
    s_waitcnt vmcnt(3)
    v_max3_u32 v11, v48, v49, v50
    v_max_u32 v11, v11, v51
    v_cmp_eq_u32 vcc, -1, v11
    s_cbranch_vccnz An_f0123
An_o0123:
    v_smfmac_f32_16x16x64_bf16 v[24:27], v[48:51], v[64:71], v1
    s_waitcnt vmcnt(2)
    v_max3_u32 v11, v52, v53, v54
    v_smfmac_f32_16x16x64_bf16 v[28:31], v[48:51], v[72:79], v1
    v_max_u32 v11, v11, v55
    v_cmp_eq_u32 vcc, -1, v11
    v_smfmac_f32_16x16x64_bf16 v[32:35], v[48:51], v[80:87], v1
    v_smfmac_f32_16x16x64_bf16 v[36:39], v[48:51], v[88:95], v1
    s_cbranch_vccz An_o123
    s_branch An_f123
An_f312:
    buffer_load_dwordx4 v[60:63], v2, s[4:7], s30 offen offset:3072 sc1
    s_sub_u32 s48, s48, 1
    s_cbranch_scc1 L_abort
    s_waitcnt vmcnt(2)
    v_max3_u32 v11, v52, v53, v54
    v_max_u32 v11, v11, v55
    v_cmp_eq_u32 vcc, -1, v11
    s_cbranch_vccnz An_f123
An_o123:
    v_smfmac_f32_16x16x64_bf16 v[24:27], v[52:55], v[112:119], v1
    s_waitcnt vmcnt(1)
    v_max3_u32 v11, v56, v57, v58
    v_smfmac_f32_16x16x64_bf16 v[28:31], v[52:55], v[120:127], v1
    v_max_u32 v11, v11, v59
    v_cmp_eq_u32 vcc, -1, v11
    v_smfmac_f32_16x16x64_bf16 v[32:35], v[52:55], v[128:135], v1
    v_smfmac_f32_16x16x64_bf16 v[36:39], v[52:55], v[136:143], v1
    s_cbranch_vccz An_o23
    s_branch An_f23
An_f32:
    buffer_load_dwordx4 v[60:63], v2, s[4:7], s30 offen offset:3072 sc1
    s_sub_u32 s48, s48, 1
    s_cbranch_scc1 L_abort
    s_waitcnt vmcnt(1)
    v_max3_u32 v11, v56, v57, v58
    v_max_u32 v11, v11, v59
    v_cmp_eq_u32 vcc, -1, v11
    s_cbranch_vccnz An_f23
An_o23:
    v_smfmac_f32_16x16x64_bf16 v[24:27], v[56:59], v[160:167], v1
    s_waitcnt vmcnt(0)
    v_max3_u32 v11, v60, v61, v62
    v_smfmac_f32_16x16x64_bf16 v[28:31], v[56:59], v[168:175], v1
    v_max_u32 v11, v11, v63
    v_cmp_eq_u32 vcc, -1, v11
    v_smfmac_f32_16x16x64_bf16 v[32:35], v[56:59], v[176:183], v1
    v_smfmac_f32_16x16x64_bf16 v[36:39], v[56:59], v[184:191], v1
    s_cbranch_vccz An_o3
    s_branch An_f3
An_f0123:
    buffer_load_dwordx4 v[48:51], v2, s[4:7], s30 offen offset:0 sc1
    s_sub_u32 s48, s48, 1
    s_cbranch_scc1 L_abort
    s_waitcnt vmcnt(3)
    v_max3_u32 v11, v52, v53, v54
    v_max_u32 v11, v11, v55
    v_cmp_eq_u32 vcc, -1, v11
    s_cbranch_vccnz An_f1230
An_o1230:
    v_smfmac_f32_16x16x64_bf16 v[24:27], v[52:55], v[112:119], v1
    s_waitcnt vmcnt(2)
    v_max3_u32 v11, v56, v57, v58
    v_smfmac_f32_16x16x64_bf16 v[28:31], v[52:55], v[120:127], v1
    v_max_u32 v11, v11, v59
    v_cmp_eq_u32 vcc, -1, v11
    v_smfmac_f32_16x16x64_bf16 v[32:35], v[52:55], v[128:135], v1
    v_smfmac_f32_16x16x64_bf16 v[36:39], v[52:55], v[136:143], v1
    s_cbranch_vccz An_o230
    s_branch An_f230
An_f023:
    buffer_load_dwordx4 v[48:51], v2, s[4:7], s30 offen offset:0 sc1
    s_sub_u32 s48, s48, 1
    s_cbranch_scc1 L_abort
    s_waitcnt vmcnt(2)
    v_max3_u32 v11, v56, v57, v58
    v_max_u32 v11, v11, v59
    v_cmp_eq_u32 vcc, -1, v11
    s_cbranch_vccnz An_f230
An_o230:
    v_smfmac_f32_16x16x64_bf16 v[24:27], v[56:59], v[160:167], v1
    s_waitcnt vmcnt(1)
    v_max3_u32 v11, v60, v61, v62
    v_smfmac_f32_16x16x64_bf16 v[28:31], v[56:59], v[168:175], v1
    v_max_u32 v11, v11, v63
    v_cmp_eq_u32 vcc, -1, v11
    v_smfmac_f32_16x16x64_bf16 v[32:35], v[56:59], v[176:183], v1
    v_smfmac_f32_16x16x64_bf16 v[36:39], v[56:59], v[184:191], v1
    s_cbranch_vccz An_o30
    s_branch An_f30
An_f03:
    buffer_load_dwordx4 v[48:51], v2, s[4:7], s30 offen offset:0 sc1
    s_sub_u32 s48, s48, 1
    s_cbranch_scc1 L_abort
    s_waitcnt vmcnt(1)
    v_max3_u32 v11, v60, v61, v62
    v_max_u32 v11, v11, v63
    v_cmp_eq_u32 vcc, -1, v11
    s_cbranch_vccnz An_f30
An_o30:
    v_smfmac_f32_16x16x64_bf16 v[24:27], v[60:63], v[208:215], v1
    s_waitcnt vmcnt(0)
    v_max3_u32 v11, v48, v49, v50
    v_smfmac_f32_16x16x64_bf16 v[28:31], v[60:63], v[216:223], v1
    v_max_u32 v11, v11, v51
    v_cmp_eq_u32 vcc, -1, v11
    v_smfmac_f32_16x16x64_bf16 v[32:35], v[60:63], v[224:231], v1
    v_smfmac_f32_16x16x64_bf16 v[36:39], v[60:63], v[232:239], v1
    s_cbranch_vccz An_o0
    s_branch An_f0
An_f1230:
    buffer_load_dwordx4 v[52:55], v2, s[4:7], s30 offen offset:1024 sc1
    s_sub_u32 s48, s48, 1
    s_cbranch_scc1 L_abort
    s_waitcnt vmcnt(3)
    v_max3_u32 v11, v56, v57, v58
    v_max_u32 v11, v11, v59
    v_cmp_eq_u32 vcc, -1, v11
    s_cbranch_vccnz An_f2301
An_o2301:
    v_smfmac_f32_16x16x64_bf16 v[24:27], v[56:59], v[160:167], v1
    s_waitcnt vmcnt(2)
    v_max3_u32 v11, v60, v61, v62
    v_smfmac_f32_16x16x64_bf16 v[28:31], v[56:59], v[168:175], v1
    v_max_u32 v11, v11, v63
    v_cmp_eq_u32 vcc, -1, v11
    v_smfmac_f32_16x16x64_bf16 v[32:35], v[56:59], v[176:183], v1
    v_smfmac_f32_16x16x64_bf16 v[36:39], v[56:59], v[184:191], v1
    s_cbranch_vccz An_o301
    s_branch An_f301
An_f130:
    buffer_load_dwordx4 v[52:55], v2, s[4:7], s30 offen offset:1024 sc1
    s_sub_u32 s48, s48, 1
    s_cbranch_scc1 L_abort
    s_waitcnt vmcnt(2)
    v_max3_u32 v11, v60, v61, v62
    v_max_u32 v11, v11, v63
    v_cmp_eq_u32 vcc, -1, v11
    s_cbranch_vccnz An_f301
An_o301:
    v_smfmac_f32_16x16x64_bf16 v[24:27], v[60:63], v[208:215], v1
    s_waitcnt vmcnt(1)
    v_max3_u32 v11, v48, v49, v50
    v_smfmac_f32_16x16x64_bf16 v[28:31], v[60:63], v[216:223], v1
    v_max_u32 v11, v11, v51
    v_cmp_eq_u32 vcc, -1, v11
    v_smfmac_f32_16x16x64_bf16 v[32:35], v[60:63], v[224:231], v1
    v_smfmac_f32_16x16x64_bf16 v[36:39], v[60:63], v[232:239], v1
    s_cbranch_vccz An_o01
    s_branch An_f01
An_f10:
    buffer_load_dwordx4 v[52:55], v2, s[4:7], s30 offen offset:1024 sc1
    s_sub_u32 s48, s48, 1
    s_cbranch_scc1 L_abort
    s_waitcnt vmcnt(1)
    v_max3_u32 v11, v48, v49, v50
    v_max_u32 v11, v11, v51
    v_cmp_eq_u32 vcc, -1, v11
    s_cbranch_vccnz An_f01
An_o01:
    v_smfmac_f32_16x16x64_bf16 v[24:27], v[48:51], v[64:71], v1
    s_waitcnt vmcnt(0)
    v_max3_u32 v11, v52, v53, v54
    v_smfmac_f32_16x16x64_bf16 v[28:31], v[48:51], v[72:79], v1
    v_max_u32 v11, v11, v55
    v_cmp_eq_u32 vcc, -1, v11
    v_smfmac_f32_16x16x64_bf16 v[32:35], v[48:51], v[80:87], v1
    v_smfmac_f32_16x16x64_bf16 v[36:39], v[48:51], v[88:95], v1
    s_cbranch_vccz An_o1
    s_branch An_f1
An_f2301:
    buffer_load_dwordx4 v[56:59], v2, s[4:7], s30 offen offset:2048 sc1
    s_sub_u32 s48, s48, 1
    s_cbranch_scc1 L_abort
    s_waitcnt vmcnt(3)
    v_max3_u32 v11, v60, v61, v62
    v_max_u32 v11, v11, v63
    v_cmp_eq_u32 vcc, -1, v11
    s_cbranch_vccnz An_f3012
An_o3012:
    v_smfmac_f32_16x16x64_bf16 v[24:27], v[60:63], v[208:215], v1
    s_waitcnt vmcnt(2)
    v_max3_u32 v11, v48, v49, v50
    v_smfmac_f32_16x16x64_bf16 v[28:31], v[60:63], v[216:223], v1
    v_max_u32 v11, v11, v51
    v_cmp_eq_u32 vcc, -1, v11
    v_smfmac_f32_16x16x64_bf16 v[32:35], v[60:63], v[224:231], v1
    v_smfmac_f32_16x16x64_bf16 v[36:39], v[60:63], v[232:239], v1
    s_cbranch_vccz An_o012
    s_branch An_f012
An_f201:
    buffer_load_dwordx4 v[56:59], v2, s[4:7], s30 offen offset:2048 sc1
    s_sub_u32 s48, s48, 1
    s_cbranch_scc1 L_abort
    s_waitcnt vmcnt(2)
    v_max3_u32 v11, v48, v49, v50
    v_max_u32 v11, v11, v51
    v_cmp_eq_u32 vcc, -1, v11
    s_cbranch_vccnz An_f012
An_o012:
    v_smfmac_f32_16x16x64_bf16 v[24:27], v[48:51], v[64:71], v1
    s_waitcnt vmcnt(1)
    v_max3_u32 v11, v52, v53, v54
    v_smfmac_f32_16x16x64_bf16 v[28:31], v[48:51], v[72:79], v1
    v_max_u32 v11, v11, v55
    v_cmp_eq_u32 vcc, -1, v11
    v_smfmac_f32_16x16x64_bf16 v[32:35], v[48:51], v[80:87], v1
    v_smfmac_f32_16x16x64_bf16 v[36:39], v[48:51], v[88:95], v1
    s_cbranch_vccz An_o12
    s_branch An_f12
An_f21:
    buffer_load_dwordx4 v[56:59], v2, s[4:7], s30 offen offset:2048 sc1
    s_sub_u32 s48, s48, 1
    s_cbranch_scc1 L_abort
    s_waitcnt vmcnt(1)
    v_max3_u32 v11, v52, v53, v54
    v_max_u32 v11, v11, v55
    v_cmp_eq_u32 vcc, -1, v11
    s_cbranch_vccnz An_f12
An_o12:
    v_smfmac_f32_16x16x64_bf16 v[24:27], v[52:55], v[112:119], v1
    s_waitcnt vmcnt(0)
    v_max3_u32 v11, v56, v57, v58
    v_smfmac_f32_16x16x64_bf16 v[28:31], v[52:55], v[120:127], v1
    v_max_u32 v11, v11, v59
    v_cmp_eq_u32 vcc, -1, v11
    v_smfmac_f32_16x16x64_bf16 v[32:35], v[52:55], v[128:135], v1
    v_smfmac_f32_16x16x64_bf16 v[36:39], v[52:55], v[136:143], v1
    s_cbranch_vccz An_o2
    s_branch An_f2
An_f012:
    buffer_load_dwordx4 v[48:51], v2, s[4:7], s30 offen offset:0 sc1
    s_sub_u32 s48, s48, 1
    s_cbranch_scc1 L_abort
    s_waitcnt vmcnt(2)
    v_max3_u32 v11, v52, v53, v54
    v_max_u32 v11, v11, v55
    v_cmp_eq_u32 vcc, -1, v11
    s_cbranch_vccnz An_f120
An_o120:
    v_smfmac_f32_16x16x64_bf16 v[24:27], v[52:55], v[112:119], v1
    s_waitcnt vmcnt(1)
    v_max3_u32 v11, v56, v57, v58
    v_smfmac_f32_16x16x64_bf16 v[28:31], v[52:55], v[120:127], v1
    v_max_u32 v11, v11, v59
    v_cmp_eq_u32 vcc, -1, v11
    v_smfmac_f32_16x16x64_bf16 v[32:35], v[52:55], v[128:135], v1
    v_smfmac_f32_16x16x64_bf16 v[36:39], v[52:55], v[136:143], v1
    s_cbranch_vccz An_o20
    s_branch An_f20
An_f120:
    buffer_load_dwordx4 v[52:55], v2, s[4:7], s30 offen offset:1024 sc1
    s_sub_u32 s48, s48, 1
    s_cbranch_scc1 L_abort
    s_waitcnt vmcnt(2)
    v_max3_u32 v11, v56, v57, v58
    v_max_u32 v11, v11, v59
    v_cmp_eq_u32 vcc, -1, v11
    s_cbranch_vccnz An_f201
An_o201:
    v_smfmac_f32_16x16x64_bf16 v[24:27], v[56:59], v[160:167], v1
    s_waitcnt vmcnt(1)
    v_max3_u32 v11, v48, v49, v50
    v_smfmac_f32_16x16x64_bf16 v[28:31], v[56:59], v[168:175], v1
    v_max_u32 v11, v11, v51
    v_cmp_eq_u32 vcc, -1, v11
    v_smfmac_f32_16x16x64_bf16 v[32:35], v[56:59], v[176:183], v1
    v_smfmac_f32_16x16x64_bf16 v[36:39], v[56:59], v[184:191], v1
    s_cbranch_vccz An_o01
    s_branch An_f01
An_f301:
    buffer_load_dwordx4 v[60:63], v2, s[4:7], s30 offen offset:3072 sc1
    s_sub_u32 s48, s48, 1
    s_cbranch_scc1 L_abort
    s_waitcnt vmcnt(2)
    v_max3_u32 v11, v48, v49, v50
    v_max_u32 v11, v11, v51
    v_cmp_eq_u32 vcc, -1, v11
    s_cbranch_vccnz An_f013
An_o013:
    v_smfmac_f32_16x16x64_bf16 v[24:27], v[48:51], v[64:71], v1
    s_waitcnt vmcnt(1)
    v_max3_u32 v11, v52, v53, v54
    v_smfmac_f32_16x16x64_bf16 v[28:31], v[48:51], v[72:79], v1
    v_max_u32 v11, v11, v55
    v_cmp_eq_u32 vcc, -1, v11
    v_smfmac_f32_16x16x64_bf16 v[32:35], v[48:51], v[80:87], v1
    v_smfmac_f32_16x16x64_bf16 v[36:39], v[48:51], v[88:95], v1
    s_cbranch_vccz An_o13
    s_branch An_f13
An_f013:
    buffer_load_dwordx4 v[48:51], v2, s[4:7], s30 offen offset:0 sc1
    s_sub_u32 s48, s48, 1
    s_cbranch_scc1 L_abort
    s_waitcnt vmcnt(2)
    v_max3_u32 v11, v52, v53, v54
    v_max_u32 v11, v11, v55
    v_cmp_eq_u32 vcc, -1, v11
    s_cbranch_vccnz An_f130
An_o130:
    v_smfmac_f32_16x16x64_bf16 v[24:27], v[52:55], v[112:119], v1
    s_waitcnt vmcnt(1)
    v_max3_u32 v11, v60, v61, v62
    v_smfmac_f32_16x16x64_bf16 v[28:31], v[52:55], v[120:127], v1
    v_max_u32 v11, v11, v63
    v_cmp_eq_u32 vcc, -1, v11
    v_smfmac_f32_16x16x64_bf16 v[32:35], v[52:55], v[128:135], v1
    v_smfmac_f32_16x16x64_bf16 v[36:39], v[52:55], v[136:143], v1
    s_cbranch_vccz An_o30
    s_branch An_f30
An_f302:
    buffer_load_dwordx4 v[60:63], v2, s[4:7], s30 offen offset:3072 sc1
    s_sub_u32 s48, s48, 1
    s_cbranch_scc1 L_abort
    s_waitcnt vmcnt(2)
    v_max3_u32 v11, v48, v49, v50
    v_max_u32 v11, v11, v51
    v_cmp_eq_u32 vcc, -1, v11
    s_cbranch_vccnz An_f023
An_o023:
    v_smfmac_f32_16x16x64_bf16 v[24:27], v[48:51], v[64:71], v1
    s_waitcnt vmcnt(1)
    v_max3_u32 v11, v56, v57, v58
    v_smfmac_f32_16x16x64_bf16 v[28:31], v[48:51], v[72:79], v1
    v_max_u32 v11, v11, v59
    v_cmp_eq_u32 vcc, -1, v11
    v_smfmac_f32_16x16x64_bf16 v[32:35], v[48:51], v[80:87], v1
    v_smfmac_f32_16x16x64_bf16 v[36:39], v[48:51], v[88:95], v1
    s_cbranch_vccz An_o23
    s_branch An_f23
An_f230:
    buffer_load_dwordx4 v[56:59], v2, s[4:7], s30 offen offset:2048 sc1
    s_sub_u32 s48, s48, 1
    s_cbranch_scc1 L_abort
    s_waitcnt vmcnt(2)
    v_max3_u32 v11, v60, v61, v62
    v_max_u32 v11, v11, v63
    v_cmp_eq_u32 vcc, -1, v11
    s_cbranch_vccnz An_f302
An_o302:
    v_smfmac_f32_16x16x64_bf16 v[24:27], v[60:63], v[208:215], v1
    s_waitcnt vmcnt(1)
    v_max3_u32 v11, v48, v49, v50
    v_smfmac_f32_16x16x64_bf16 v[28:31], v[60:63], v[216:223], v1
    v_max_u32 v11, v11, v51
    v_cmp_eq_u32 vcc, -1, v11
    v_smfmac_f32_16x16x64_bf16 v[32:35], v[60:63], v[224:231], v1
    v_smfmac_f32_16x16x64_bf16 v[36:39], v[60:63], v[232:239], v1
    s_cbranch_vccz An_o02
    s_branch An_f02
An_f123:
    buffer_load_dwordx4 v[52:55], v2, s[4:7], s30 offen offset:1024 sc1
    s_sub_u32 s48, s48, 1
    s_cbranch_scc1 L_abort
    s_waitcnt vmcnt(2)
    v_max3_u32 v11, v56, v57, v58
    v_max_u32 v11, v11, v59
    v_cmp_eq_u32 vcc, -1, v11
    s_cbranch_vccnz An_f231
An_o231:
    v_smfmac_f32_16x16x64_bf16 v[24:27], v[56:59], v[160:167], v1
    s_waitcnt vmcnt(1)
    v_max3_u32 v11, v60, v61, v62
    v_smfmac_f32_16x16x64_bf16 v[28:31], v[56:59], v[168:175], v1
    v_max_u32 v11, v11, v63
    v_cmp_eq_u32 vcc, -1, v11
    v_smfmac_f32_16x16x64_bf16 v[32:35], v[56:59], v[176:183], v1
    v_smfmac_f32_16x16x64_bf16 v[36:39], v[56:59], v[184:191], v1
    s_cbranch_vccz An_o31
    s_branch An_f31
An_f231:
    buffer_load_dwordx4 v[56:59], v2, s[4:7], s30 offen offset:2048 sc1
    s_sub_u32 s48, s48, 1
    s_cbranch_scc1 L_abort
    s_waitcnt vmcnt(2)
    v_max3_u32 v11, v60, v61, v62
    v_max_u32 v11, v11, v63
    v_cmp_eq_u32 vcc, -1, v11
    s_cbranch_vccnz An_f312
An_o312:
    v_smfmac_f32_16x16x64_bf16 v[24:27], v[60:63], v[208:215], v1
    s_waitcnt vmcnt(1)
    v_max3_u32 v11, v52, v53, v54
    v_smfmac_f32_16x16x64_bf16 v[28:31], v[60:63], v[216:223], v1
    v_max_u32 v11, v11, v55
    v_cmp_eq_u32 vcc, -1, v11
    v_smfmac_f32_16x16x64_bf16 v[32:35], v[60:63], v[224:231], v1
    v_smfmac_f32_16x16x64_bf16 v[36:39], v[60:63], v[232:239], v1
    s_cbranch_vccz An_o12
    s_branch An_f12
An_f01:
    buffer_load_dwordx4 v[48:51], v2, s[4:7], s30 offen offset:0 sc1
    s_sub_u32 s48, s48, 1
    s_cbranch_scc1 L_abort
    s_waitcnt vmcnt(1)
    v_max3_u32 v11, v52, v53, v54
    v_max_u32 v11, v11, v55
    v_cmp_eq_u32 vcc, -1, v11
    s_cbranch_vccnz An_f10
An_o10:
    v_smfmac_f32_16x16x64_bf16 v[24:27], v[52:55], v[112:119], v1
    s_waitcnt vmcnt(0)
    v_max3_u32 v11, v48, v49, v50
    v_smfmac_f32_16x16x64_bf16 v[28:31], v[52:55], v[120:127], v1
    v_max_u32 v11, v11, v51
    v_cmp_eq_u32 vcc, -1, v11
    v_smfmac_f32_16x16x64_bf16 v[32:35], v[52:55], v[128:135], v1
    v_smfmac_f32_16x16x64_bf16 v[36:39], v[52:55], v[136:143], v1
    s_cbranch_vccz An_o0
    s_branch An_f0
An_f20:
    buffer_load_dwordx4 v[56:59], v2, s[4:7], s30 offen offset:2048 sc1
    s_sub_u32 s48, s48, 1
    s_cbranch_scc1 L_abort
    s_waitcnt vmcnt(1)
    v_max3_u32 v11, v48, v49, v50
    v_max_u32 v11, v11, v51
    v_cmp_eq_u32 vcc, -1, v11
    s_cbranch_vccnz An_f02
An_o02:
    v_smfmac_f32_16x16x64_bf16 v[24:27], v[48:51], v[64:71], v1
    s_waitcnt vmcnt(0)
    v_max3_u32 v11, v56, v57, v58
    v_smfmac_f32_16x16x64_bf16 v[28:31], v[48:51], v[72:79], v1
    v_max_u32 v11, v11, v59
    v_cmp_eq_u32 vcc, -1, v11
    v_smfmac_f32_16x16x64_bf16 v[32:35], v[48:51], v[80:87], v1
    v_smfmac_f32_16x16x64_bf16 v[36:39], v[48:51], v[88:95], v1
    s_cbranch_vccz An_o2
    s_branch An_f2
An_f02:
    buffer_load_dwordx4 v[48:51], v2, s[4:7], s30 offen offset:0 sc1
    s_sub_u32 s48, s48, 1
    s_cbranch_scc1 L_abort
    s_waitcnt vmcnt(1)
    v_max3_u32 v11, v56, v57, v58
    v_max_u32 v11, v11, v59
    v_cmp_eq_u32 vcc, -1, v11
    s_cbranch_vccnz An_f20
An_o20:
    v_smfmac_f32_16x16x64_bf16 v[24:27], v[56:59], v[160:167], v1
    s_waitcnt vmcnt(0)
    v_max3_u32 v11, v48, v49, v50
    v_smfmac_f32_16x16x64_bf16 v[28:31], v[56:59], v[168:175], v1
    v_max_u32 v11, v11, v51
    v_cmp_eq_u32 vcc, -1, v11
    v_smfmac_f32_16x16x64_bf16 v[32:35], v[56:59], v[176:183], v1
    v_smfmac_f32_16x16x64_bf16 v[36:39], v[56:59], v[184:191], v1
    s_cbranch_vccz An_o0
    s_branch An_f0
An_f30:
    buffer_load_dwordx4 v[60:63], v2, s[4:7], s30 offen offset:3072 sc1
    s_sub_u32 s48, s48, 1
    s_cbranch_scc1 L_abort
    s_waitcnt vmcnt(1)
    v_max3_u32 v11, v48, v49, v50
    v_max_u32 v11, v11, v51
    v_cmp_eq_u32 vcc, -1, v11
    s_cbranch_vccnz An_f03
An_o03:
    v_smfmac_f32_16x16x64_bf16 v[24:27], v[48:51], v[64:71], v1
    s_waitcnt vmcnt(0)
    v_max3_u32 v11, v60, v61, v62
    v_smfmac_f32_16x16x64_bf16 v[28:31], v[48:51], v[72:79], v1
    v_max_u32 v11, v11, v63
    v_cmp_eq_u32 vcc, -1, v11
    v_smfmac_f32_16x16x64_bf16 v[32:35], v[48:51], v[80:87], v1
    v_smfmac_f32_16x16x64_bf16 v[36:39], v[48:51], v[88:95], v1
    s_cbranch_vccz An_o3
    s_branch An_f3
An_f12:
    buffer_load_dwordx4 v[52:55], v2, s[4:7], s30 offen offset:1024 sc1
    s_sub_u32 s48, s48, 1
    s_cbranch_scc1 L_abort
    s_waitcnt vmcnt(1)
    v_max3_u32 v11, v56, v57, v58
    v_max_u32 v11, v11, v59
    v_cmp_eq_u32 vcc, -1, v11
    s_cbranch_vccnz An_f21
An_o21:
    v_smfmac_f32_16x16x64_bf16 v[24:27], v[56:59], v[160:167], v1
    s_waitcnt vmcnt(0)
    v_max3_u32 v11, v52, v53, v54
    v_smfmac_f32_16x16x64_bf16 v[28:31], v[56:59], v[168:175], v1
    v_max_u32 v11, v11, v55
    v_cmp_eq_u32 vcc, -1, v11
    v_smfmac_f32_16x16x64_bf16 v[32:35], v[56:59], v[176:183], v1
    v_smfmac_f32_16x16x64_bf16 v[36:39], v[56:59], v[184:191], v1
    s_cbranch_vccz An_o1
    s_branch An_f1
An_f31:
    buffer_load_dwordx4 v[60:63], v2, s[4:7], s30 offen offset:3072 sc1
    s_sub_u32 s48, s48, 1
    s_cbranch_scc1 L_abort
    s_waitcnt vmcnt(1)
    v_max3_u32 v11, v52, v53, v54
    v_max_u32 v11, v11, v55
    v_cmp_eq_u32 vcc, -1, v11
    s_cbranch_vccnz An_f13
An_o13:
    v_smfmac_f32_16x16x64_bf16 v[24:27], v[52:55], v[112:119], v1
    s_waitcnt vmcnt(0)
    v_max3_u32 v11, v60, v61, v62
    v_smfmac_f32_16x16x64_bf16 v[28:31], v[52:55], v[120:127], v1
    v_max_u32 v11, v11, v63
    v_cmp_eq_u32 vcc, -1, v11
    v_smfmac_f32_16x16x64_bf16 v[32:35], v[52:55], v[128:135], v1
    v_smfmac_f32_16x16x64_bf16 v[36:39], v[52:55], v[136:143], v1
    s_cbranch_vccz An_o3
    s_branch An_f3
An_f13:
    buffer_load_dwordx4 v[52:55], v2, s[4:7], s30 offen offset:1024 sc1
    s_sub_u32 s48, s48, 1
    s_cbranch_scc1 L_abort
    s_waitcnt vmcnt(1)
    v_max3_u32 v11, v60, v61, v62
    v_max_u32 v11, v11, v63
    v_cmp_eq_u32 vcc, -1, v11
    s_cbranch_vccnz An_f31
An_o31:
    v_smfmac_f32_16x16x64_bf16 v[24:27], v[60:63], v[208:215], v1
    s_waitcnt vmcnt(0)
    v_max3_u32 v11, v52, v53, v54
    v_smfmac_f32_16x16x64_bf16 v[28:31], v[60:63], v[216:223], v1
    v_max_u32 v11, v11, v55
    v_cmp_eq_u32 vcc, -1, v11
    v_smfmac_f32_16x16x64_bf16 v[32:35], v[60:63], v[224:231], v1
    v_smfmac_f32_16x16x64_bf16 v[36:39], v[60:63], v[232:239], v1
    s_cbranch_vccz An_o1
    s_branch An_f1
An_f23:
    buffer_load_dwordx4 v[56:59], v2, s[4:7], s30 offen offset:2048 sc1
    s_sub_u32 s48, s48, 1
    s_cbranch_scc1 L_abort
    s_waitcnt vmcnt(1)
    v_max3_u32 v11, v60, v61, v62
    v_max_u32 v11, v11, v63
    v_cmp_eq_u32 vcc, -1, v11
    s_cbranch_vccnz An_f32
An_o32:
    v_smfmac_f32_16x16x64_bf16 v[24:27], v[60:63], v[208:215], v1
    s_waitcnt vmcnt(0)
    v_max3_u32 v11, v56, v57, v58
    v_smfmac_f32_16x16x64_bf16 v[28:31], v[60:63], v[216:223], v1
    v_max_u32 v11, v11, v59
    v_cmp_eq_u32 vcc, -1, v11
    v_smfmac_f32_16x16x64_bf16 v[32:35], v[60:63], v[224:231], v1
    v_smfmac_f32_16x16x64_bf16 v[36:39], v[60:63], v[232:239], v1
    s_cbranch_vccz An_o2
    s_branch An_f2
An_f0:
    buffer_load_dwordx4 v[48:51], v2, s[4:7], s30 offen offset:0 sc1
    s_sub_u32 s48, s48, 1
    s_cbranch_scc1 L_abort
    s_waitcnt vmcnt(0)
    v_max3_u32 v11, v48, v49, v50
    v_max_u32 v11, v11, v51
    v_cmp_eq_u32 vcc, -1, v11
    s_cbranch_vccnz An_f0
An_o0:
    v_smfmac_f32_16x16x64_bf16 v[24:27], v[48:51], v[64:71], v1
    s_nop 0
    v_smfmac_f32_16x16x64_bf16 v[28:31], v[48:51], v[72:79], v1
    v_smfmac_f32_16x16x64_bf16 v[32:35], v[48:51], v[80:87], v1
    v_smfmac_f32_16x16x64_bf16 v[36:39], v[48:51], v[88:95], v1
    s_branch An_tail
An_f1:
    buffer_load_dwordx4 v[52:55], v2, s[4:7], s30 offen offset:1024 sc1
    s_sub_u32 s48, s48, 1
    s_cbranch_scc1 L_abort
    s_waitcnt vmcnt(0)
    v_max3_u32 v11, v52, v53, v54
    v_max_u32 v11, v11, v55
    v_cmp_eq_u32 vcc, -1, v11
    s_cbranch_vccnz An_f1
An_o1:
    v_smfmac_f32_16x16x64_bf16 v[24:27], v[52:55], v[112:119], v1
    s_nop 0
    v_smfmac_f32_16x16x64_bf16 v[28:31], v[52:55], v[120:127], v1
    v_smfmac_f32_16x16x64_bf16 v[32:35], v[52:55], v[128:135], v1
    v_smfmac_f32_16x16x64_bf16 v[36:39], v[52:55], v[136:143], v1
    s_branch An_tail
An_f2:
    buffer_load_dwordx4 v[56:59], v2, s[4:7], s30 offen offset:2048 sc1
    s_sub_u32 s48, s48, 1
    s_cbranch_scc1 L_abort
    s_waitcnt vmcnt(0)
    v_max3_u32 v11, v56, v57, v58
    v_max_u32 v11, v11, v59
    v_cmp_eq_u32 vcc, -1, v11
    s_cbranch_vccnz An_f2
An_o2:
    v_smfmac_f32_16x16x64_bf16 v[24:27], v[56:59], v[160:167], v1
    s_nop 0
    v_smfmac_f32_16x16x64_bf16 v[28:31], v[56:59], v[168:175], v1
    v_smfmac_f32_16x16x64_bf16 v[32:35], v[56:59], v[176:183], v1
    v_smfmac_f32_16x16x64_bf16 v[36:39], v[56:59], v[184:191], v1
    s_branch An_tail
An_f3:
    buffer_load_dwordx4 v[60:63], v2, s[4:7], s30 offen offset:3072 sc1
    s_sub_u32 s48, s48, 1
    s_cbranch_scc1 L_abort
    s_waitcnt vmcnt(0)
    v_max3_u32 v11, v60, v61, v62
    v_max_u32 v11, v11, v63
    v_cmp_eq_u32 vcc, -1, v11
    s_cbranch_vccnz An_f3
    s_branch An_o3
An_z:
    buffer_load_dwordx4 v[48:51], v2, s[4:7], s30 offen offset:0 sc1
    s_sub_u32 s48, s48, 1
    s_cbranch_scc1 L_abort
    s_nop 3
    v_mov_b64 v[24:25], 0
    v_mov_b64 v[26:27], 0
    v_mov_b64 v[28:29], 0
    v_mov_b64 v[30:31], 0
    v_mov_b64 v[32:33], 0
    v_mov_b64 v[34:35], 0
    v_mov_b64 v[36:37], 0
    v_mov_b64 v[38:39], 0
    s_waitcnt vmcnt(3)
    v_max3_u32 v11, v52, v53, v54
    v_max_u32 v11, v11, v55
    v_cmp_eq_u32 vcc, -1, v11
    s_cbranch_vccz An_o1230
    s_branch An_f1230
An_slow3:
    buffer_load_dwordx4 v[48:51], v4, s[4:7], s31 offen sc1
    s_sub_u32 s48, s48, 1
    s_cbranch_scc1 L_abort
    s_waitcnt vmcnt(0)
    v_max3_u32 v11, v48, v49, v50
    v_max_u32 v11, v11, v51
    v_cmp_eq_u32 vcc, -1, v11
    s_cbranch_vccnz An_slow3
    v_mfma_f32_16x16x32_bf16 v[52:55], v[16:19], v[48:51], 0
    s_nop 2
    s_branch An_r4
L_rec_lastA:
    buffer_store_dword v12, v13, s[4:7], s59 offen sc1
    s_waitcnt vmcnt(0)
    s_barrier
    s_branch L_done
L_rec_B:
    v_and_b32 v44, 63, v0
    v_mov_b32 v9, 0
    v_and_b32 v47, 127, v0
    s_setprio 3
    s_mul_i32 s39, s25, 8
    s_mul_i32 s47, s61, 4
    s_add_u32 s39, s39, s47
    s_mul_i32 s47, s60, 1
    s_add_u32 s39, s39, s47
    s_mul_i32 s32, s25, 16384
    s_mul_i32 s47, s26, 512
    s_add_u32 s32, s32, s47
    s_mul_i32 s33, s71, 6144
    s_bfe_u32 s47, s26, 0x20000
    s_mul_i32 s47, s47, 1024
    s_add_u32 s33, s33, s47
    s_add_u32 s33, s33, 65024
    s_mul_i32 s34, s71, 6144
    s_bfe_u32 s47, s26, 0x20000
    s_mul_i32 s47, s47, 512
    s_add_u32 s34, s34, s47
    s_add_u32 s34, s34, 68096
    v_mov_b32 v45, s32
    v_mov_b32 v46, s33
    v_cmp_le_u32 vcc, 32, v47
    s_nop 1
    v_cndmask_b32 v45, v45, v46, vcc
    v_mov_b32 v46, s34
    v_cmp_le_u32 vcc, 0x60, v47
    s_nop 1
    v_cndmask_b32 v45, v45, v46, vcc
    v_lshl_add_u32 v56, v47, 4, v45
    v_mov_b32 v96, -1
    v_mov_b32 v97, -1
    v_mov_b32 v98, -1
    v_mov_b32 v99, -1
    s_bfe_u32 s47, s60, 0x10001
    s_mul_i32 s32, s47, 524288
    s_add_u32 s32, s32, 96468992
    buffer_store_dwordx4 v[96:99], v56, s[4:7], s32 offen sc1
    s_add_u32 s32, s32, 262144
    buffer_store_dwordx4 v[96:99], v56, s[4:7], s32 offen sc1
    s_mul_i32 s51, s71, 512
    s_bfe_u32 s47, s26, 0x20000
    s_mul_i32 s47, s47, 128
    s_add_u32 s51, s51, s47
    s_add_u32 s51, s51, 98582528
    s_mul_i32 s3, s25, 128
    s_add_u32 s3, s3, 98568192
    s_cmp_lg_u32 s24, 4
    s_cbranch_scc1 GC_44
    s_mov_b64 exec, 1
    buffer_store_dword v9, v9, s[4:7], s3 offen sc1
    buffer_store_dword v9, v9, s[4:7], s51 offen offset:0 sc1
    s_mov_b64 exec, -1
GC_44:
    s_barrier
    s_waitcnt vmcnt(0)
    v_mov_b32 v46, 1
    v_mov_b32 v45, 163832
    s_mov_b64 exec, 1
    ds_add_rtn_u32 v46, v45, v46
    s_waitcnt lgkmcnt(0)
    v_readfirstlane_b32 s32, v46
    s_mov_b64 exec, -1
    s_nop 2
    s_cmp_lg_u32 s32, 3
    s_cbranch_scc1 NL_45
    s_mov_b32 s72, 1
    s_atomic_add s72, s[20:21], 4
NL_45:
    s_load_dwordx2 s[44:45], s[0:1], 40
    s_mul_i32 s32, s39, 262144
    s_mul_i32 s47, s62, 128
    s_add_u32 s32, s32, s47
    v_bfe_u32 v45, v44, 4, 2
    v_lshlrev_b32 v10, 14, v45
    v_and_b32 v45, 15, v44
    v_lshl_add_u32 v10, v45, 3, v10
    v_add_u32 v10, s32, v10
    s_mov_b32 s56, 0x05040100
    s_mov_b32 s57, 0x07060302
    s_waitcnt lgkmcnt(0)
    s_mov_b32 s8, s44
    s_and_b32 s9, s45, 0xffff
    s_mov_b32 s10, 8388608
    s_mov_b32 s11, 0x20000
    s_mov_b32 s32, 0
    buffer_load_dwordx2 v[128:129], v10, s[8:11], s32 offen nt
    s_mov_b32 s32, 2048
    buffer_load_dwordx2 v[130:131], v10, s[8:11], s32 offen nt
    s_mov_b32 s32, 4096
    buffer_load_dwordx2 v[132:133], v10, s[8:11], s32 offen nt
    s_mov_b32 s32, 6144
    buffer_load_dwordx2 v[134:135], v10, s[8:11], s32 offen nt
    s_mov_b32 s32, 8192
    buffer_load_dwordx2 v[136:137], v10, s[8:11], s32 offen nt
    s_mov_b32 s32, 10240
    buffer_load_dwordx2 v[138:139], v10, s[8:11], s32 offen nt
    s_mov_b32 s32, 12288
    buffer_load_dwordx2 v[140:141], v10, s[8:11], s32 offen nt
    s_mov_b32 s32, 14336
    buffer_load_dwordx2 v[142:143], v10, s[8:11], s32 offen nt
    s_mov_b32 s32, 65536
    buffer_load_dwordx2 v[144:145], v10, s[8:11], s32 offen nt
    s_mov_b32 s32, 67584
    buffer_load_dwordx2 v[146:147], v10, s[8:11], s32 offen nt
    s_mov_b32 s32, 69632
    buffer_load_dwordx2 v[148:149], v10, s[8:11], s32 offen nt
    s_mov_b32 s32, 71680
    buffer_load_dwordx2 v[150:151], v10, s[8:11], s32 offen nt
    s_mov_b32 s32, 73728
    buffer_load_dwordx2 v[152:153], v10, s[8:11], s32 offen nt
    s_mov_b32 s32, 75776
    buffer_load_dwordx2 v[154:155], v10, s[8:11], s32 offen nt
    s_mov_b32 s32, 77824
    buffer_load_dwordx2 v[156:157], v10, s[8:11], s32 offen nt
    s_mov_b32 s32, 79872
    buffer_load_dwordx2 v[158:159], v10, s[8:11], s32 offen nt
    s_mov_b32 s32, 131072
    buffer_load_dwordx2 v[160:161], v10, s[8:11], s32 offen nt
    s_mov_b32 s32, 133120
    buffer_load_dwordx2 v[162:163], v10, s[8:11], s32 offen nt
    s_mov_b32 s32, 135168
    buffer_load_dwordx2 v[164:165], v10, s[8:11], s32 offen nt
    s_mov_b32 s32, 137216
    buffer_load_dwordx2 v[166:167], v10, s[8:11], s32 offen nt
    s_mov_b32 s32, 139264
    buffer_load_dwordx2 v[168:169], v10, s[8:11], s32 offen nt
    s_mov_b32 s32, 141312
    buffer_load_dwordx2 v[170:171], v10, s[8:11], s32 offen nt
    s_mov_b32 s32, 143360
    buffer_load_dwordx2 v[172:173], v10, s[8:11], s32 offen nt
    s_mov_b32 s32, 145408
    buffer_load_dwordx2 v[174:175], v10, s[8:11], s32 offen nt
    s_mov_b32 s32, 196608
    buffer_load_dwordx2 v[176:177], v10, s[8:11], s32 offen nt
    s_mov_b32 s32, 198656
    buffer_load_dwordx2 v[178:179], v10, s[8:11], s32 offen nt
    s_mov_b32 s32, 200704
    buffer_load_dwordx2 v[180:181], v10, s[8:11], s32 offen nt
    s_mov_b32 s32, 202752
    buffer_load_dwordx2 v[182:183], v10, s[8:11], s32 offen nt
    s_mov_b32 s32, 204800
    buffer_load_dwordx2 v[184:185], v10, s[8:11], s32 offen nt
    s_mov_b32 s32, 206848
    buffer_load_dwordx2 v[186:187], v10, s[8:11], s32 offen nt
    s_mov_b32 s32, 208896
    buffer_load_dwordx2 v[188:189], v10, s[8:11], s32 offen nt
    s_mov_b32 s32, 210944
    buffer_load_dwordx2 v[190:191], v10, s[8:11], s32 offen nt
    v_and_b32 v45, 2, v44
    v_cmp_eq_u32 vcc, 0, v45
    v_mov_b32 v1, 0xeeee
    v_mov_b32 v46, 0x4444
    v_cndmask_b32 v1, v1, v46, vcc
    v_mov_b32 v15, 0x7f800000
    v_cndmask_b32 v15, v15, v9, vcc
    v_mov_b32 v18, 0
    v_mov_b32 v19, 0
    v_mov_b32 v20, 0
    v_mov_b32 v21, 0
    v_mov_b32 v22, 0
    v_mov_b32 v23, 0
    v_mov_b32 v24, 0
    v_mov_b32 v25, 0
    v_mov_b32 v26, 0
    v_mov_b32 v27, 0
    v_mov_b32 v28, 0
    v_mov_b32 v29, 0
    v_mov_b32 v30, 0
    v_mov_b32 v31, 0
    v_mov_b32 v32, 0
    v_mov_b32 v33, 0
    v_mov_b32 v34, 0
    v_mov_b32 v35, 0
    v_mov_b32 v30, 0x3f803f80
    v_mov_b32 v31, 0x3f803f80
    v_mov_b32 v32, 0x3f803f80
    v_mov_b32 v33, 0x3f803f80
    s_mov_b32 s54, 0x3e0293ee
    s_mul_i32 s32, s39, 6144
    s_add_u32 s32, s32, 65536
    v_lshlrev_b32 v2, 4, v44
    v_add_u32 v2, s32, v2
    s_mul_i32 s32, s39, 16384
    v_lshlrev_b32 v8, 4, v44
    v_add_u32 v8, s32, v8
    s_mul_i32 s32, s60, 8192
    s_add_u32 s32, s32, 23808
    v_lshlrev_b32 v7, 4, v44
    v_add_u32 v7, s32, v7
    s_mul_i32 s32, s60, 544
    s_add_u32 s32, s32, 1536
    v_lshlrev_b32 v5, 3, v44
    v_add_u32 v5, s32, v5
    s_mul_i32 s32, s60, 2304
    s_add_u32 s32, s32, 14592
    v_lshlrev_b32 v6, 4, v44
    v_add_u32 v6, s32, v6
    v_lshlrev_b32 v14, 2, v44
    v_mov_b32 v13, 1
    ds_write_b32 v14, v9
    ds_write_b32 v14, v9 offset:256
    s_mul_i32 s32, s60, 256
    s_add_u32 s32, s32, 512
    v_add_u32 v12, s32, v14
    s_mul_i32 s32, s71, 6144
    s_bfe_u32 s47, s26, 0x20000
    s_mul_i32 s47, s47, 1024
    s_add_u32 s32, s32, s47
    s_mul_i32 s47, s60, 256
    s_add_u32 s32, s32, s47
    s_add_u32 s32, s32, 65536
    v_lshlrev_b32 v4, 2, v44
    v_add_u32 v4, s32, v4
    s_mul_i32 s32, s71, 4096
    s_bfe_u32 s47, s26, 0x20000
    s_mul_i32 s47, s47, 512
    s_add_u32 s32, s32, s47
    s_mul_i32 s47, s60, 128
    s_add_u32 s32, s32, s47
    v_bfe_u32 v45, v44, 4, 2
    v_lshlrev_b32 v0, 5, v45
    v_bfe_u32 v45, v44, 2, 1
    v_lshl_add_u32 v0, v45, 4, v0
    v_and_b32 v45, 3, v44
    v_lshl_add_u32 v0, v45, 2, v0
    v_add_u32 v0, s32, v0
    v_and_b32 v45, 8, v44
    v_cmp_eq_u32 vcc, 0, v45
    v_mov_b32 v46, 2147483632
    s_nop 0
    v_cndmask_b32 v0, v0, v46, vcc
    s_mul_i32 s50, s25, 131072
    s_mul_i32 s47, s61, 65536
    s_add_u32 s50, s50, s47
    s_mul_i32 s47, s62, 4096
    s_add_u32 s50, s50, s47
    s_mul_i32 s47, s60, 1024
    s_add_u32 s50, s50, s47
    s_add_u32 s50, s50, 1048576
    s_mul_i32 s70, s25, 256
    s_mul_i32 s47, s61, 128
    s_add_u32 s70, s70, s47
    s_add_u32 s70, s70, 98566144
    s_waitcnt vmcnt(0)
    v_perm_b32 v192, v130, v128, s56
    v_perm_b32 v208, v130, v128, s57
    v_perm_b32 v224, v131, v129, s56
    v_perm_b32 v240, v131, v129, s57
    v_perm_b32 v193, v134, v132, s56
    v_perm_b32 v209, v134, v132, s57
    v_perm_b32 v225, v135, v133, s56
    v_perm_b32 v241, v135, v133, s57
    v_perm_b32 v194, v138, v136, s56
    v_perm_b32 v210, v138, v136, s57
    v_perm_b32 v226, v139, v137, s56
    v_perm_b32 v242, v139, v137, s57
    v_perm_b32 v195, v142, v140, s56
    v_perm_b32 v211, v142, v140, s57
    v_perm_b32 v227, v143, v141, s56
    v_perm_b32 v243, v143, v141, s57
    v_perm_b32 v196, v146, v144, s56
    v_perm_b32 v212, v146, v144, s57
    v_perm_b32 v228, v147, v145, s56
    v_perm_b32 v244, v147, v145, s57
    v_perm_b32 v197, v150, v148, s56
    v_perm_b32 v213, v150, v148, s57
    v_perm_b32 v229, v151, v149, s56
    v_perm_b32 v245, v151, v149, s57
    v_perm_b32 v198, v154, v152, s56
    v_perm_b32 v214, v154, v152, s57
    v_perm_b32 v230, v155, v153, s56
    v_perm_b32 v246, v155, v153, s57
    v_perm_b32 v199, v158, v156, s56
    v_perm_b32 v215, v158, v156, s57
    v_perm_b32 v231, v159, v157, s56
    v_perm_b32 v247, v159, v157, s57
    v_perm_b32 v200, v162, v160, s56
    v_perm_b32 v216, v162, v160, s57
    v_perm_b32 v232, v163, v161, s56
    v_perm_b32 v248, v163, v161, s57
    v_perm_b32 v201, v166, v164, s56
    v_perm_b32 v217, v166, v164, s57
    v_perm_b32 v233, v167, v165, s56
    v_perm_b32 v249, v167, v165, s57
    v_perm_b32 v202, v170, v168, s56
    v_perm_b32 v218, v170, v168, s57
    v_perm_b32 v234, v171, v169, s56
    v_perm_b32 v250, v171, v169, s57
    v_perm_b32 v203, v174, v172, s56
    v_perm_b32 v219, v174, v172, s57
    v_perm_b32 v235, v175, v173, s56
    v_perm_b32 v251, v175, v173, s57
    v_perm_b32 v204, v178, v176, s56
    v_perm_b32 v220, v178, v176, s57
    v_perm_b32 v236, v179, v177, s56
    v_perm_b32 v252, v179, v177, s57
    v_perm_b32 v205, v182, v180, s56
    v_perm_b32 v221, v182, v180, s57
    v_perm_b32 v237, v183, v181, s56
    v_perm_b32 v253, v183, v181, s57
    v_perm_b32 v206, v186, v184, s56
    v_perm_b32 v222, v186, v184, s57
    v_perm_b32 v238, v187, v185, s56
    v_perm_b32 v254, v187, v185, s57
    v_perm_b32 v207, v190, v188, s56
    v_perm_b32 v223, v190, v188, s57
    v_perm_b32 v239, v191, v189, s56
    v_perm_b32 v255, v191, v189, s57
    s_load_dwordx2 s[40:41], s[0:1], 8
    s_mul_i32 s32, s26, 64
    s_bfe_u32 s47, s60, 0x10001
    s_mul_i32 s47, s47, 32
    s_add_u32 s32, s32, s47
    s_bfe_u32 s47, s60, 0x10000
    s_mul_i32 s47, s47, 8192
    s_add_u32 s32, s32, s47
    v_bfe_u32 v45, v44, 2, 1
    v_lshlrev_b32 v47, 12, v45
    v_and_b32 v45, 1, v44
    v_lshl_add_u32 v47, v45, 11, v47
    v_bfe_u32 v45, v44, 1, 1
    v_lshl_add_u32 v47, v45, 2, v47
    v_bfe_u32 v45, v44, 4, 1
    v_lshl_add_u32 v47, v45, 4, v47
    v_bfe_u32 v45, v44, 5, 1
    v_lshl_add_u32 v47, v45, 1, v47
    v_add_u32 v47, s32, v47
    s_waitcnt lgkmcnt(0)
    s_mov_b32 s8, s40
    s_and_b32 s9, s41, 0xffff
    s_mov_b32 s10, 16384
    s_mov_b32 s11, 0x20000
    buffer_load_ushort v40, v47, s[8:11], 0 offen
    buffer_load_ushort v41, v47, s[8:11], 0 offen offset:8
    s_mul_i32 s32, s25, 16384
    s_mul_i32 s47, s26, 512
    s_add_u32 s32, s32, s47
    s_mul_i32 s47, s60, 128
    s_add_u32 s32, s32, s47
    s_add_u32 s32, s32, 96468992
    v_and_b32 v45, 7, v44
    v_lshlrev_b32 v47, 4, v45
    v_bfe_u32 v45, v44, 4, 2
    v_lshl_add_u32 v47, v45, 2, v47
    v_add_u32 v47, s32, v47
    v_mov_b32 v46, 163824
    s_mov_b32 s48, 400000
BC_46:
    ds_read_b32 v45, v46 offset:8
    s_sub_u32 s48, s48, 1
    s_cbranch_scc1 L_abort
    s_waitcnt lgkmcnt(0)
    v_cmp_gt_u32 vcc, 4, v45
    s_cbranch_vccnz BC_46
    s_mov_b32 s48, 400000
WI_47:
    buffer_load_dword v45, v9, s[4:7], s3 offen sc1
    s_sub_u32 s48, s48, 1
    s_cbranch_scc1 L_abort
    s_waitcnt vmcnt(0)
    v_readfirstlane_b32 s29, v45
    s_nop 3
    s_cmp_lg_u32 s29, 0
    s_cbranch_scc1 WE_48
    s_sleep 8
    s_branch WI_47
WE_48:
    s_bfe_u32 s27, s29, 0x10008
    s_bfe_u32 s47, s60, 0x10001
    s_mul_i32 s32, s47, 524288
    s_add_u32 s32, s32, 96468992
    buffer_load_dword v45, v56, s[4:7], s32 offen sc1
    s_add_u32 s32, s32, 262144
    buffer_load_dword v45, v56, s[4:7], s32 offen sc1
    s_lshl_b32 s32, s27, 8
    s_and_b32 s33, s29, 0xff
    s_or_b32 s32, s32, s33
    v_mov_b32 v42, s32
    ds_write_b32 v46, v42 offset:4
    v_lshl_or_b32 v40, v41, 16, v40
    v_min_u32 v40, -2, v40
    buffer_store_dword v40, v47, s[4:7], 0 offen sc1
    s_mov_b32 s58, 0
    s_cmp_lg_u32 s60, 0
    s_cbranch_scc1 BW_49
    s_mov_b32 s32, 1
    s_mov_b32 s48, 400000
KW_51:
    s_cmp_ge_u32 s58, s32
    s_cbranch_scc1 KD_52
    s_buffer_load_dwordx8 s[40:47], s[4:7], s70 glc
    s_sub_u32 s48, s48, 1
    s_cbranch_scc1 L_abort
    s_waitcnt lgkmcnt(0)
    s_min_u32 s58, s40, s41
    s_min_u32 s58, s58, s42
    s_min_u32 s58, s58, s43
    s_min_u32 s58, s58, s44
    s_min_u32 s58, s58, s45
    s_min_u32 s58, s58, s46
    s_min_u32 s58, s58, s47
    s_cmp_ge_u32 s58, s32
    s_cbranch_scc1 KD_52
    s_sleep 4
    s_branch KW_51
KD_52:
    v_mov_b32 v43, s58
    ds_write_b32 v46, v43 offset:12
BW_49:
    s_mov_b32 s48, 400000
BW_50:
    s_sleep 1
    ds_read_b32 v43, v46 offset:12
    s_sub_u32 s48, s48, 1
    s_cbranch_scc1 L_abort
    s_waitcnt lgkmcnt(0)
    v_cmp_gt_u32 vcc, 1, v43
    s_cbranch_vccnz BW_50
    s_mov_b32 s32, 8192
    buffer_load_dwordx4 v[128:131], v8, s[4:7], s32 offen offset:0 sc1
    s_mov_b32 s32, 8192
    buffer_load_dwordx4 v[132:135], v8, s[4:7], s32 offen offset:1024 sc1
    s_mov_b32 s32, 8192
    buffer_load_dwordx4 v[136:139], v8, s[4:7], s32 offen offset:2048 sc1
    s_mov_b32 s32, 8192
    buffer_load_dwordx4 v[140:143], v8, s[4:7], s32 offen offset:3072 sc1
    s_mov_b32 s32, 12288
    buffer_load_dwordx4 v[144:147], v8, s[4:7], s32 offen offset:0 sc1
    s_mov_b32 s32, 12288
    buffer_load_dwordx4 v[148:151], v8, s[4:7], s32 offen offset:1024 sc1
    s_mov_b32 s32, 12288
    buffer_load_dwordx4 v[152:155], v8, s[4:7], s32 offen offset:2048 sc1
    s_mov_b32 s32, 12288
    buffer_load_dwordx4 v[156:159], v8, s[4:7], s32 offen offset:3072 sc1
    s_mov_b32 s32, 0
    buffer_load_dwordx4 v[160:163], v8, s[4:7], s32 offen offset:0 sc1
    s_mov_b32 s32, 0
    buffer_load_dwordx4 v[164:167], v8, s[4:7], s32 offen offset:1024 sc1
    s_mov_b32 s32, 0
    buffer_load_dwordx4 v[168:171], v8, s[4:7], s32 offen offset:2048 sc1
    s_mov_b32 s32, 0
    buffer_load_dwordx4 v[172:175], v8, s[4:7], s32 offen offset:3072 sc1
    s_mov_b32 s32, 4096
    buffer_load_dwordx4 v[176:179], v8, s[4:7], s32 offen offset:0 sc1
    s_mov_b32 s32, 4096
    buffer_load_dwordx4 v[180:183], v8, s[4:7], s32 offen offset:1024 sc1
    s_mov_b32 s32, 4096
    buffer_load_dwordx4 v[184:187], v8, s[4:7], s32 offen offset:2048 sc1
    s_mov_b32 s32, 4096
    buffer_load_dwordx4 v[188:191], v8, s[4:7], s32 offen offset:3072 sc1
    s_waitcnt vmcnt(8)
    v_mfma_f32_16x16x32_bf16 v[96:99], v[144:147], v[192:195], 0
    v_mfma_f32_16x16x32_bf16 v[96:99], v[148:151], v[196:199], v[96:99]
    v_mfma_f32_16x16x32_bf16 v[96:99], v[152:155], v[200:203], v[96:99]
    v_mfma_f32_16x16x32_bf16 v[96:99], v[156:159], v[204:207], v[96:99]
    v_mfma_f32_16x16x32_bf16 v[100:103], v[144:147], v[208:211], 0
    v_mfma_f32_16x16x32_bf16 v[100:103], v[148:151], v[212:215], v[100:103]
    v_mfma_f32_16x16x32_bf16 v[100:103], v[152:155], v[216:219], v[100:103]
    v_mfma_f32_16x16x32_bf16 v[100:103], v[156:159], v[220:223], v[100:103]
    v_mfma_f32_16x16x32_bf16 v[104:107], v[144:147], v[224:227], 0
    v_mfma_f32_16x16x32_bf16 v[104:107], v[148:151], v[228:231], v[104:107]
    v_mfma_f32_16x16x32_bf16 v[104:107], v[152:155], v[232:235], v[104:107]
    v_mfma_f32_16x16x32_bf16 v[104:107], v[156:159], v[236:239], v[104:107]
    v_mfma_f32_16x16x32_bf16 v[108:111], v[144:147], v[240:243], 0
    v_mfma_f32_16x16x32_bf16 v[108:111], v[148:151], v[244:247], v[108:111]
    v_mfma_f32_16x16x32_bf16 v[108:111], v[152:155], v[248:251], v[108:111]
    v_mfma_f32_16x16x32_bf16 v[108:111], v[156:159], v[252:255], v[108:111]
    v_mfma_f32_16x16x32_bf16 v[80:83], v[128:131], v[192:195], 0
    v_mfma_f32_16x16x32_bf16 v[80:83], v[132:135], v[196:199], v[80:83]
    v_mfma_f32_16x16x32_bf16 v[80:83], v[136:139], v[200:203], v[80:83]
    v_mfma_f32_16x16x32_bf16 v[80:83], v[140:143], v[204:207], v[80:83]
    v_mfma_f32_16x16x32_bf16 v[84:87], v[128:131], v[208:211], 0
    v_mfma_f32_16x16x32_bf16 v[84:87], v[132:135], v[212:215], v[84:87]
    v_mfma_f32_16x16x32_bf16 v[84:87], v[136:139], v[216:219], v[84:87]
    v_mfma_f32_16x16x32_bf16 v[84:87], v[140:143], v[220:223], v[84:87]
    v_mfma_f32_16x16x32_bf16 v[88:91], v[128:131], v[224:227], 0
    v_mfma_f32_16x16x32_bf16 v[88:91], v[132:135], v[228:231], v[88:91]
    v_mfma_f32_16x16x32_bf16 v[88:91], v[136:139], v[232:235], v[88:91]
    v_mfma_f32_16x16x32_bf16 v[88:91], v[140:143], v[236:239], v[88:91]
    v_mfma_f32_16x16x32_bf16 v[92:95], v[128:131], v[240:243], 0
    v_mfma_f32_16x16x32_bf16 v[92:95], v[132:135], v[244:247], v[92:95]
    v_mfma_f32_16x16x32_bf16 v[92:95], v[136:139], v[248:251], v[92:95]
    v_mfma_f32_16x16x32_bf16 v[92:95], v[140:143], v[252:255], v[92:95]
    v_cvt_pk_bf16_f32 v114, v96, v97
    v_cvt_pk_bf16_f32 v115, v98, v99
    v_cvt_pk_bf16_f32 v118, v100, v101
    v_cvt_pk_bf16_f32 v119, v102, v103
    v_cvt_pk_bf16_f32 v122, v104, v105
    v_cvt_pk_bf16_f32 v123, v106, v107
    v_cvt_pk_bf16_f32 v126, v108, v109
    v_cvt_pk_bf16_f32 v127, v110, v111
    v_cvt_pk_bf16_f32 v112, v80, v81
    v_cvt_pk_bf16_f32 v113, v82, v83
    v_cvt_pk_bf16_f32 v116, v84, v85
    v_cvt_pk_bf16_f32 v117, v86, v87
    v_cvt_pk_bf16_f32 v120, v88, v89
    v_cvt_pk_bf16_f32 v121, v90, v91
    v_cvt_pk_bf16_f32 v124, v92, v93
    v_cvt_pk_bf16_f32 v125, v94, v95
    s_waitcnt lgkmcnt(0)
    s_barrier
    s_cmp_lg_u32 s60, 0
    s_cbranch_scc1 BW_53
    s_mov_b32 s32, 2
    s_mov_b32 s48, 400000
KW_55:
    s_cmp_ge_u32 s58, s32
    s_cbranch_scc1 KD_56
    s_buffer_load_dwordx8 s[40:47], s[4:7], s70 glc
    s_sub_u32 s48, s48, 1
    s_cbranch_scc1 L_abort
    s_waitcnt lgkmcnt(0)
    s_min_u32 s58, s40, s41
    s_min_u32 s58, s58, s42
    s_min_u32 s58, s58, s43
    s_min_u32 s58, s58, s44
    s_min_u32 s58, s58, s45
    s_min_u32 s58, s58, s46
    s_min_u32 s58, s58, s47
    s_cmp_ge_u32 s58, s32
    s_cbranch_scc1 KD_56
    s_sleep 4
    s_branch KW_55
KD_56:
    v_mov_b32 v43, s58
    ds_write_b32 v46, v43 offset:12
BW_53:
    s_mov_b32 s48, 400000
BW_54:
    s_sleep 1
    ds_read_b32 v43, v46 offset:12
    s_sub_u32 s48, s48, 1
    s_cbranch_scc1 L_abort
    s_waitcnt lgkmcnt(0)
    v_cmp_gt_u32 vcc, 2, v43
    s_cbranch_vccnz BW_54
    s_mov_b32 s32, 532480
    buffer_load_dwordx4 v[128:131], v8, s[4:7], s32 offen offset:0 sc1
    s_mov_b32 s32, 532480
    buffer_load_dwordx4 v[132:135], v8, s[4:7], s32 offen offset:1024 sc1
    s_mov_b32 s32, 532480
    buffer_load_dwordx4 v[136:139], v8, s[4:7], s32 offen offset:2048 sc1
    s_mov_b32 s32, 532480
    buffer_load_dwordx4 v[140:143], v8, s[4:7], s32 offen offset:3072 sc1
    s_mov_b32 s32, 536576
    buffer_load_dwordx4 v[144:147], v8, s[4:7], s32 offen offset:0 sc1
    s_mov_b32 s32, 536576
    buffer_load_dwordx4 v[148:151], v8, s[4:7], s32 offen offset:1024 sc1
    s_mov_b32 s32, 536576
    buffer_load_dwordx4 v[152:155], v8, s[4:7], s32 offen offset:2048 sc1
    s_mov_b32 s32, 536576
    buffer_load_dwordx4 v[156:159], v8, s[4:7], s32 offen offset:3072 sc1
    s_waitcnt vmcnt(4)
    ds_write_b128 v7, v[160:163] offset:0
    ds_write_b128 v7, v[128:131] offset:4096
    ds_write_b128 v7, v[164:167] offset:1024
    ds_write_b128 v7, v[132:135] offset:5120
    ds_write_b128 v7, v[168:171] offset:2048
    ds_write_b128 v7, v[136:139] offset:6144
    ds_write_b128 v7, v[172:175] offset:3072
    ds_write_b128 v7, v[140:143] offset:7168
    s_cmp_eq_u32 s60, 0
    s_cselect_b32 s58, s58, 64
    s_mov_b32 s28, 0
    s_setprio 0
    s_cmp_lg_u32 s27, 0
    s_cbranch_scc1 Bn_loop
    s_branch Bl_loop
    .p2align 6
Bl_loop:
    s_add_u32 s30, s28, 0
    s_and_b32 s30, s30, 3
    s_lshl_b32 s30, s30, 18
    s_add_u32 s30, s30, 96468992
    s_add_u32 s49, s30, 4096
    s_add_u32 s52, s28, 1
    s_lshl_b32 s52, s52, 19
    s_lshl_b32 s59, s28, 17
    s_add_u32 s59, s59, 37748736
    v_mov_b64 v[80:81], 0
    v_mov_b64 v[82:83], 0
    v_mov_b64 v[84:85], 0
    v_mov_b64 v[86:87], 0
    v_mov_b64 v[88:89], 0
    v_mov_b64 v[90:91], 0
    v_mov_b64 v[92:93], 0
    v_mov_b64 v[94:95], 0
    v_mov_b64 v[44:45], 0
    v_mov_b64 v[46:47], 0
    v_mov_b64 v[48:49], 0
    v_mov_b64 v[50:51], 0
    v_mov_b64 v[52:53], 0
    v_mov_b64 v[54:55], 0
    s_add_u32 s32, s28, 3
    s_min_u32 s32, s32, 64
    s_mov_b32 s48, 400000
KW_57:
    s_cmp_ge_u32 s58, s32
    s_cbranch_scc1 KD_58
    s_buffer_load_dwordx8 s[40:47], s[4:7], s70 glc
    s_sub_u32 s48, s48, 1
    s_cbranch_scc1 L_abort
    s_waitcnt lgkmcnt(0)
    s_min_u32 s58, s40, s41
    s_min_u32 s58, s58, s42
    s_min_u32 s58, s58, s43
    s_min_u32 s58, s58, s44
    s_min_u32 s58, s58, s45
    s_min_u32 s58, s58, s46
    s_min_u32 s58, s58, s47
    s_cmp_ge_u32 s58, s32
    s_cbranch_scc1 KD_58
    s_sleep 4
    s_branch KW_57
KD_58:
    s_mov_b32 s48, 400000
    s_lshl_b32 s36, s28, 2
    s_add_u32 s36, s36, 4
    s_sub_u32 s37, s52, 520192
    s_sub_u32 s38, s52, 524288
    s_waitcnt lgkmcnt(0)
    s_setprio 3
    s_waitcnt vmcnt(0)
    s_mov_b32 s48, 400000
    s_barrier
    ds_read_b64 v[96:97], v5 offset:0
    ds_read_b64 v[98:99], v5 offset:3264
    ds_read_b64 v[100:101], v5 offset:6528
    ds_read_b64 v[102:103], v5 offset:9792
    s_waitcnt lgkmcnt(2)
    v_pk_add_f32 v[96:97], v[96:97], v[98:99]
    s_waitcnt lgkmcnt(0)
    v_pk_add_f32 v[100:101], v[100:101], v[102:103]
    v_pk_add_f32 v[96:97], v[96:97], v[100:101]
    v_cvt_pk_bf16_f32 v11, v96, v97
    buffer_store_dword v11, v4, s[4:7], s30 offen
    s_cmp_eq_u32 s28, 63
    s_cbranch_scc1 L_rec_lastB
    ds_read_b128 v[160:163], v7 offset:0
    ds_read_b128 v[164:167], v7 offset:1024
    ds_read_b128 v[168:171], v7 offset:2048
    ds_read_b128 v[172:175], v7 offset:3072
    ds_read_b128 v[128:131], v7 offset:4096
    ds_read_b128 v[132:135], v7 offset:5120
    ds_read_b128 v[136:139], v7 offset:6144
    ds_read_b128 v[140:143], v7 offset:7168
    s_nop 9
    buffer_load_dwordx4 v[56:59], v2, s[4:7], s30 offen offset:0 sc1
    s_nop 10
    buffer_load_dwordx4 v[60:63], v2, s[4:7], s30 offen offset:1024 sc1
    s_nop 10
    buffer_load_dwordx4 v[64:67], v2, s[4:7], s30 offen offset:2048 sc1
    s_nop 10
    buffer_load_dwordx4 v[68:71], v2, s[4:7], s30 offen offset:3072 sc1
    s_waitcnt vmcnt(3) lgkmcnt(0)
    v_max3_u32 v10, v56, v57, v58
    v_max_u32 v10, v10, v59
    v_cmp_eq_u32 vcc, -1, v10
    s_cbranch_vccnz Bl_f0123
Bl_o0123:
    v_mfma_f32_16x16x32_bf16 v[44:47], v[160:163], v[56:59], v[44:47]
    v_mfma_f32_16x16x32_bf16 v[48:51], v[176:179], v[56:59], v[48:51]
    s_waitcnt vmcnt(2)
    v_max3_u32 v10, v60, v61, v62
    v_max_u32 v10, v10, v63
    v_cmp_eq_u32 vcc, -1, v10
    v_mfma_f32_16x16x32_bf16 v[52:55], v[56:59], v[56:59], v[52:55]
    s_cbranch_vccnz Bl_f123
Bl_o123:
    v_mfma_f32_16x16x32_bf16 v[44:47], v[164:167], v[60:63], v[44:47]
    v_mfma_f32_16x16x32_bf16 v[48:51], v[180:183], v[60:63], v[48:51]
    s_waitcnt vmcnt(1)
    v_max3_u32 v10, v64, v65, v66
    v_max_u32 v10, v10, v67
    v_cmp_eq_u32 vcc, -1, v10
    v_mfma_f32_16x16x32_bf16 v[52:55], v[60:63], v[60:63], v[52:55]
    s_cbranch_vccnz Bl_f23
Bl_o23:
    v_mfma_f32_16x16x32_bf16 v[44:47], v[168:171], v[64:67], v[44:47]
    buffer_load_dwordx4 v[72:75], v2, s[4:7], s49 offen offset:0 sc1
    v_mfma_f32_16x16x32_bf16 v[48:51], v[184:187], v[64:67], v[48:51]
    buffer_load_dwordx4 v[76:79], v2, s[4:7], s49 offen offset:1024 sc1
    ds_add_u32 v14, v13
    v_mfma_f32_16x16x32_bf16 v[52:55], v[64:67], v[64:67], v[52:55]
Bl_k3:
    s_waitcnt vmcnt(2)
    v_mfma_f32_16x16x32_bf16 v[96:99], v[172:175], v[68:71], v[44:47]
    v_max3_u32 v10, v68, v69, v70
    v_mfma_f32_16x16x32_bf16 v[100:103], v[188:191], v[68:71], v[48:51]
    v_max_u32 v10, v10, v71
    v_cmp_eq_u32 vcc, -1, v10
    v_mfma_f32_16x16x32_bf16 v[108:111], v[68:71], v[68:71], v[52:55]
    s_cbranch_vccz Bl_soft
    buffer_load_dwordx4 v[68:71], v2, s[4:7], s30 offen offset:3072 sc1
    buffer_load_dwordx4 v[72:75], v2, s[4:7], s49 offen offset:0 sc1
    buffer_load_dwordx4 v[76:79], v2, s[4:7], s49 offen offset:1024 sc1
    s_sub_u32 s48, s48, 1
    s_cbranch_scc1 L_abort
    s_branch Bl_k3
Bl_o1230:
    v_mfma_f32_16x16x32_bf16 v[44:47], v[164:167], v[60:63], v[44:47]
    v_mfma_f32_16x16x32_bf16 v[48:51], v[180:183], v[60:63], v[48:51]
    s_waitcnt vmcnt(2)
    v_max3_u32 v10, v64, v65, v66
    v_max_u32 v10, v10, v67
    v_cmp_eq_u32 vcc, -1, v10
    v_mfma_f32_16x16x32_bf16 v[52:55], v[60:63], v[60:63], v[52:55]
    s_cbranch_vccnz Bl_f230
Bl_o230:
    v_mfma_f32_16x16x32_bf16 v[44:47], v[168:171], v[64:67], v[44:47]
    v_mfma_f32_16x16x32_bf16 v[48:51], v[184:187], v[64:67], v[48:51]
    s_waitcnt vmcnt(1)
    v_max3_u32 v10, v68, v69, v70
    v_max_u32 v10, v10, v71
    v_cmp_eq_u32 vcc, -1, v10
    v_mfma_f32_16x16x32_bf16 v[52:55], v[64:67], v[64:67], v[52:55]
    s_cbranch_vccnz Bl_f30
Bl_o30:
    v_mfma_f32_16x16x32_bf16 v[44:47], v[172:175], v[68:71], v[44:47]
    buffer_load_dwordx4 v[72:75], v2, s[4:7], s49 offen offset:0 sc1
    v_mfma_f32_16x16x32_bf16 v[48:51], v[188:191], v[68:71], v[48:51]
    buffer_load_dwordx4 v[76:79], v2, s[4:7], s49 offen offset:1024 sc1
    ds_add_u32 v14, v13
    v_mfma_f32_16x16x32_bf16 v[52:55], v[68:71], v[68:71], v[52:55]
Bl_k0:
    s_waitcnt vmcnt(2)
    v_mfma_f32_16x16x32_bf16 v[96:99], v[160:163], v[56:59], v[44:47]
    v_max3_u32 v10, v56, v57, v58
    v_mfma_f32_16x16x32_bf16 v[100:103], v[176:179], v[56:59], v[48:51]
    v_max_u32 v10, v10, v59
    v_cmp_eq_u32 vcc, -1, v10
    v_mfma_f32_16x16x32_bf16 v[108:111], v[56:59], v[56:59], v[52:55]
    s_cbranch_vccz Bl_soft
    buffer_load_dwordx4 v[56:59], v2, s[4:7], s30 offen offset:0 sc1
    buffer_load_dwordx4 v[72:75], v2, s[4:7], s49 offen offset:0 sc1
    buffer_load_dwordx4 v[76:79], v2, s[4:7], s49 offen offset:1024 sc1
    s_sub_u32 s48, s48, 1
    s_cbranch_scc1 L_abort
    s_branch Bl_k0
Bl_o2301:
    v_mfma_f32_16x16x32_bf16 v[44:47], v[168:171], v[64:67], v[44:47]
    v_mfma_f32_16x16x32_bf16 v[48:51], v[184:187], v[64:67], v[48:51]
    s_waitcnt vmcnt(2)
    v_max3_u32 v10, v68, v69, v70
    v_max_u32 v10, v10, v71
    v_cmp_eq_u32 vcc, -1, v10
    v_mfma_f32_16x16x32_bf16 v[52:55], v[64:67], v[64:67], v[52:55]
    s_cbranch_vccnz Bl_f301
Bl_o301:
    v_mfma_f32_16x16x32_bf16 v[44:47], v[172:175], v[68:71], v[44:47]
    v_mfma_f32_16x16x32_bf16 v[48:51], v[188:191], v[68:71], v[48:51]
    s_waitcnt vmcnt(1)
    v_max3_u32 v10, v56, v57, v58
    v_max_u32 v10, v10, v59
    v_cmp_eq_u32 vcc, -1, v10
    v_mfma_f32_16x16x32_bf16 v[52:55], v[68:71], v[68:71], v[52:55]
    s_cbranch_vccnz Bl_f01
Bl_o01:
    v_mfma_f32_16x16x32_bf16 v[44:47], v[160:163], v[56:59], v[44:47]
    buffer_load_dwordx4 v[72:75], v2, s[4:7], s49 offen offset:0 sc1
    v_mfma_f32_16x16x32_bf16 v[48:51], v[176:179], v[56:59], v[48:51]
    buffer_load_dwordx4 v[76:79], v2, s[4:7], s49 offen offset:1024 sc1
    ds_add_u32 v14, v13
    v_mfma_f32_16x16x32_bf16 v[52:55], v[56:59], v[56:59], v[52:55]
Bl_k1:
    s_waitcnt vmcnt(2)
    v_mfma_f32_16x16x32_bf16 v[96:99], v[164:167], v[60:63], v[44:47]
    v_max3_u32 v10, v60, v61, v62
    v_mfma_f32_16x16x32_bf16 v[100:103], v[180:183], v[60:63], v[48:51]
    v_max_u32 v10, v10, v63
    v_cmp_eq_u32 vcc, -1, v10
    v_mfma_f32_16x16x32_bf16 v[108:111], v[60:63], v[60:63], v[52:55]
    s_cbranch_vccz Bl_soft
    buffer_load_dwordx4 v[60:63], v2, s[4:7], s30 offen offset:1024 sc1
    buffer_load_dwordx4 v[72:75], v2, s[4:7], s49 offen offset:0 sc1
    buffer_load_dwordx4 v[76:79], v2, s[4:7], s49 offen offset:1024 sc1
    s_sub_u32 s48, s48, 1
    s_cbranch_scc1 L_abort
    s_branch Bl_k1
Bl_o3012:
    v_mfma_f32_16x16x32_bf16 v[44:47], v[172:175], v[68:71], v[44:47]
    v_mfma_f32_16x16x32_bf16 v[48:51], v[188:191], v[68:71], v[48:51]
    s_waitcnt vmcnt(2)
    v_max3_u32 v10, v56, v57, v58
    v_max_u32 v10, v10, v59
    v_cmp_eq_u32 vcc, -1, v10
    v_mfma_f32_16x16x32_bf16 v[52:55], v[68:71], v[68:71], v[52:55]
    s_cbranch_vccnz Bl_f012
Bl_o012:
    v_mfma_f32_16x16x32_bf16 v[44:47], v[160:163], v[56:59], v[44:47]
    v_mfma_f32_16x16x32_bf16 v[48:51], v[176:179], v[56:59], v[48:51]
    s_waitcnt vmcnt(1)
    v_max3_u32 v10, v60, v61, v62
    v_max_u32 v10, v10, v63
    v_cmp_eq_u32 vcc, -1, v10
    v_mfma_f32_16x16x32_bf16 v[52:55], v[56:59], v[56:59], v[52:55]
    s_cbranch_vccnz Bl_f12
Bl_o12:
    v_mfma_f32_16x16x32_bf16 v[44:47], v[164:167], v[60:63], v[44:47]
    buffer_load_dwordx4 v[72:75], v2, s[4:7], s49 offen offset:0 sc1
    v_mfma_f32_16x16x32_bf16 v[48:51], v[180:183], v[60:63], v[48:51]
    buffer_load_dwordx4 v[76:79], v2, s[4:7], s49 offen offset:1024 sc1
    ds_add_u32 v14, v13
    v_mfma_f32_16x16x32_bf16 v[52:55], v[60:63], v[60:63], v[52:55]
Bl_k2:
    s_waitcnt vmcnt(2)
    v_mfma_f32_16x16x32_bf16 v[96:99], v[168:171], v[64:67], v[44:47]
    v_max3_u32 v10, v64, v65, v66
    v_mfma_f32_16x16x32_bf16 v[100:103], v[184:187], v[64:67], v[48:51]
    v_max_u32 v10, v10, v67
    v_cmp_eq_u32 vcc, -1, v10
    v_mfma_f32_16x16x32_bf16 v[108:111], v[64:67], v[64:67], v[52:55]
    s_cbranch_vccz Bl_soft
    buffer_load_dwordx4 v[64:67], v2, s[4:7], s30 offen offset:2048 sc1
    buffer_load_dwordx4 v[72:75], v2, s[4:7], s49 offen offset:0 sc1
    buffer_load_dwordx4 v[76:79], v2, s[4:7], s49 offen offset:1024 sc1
    s_sub_u32 s48, s48, 1
    s_cbranch_scc1 L_abort
    s_branch Bl_k2
Bl_o120:
    v_mfma_f32_16x16x32_bf16 v[44:47], v[164:167], v[60:63], v[44:47]
    v_mfma_f32_16x16x32_bf16 v[48:51], v[180:183], v[60:63], v[48:51]
    s_waitcnt vmcnt(1)
    v_max3_u32 v10, v64, v65, v66
    v_max_u32 v10, v10, v67
    v_cmp_eq_u32 vcc, -1, v10
    v_mfma_f32_16x16x32_bf16 v[52:55], v[60:63], v[60:63], v[52:55]
    s_cbranch_vccnz Bl_f20
    s_branch Bl_o20
Bl_o201:
    v_mfma_f32_16x16x32_bf16 v[44:47], v[168:171], v[64:67], v[44:47]
    v_mfma_f32_16x16x32_bf16 v[48:51], v[184:187], v[64:67], v[48:51]
    s_waitcnt vmcnt(1)
    v_max3_u32 v10, v56, v57, v58
    v_max_u32 v10, v10, v59
    v_cmp_eq_u32 vcc, -1, v10
    v_mfma_f32_16x16x32_bf16 v[52:55], v[64:67], v[64:67], v[52:55]
    s_cbranch_vccnz Bl_f01
    s_branch Bl_o01
Bl_o013:
    v_mfma_f32_16x16x32_bf16 v[44:47], v[160:163], v[56:59], v[44:47]
    v_mfma_f32_16x16x32_bf16 v[48:51], v[176:179], v[56:59], v[48:51]
    s_waitcnt vmcnt(1)
    v_max3_u32 v10, v60, v61, v62
    v_max_u32 v10, v10, v63
    v_cmp_eq_u32 vcc, -1, v10
    v_mfma_f32_16x16x32_bf16 v[52:55], v[56:59], v[56:59], v[52:55]
    s_cbranch_vccnz Bl_f13
    s_branch Bl_o13
Bl_o130:
    v_mfma_f32_16x16x32_bf16 v[44:47], v[164:167], v[60:63], v[44:47]
    v_mfma_f32_16x16x32_bf16 v[48:51], v[180:183], v[60:63], v[48:51]
    s_waitcnt vmcnt(1)
    v_max3_u32 v10, v68, v69, v70
    v_max_u32 v10, v10, v71
    v_cmp_eq_u32 vcc, -1, v10
    v_mfma_f32_16x16x32_bf16 v[52:55], v[60:63], v[60:63], v[52:55]
    s_cbranch_vccnz Bl_f30
    s_branch Bl_o30
Bl_o023:
    v_mfma_f32_16x16x32_bf16 v[44:47], v[160:163], v[56:59], v[44:47]
    v_mfma_f32_16x16x32_bf16 v[48:51], v[176:179], v[56:59], v[48:51]
    s_waitcnt vmcnt(1)
    v_max3_u32 v10, v64, v65, v66
    v_max_u32 v10, v10, v67
    v_cmp_eq_u32 vcc, -1, v10
    v_mfma_f32_16x16x32_bf16 v[52:55], v[56:59], v[56:59], v[52:55]
    s_cbranch_vccnz Bl_f23
    s_branch Bl_o23
Bl_o302:
    v_mfma_f32_16x16x32_bf16 v[44:47], v[172:175], v[68:71], v[44:47]
    v_mfma_f32_16x16x32_bf16 v[48:51], v[188:191], v[68:71], v[48:51]
    s_waitcnt vmcnt(1)
    v_max3_u32 v10, v56, v57, v58
    v_max_u32 v10, v10, v59
    v_cmp_eq_u32 vcc, -1, v10
    v_mfma_f32_16x16x32_bf16 v[52:55], v[68:71], v[68:71], v[52:55]
    s_cbranch_vccnz Bl_f02
    s_branch Bl_o02
Bl_o231:
    v_mfma_f32_16x16x32_bf16 v[44:47], v[168:171], v[64:67], v[44:47]
    v_mfma_f32_16x16x32_bf16 v[48:51], v[184:187], v[64:67], v[48:51]
    s_waitcnt vmcnt(1)
    v_max3_u32 v10, v68, v69, v70
    v_max_u32 v10, v10, v71
    v_cmp_eq_u32 vcc, -1, v10
    v_mfma_f32_16x16x32_bf16 v[52:55], v[64:67], v[64:67], v[52:55]
    s_cbranch_vccnz Bl_f31
    s_branch Bl_o31
Bl_o312:
    v_mfma_f32_16x16x32_bf16 v[44:47], v[172:175], v[68:71], v[44:47]
    v_mfma_f32_16x16x32_bf16 v[48:51], v[188:191], v[68:71], v[48:51]
    s_waitcnt vmcnt(1)
    v_max3_u32 v10, v60, v61, v62
    v_max_u32 v10, v10, v63
    v_cmp_eq_u32 vcc, -1, v10
    v_mfma_f32_16x16x32_bf16 v[52:55], v[68:71], v[68:71], v[52:55]
    s_cbranch_vccnz Bl_f12
    s_branch Bl_o12
Bl_o10:
    v_mfma_f32_16x16x32_bf16 v[44:47], v[164:167], v[60:63], v[44:47]
    buffer_load_dwordx4 v[72:75], v2, s[4:7], s49 offen offset:0 sc1
    v_mfma_f32_16x16x32_bf16 v[48:51], v[180:183], v[60:63], v[48:51]
    buffer_load_dwordx4 v[76:79], v2, s[4:7], s49 offen offset:1024 sc1
    ds_add_u32 v14, v13
    v_mfma_f32_16x16x32_bf16 v[52:55], v[60:63], v[60:63], v[52:55]
    s_branch Bl_k0
Bl_o02:
    v_mfma_f32_16x16x32_bf16 v[44:47], v[160:163], v[56:59], v[44:47]
    buffer_load_dwordx4 v[72:75], v2, s[4:7], s49 offen offset:0 sc1
    v_mfma_f32_16x16x32_bf16 v[48:51], v[176:179], v[56:59], v[48:51]
    buffer_load_dwordx4 v[76:79], v2, s[4:7], s49 offen offset:1024 sc1
    ds_add_u32 v14, v13
    v_mfma_f32_16x16x32_bf16 v[52:55], v[56:59], v[56:59], v[52:55]
    s_branch Bl_k2
Bl_o20:
    v_mfma_f32_16x16x32_bf16 v[44:47], v[168:171], v[64:67], v[44:47]
    buffer_load_dwordx4 v[72:75], v2, s[4:7], s49 offen offset:0 sc1
    v_mfma_f32_16x16x32_bf16 v[48:51], v[184:187], v[64:67], v[48:51]
    buffer_load_dwordx4 v[76:79], v2, s[4:7], s49 offen offset:1024 sc1
    ds_add_u32 v14, v13
    v_mfma_f32_16x16x32_bf16 v[52:55], v[64:67], v[64:67], v[52:55]
    s_branch Bl_k0
Bl_o03:
    v_mfma_f32_16x16x32_bf16 v[44:47], v[160:163], v[56:59], v[44:47]
    buffer_load_dwordx4 v[72:75], v2, s[4:7], s49 offen offset:0 sc1
    v_mfma_f32_16x16x32_bf16 v[48:51], v[176:179], v[56:59], v[48:51]
    buffer_load_dwordx4 v[76:79], v2, s[4:7], s49 offen offset:1024 sc1
    ds_add_u32 v14, v13
    v_mfma_f32_16x16x32_bf16 v[52:55], v[56:59], v[56:59], v[52:55]
    s_branch Bl_k3
Bl_o21:
    v_mfma_f32_16x16x32_bf16 v[44:47], v[168:171], v[64:67], v[44:47]
    buffer_load_dwordx4 v[72:75], v2, s[4:7], s49 offen offset:0 sc1
    v_mfma_f32_16x16x32_bf16 v[48:51], v[184:187], v[64:67], v[48:51]
    buffer_load_dwordx4 v[76:79], v2, s[4:7], s49 offen offset:1024 sc1
    ds_add_u32 v14, v13
    v_mfma_f32_16x16x32_bf16 v[52:55], v[64:67], v[64:67], v[52:55]
    s_branch Bl_k1
Bl_o13:
    v_mfma_f32_16x16x32_bf16 v[44:47], v[164:167], v[60:63], v[44:47]
    buffer_load_dwordx4 v[72:75], v2, s[4:7], s49 offen offset:0 sc1
    v_mfma_f32_16x16x32_bf16 v[48:51], v[180:183], v[60:63], v[48:51]
    buffer_load_dwordx4 v[76:79], v2, s[4:7], s49 offen offset:1024 sc1
    ds_add_u32 v14, v13
    v_mfma_f32_16x16x32_bf16 v[52:55], v[60:63], v[60:63], v[52:55]
    s_branch Bl_k3
Bl_o31:
    v_mfma_f32_16x16x32_bf16 v[44:47], v[172:175], v[68:71], v[44:47]
    buffer_load_dwordx4 v[72:75], v2, s[4:7], s49 offen offset:0 sc1
    v_mfma_f32_16x16x32_bf16 v[48:51], v[188:191], v[68:71], v[48:51]
    buffer_load_dwordx4 v[76:79], v2, s[4:7], s49 offen offset:1024 sc1
    ds_add_u32 v14, v13
    v_mfma_f32_16x16x32_bf16 v[52:55], v[68:71], v[68:71], v[52:55]
    s_branch Bl_k1
Bl_o32:
    v_mfma_f32_16x16x32_bf16 v[44:47], v[172:175], v[68:71], v[44:47]
    buffer_load_dwordx4 v[72:75], v2, s[4:7], s49 offen offset:0 sc1
    v_mfma_f32_16x16x32_bf16 v[48:51], v[188:191], v[68:71], v[48:51]
    buffer_load_dwordx4 v[76:79], v2, s[4:7], s49 offen offset:1024 sc1
    ds_add_u32 v14, v13
    v_mfma_f32_16x16x32_bf16 v[52:55], v[68:71], v[68:71], v[52:55]
    s_branch Bl_k2
Bl_f0123:
    buffer_load_dwordx4 v[56:59], v2, s[4:7], s30 offen offset:0 sc1
    s_sub_u32 s48, s48, 1
    s_cbranch_scc1 L_abort
    s_waitcnt vmcnt(3)
    v_max3_u32 v10, v60, v61, v62
    v_max_u32 v10, v10, v63
    v_cmp_eq_u32 vcc, -1, v10
    s_cbranch_vccz Bl_o1230
    s_branch Bl_f1230
Bl_f123:
    buffer_load_dwordx4 v[60:63], v2, s[4:7], s30 offen offset:1024 sc1
    s_sub_u32 s48, s48, 1
    s_cbranch_scc1 L_abort
    s_waitcnt vmcnt(2)
    v_max3_u32 v10, v64, v65, v66
    v_max_u32 v10, v10, v67
    v_cmp_eq_u32 vcc, -1, v10
    s_cbranch_vccz Bl_o231
    s_branch Bl_f231
Bl_f23:
    buffer_load_dwordx4 v[64:67], v2, s[4:7], s30 offen offset:2048 sc1
    s_sub_u32 s48, s48, 1
    s_cbranch_scc1 L_abort
    s_waitcnt vmcnt(1)
    v_max3_u32 v10, v68, v69, v70
    v_max_u32 v10, v10, v71
    v_cmp_eq_u32 vcc, -1, v10
    s_cbranch_vccz Bl_o32
    s_branch Bl_f32
Bl_f1230:
    buffer_load_dwordx4 v[60:63], v2, s[4:7], s30 offen offset:1024 sc1
    s_sub_u32 s48, s48, 1
    s_cbranch_scc1 L_abort
    s_waitcnt vmcnt(3)
    v_max3_u32 v10, v64, v65, v66
    v_max_u32 v10, v10, v67
    v_cmp_eq_u32 vcc, -1, v10
    s_cbranch_vccz Bl_o2301
    s_branch Bl_f2301
Bl_f230:
    buffer_load_dwordx4 v[64:67], v2, s[4:7], s30 offen offset:2048 sc1
    s_sub_u32 s48, s48, 1
    s_cbranch_scc1 L_abort
    s_waitcnt vmcnt(2)
    v_max3_u32 v10, v68, v69, v70
    v_max_u32 v10, v10, v71
    v_cmp_eq_u32 vcc, -1, v10
    s_cbranch_vccz Bl_o302
    s_branch Bl_f302
Bl_f30:
    buffer_load_dwordx4 v[68:71], v2, s[4:7], s30 offen offset:3072 sc1
    s_sub_u32 s48, s48, 1
    s_cbranch_scc1 L_abort
    s_waitcnt vmcnt(1)
    v_max3_u32 v10, v56, v57, v58
    v_max_u32 v10, v10, v59
    v_cmp_eq_u32 vcc, -1, v10
    s_cbranch_vccz Bl_o03
    s_branch Bl_f03
Bl_f2301:
    buffer_load_dwordx4 v[64:67], v2, s[4:7], s30 offen offset:2048 sc1
    s_sub_u32 s48, s48, 1
    s_cbranch_scc1 L_abort
    s_waitcnt vmcnt(3)
    v_max3_u32 v10, v68, v69, v70
    v_max_u32 v10, v10, v71
    v_cmp_eq_u32 vcc, -1, v10
    s_cbranch_vccz Bl_o3012
    s_branch Bl_f3012
Bl_f301:
    buffer_load_dwordx4 v[68:71], v2, s[4:7], s30 offen offset:3072 sc1
    s_sub_u32 s48, s48, 1
    s_cbranch_scc1 L_abort
    s_waitcnt vmcnt(2)
    v_max3_u32 v10, v56, v57, v58
    v_max_u32 v10, v10, v59
    v_cmp_eq_u32 vcc, -1, v10
    s_cbranch_vccz Bl_o013
    s_branch Bl_f013
Bl_f01:
    buffer_load_dwordx4 v[56:59], v2, s[4:7], s30 offen offset:0 sc1
    s_sub_u32 s48, s48, 1
    s_cbranch_scc1 L_abort
    s_waitcnt vmcnt(1)
    v_max3_u32 v10, v60, v61, v62
    v_max_u32 v10, v10, v63
    v_cmp_eq_u32 vcc, -1, v10
    s_cbranch_vccz Bl_o10
    s_branch Bl_f10
Bl_f3012:
    buffer_load_dwordx4 v[68:71], v2, s[4:7], s30 offen offset:3072 sc1
    s_sub_u32 s48, s48, 1
    s_cbranch_scc1 L_abort
    s_waitcnt vmcnt(3)
    v_max3_u32 v10, v56, v57, v58
    v_max_u32 v10, v10, v59
    v_cmp_eq_u32 vcc, -1, v10
    s_cbranch_vccz Bl_o0123
    s_branch Bl_f0123
Bl_f012:
    buffer_load_dwordx4 v[56:59], v2, s[4:7], s30 offen offset:0 sc1
    s_sub_u32 s48, s48, 1
    s_cbranch_scc1 L_abort
    s_waitcnt vmcnt(2)
    v_max3_u32 v10, v60, v61, v62
    v_max_u32 v10, v10, v63
    v_cmp_eq_u32 vcc, -1, v10
    s_cbranch_vccz Bl_o120
    s_branch Bl_f120
Bl_f12:
    buffer_load_dwordx4 v[60:63], v2, s[4:7], s30 offen offset:1024 sc1
    s_sub_u32 s48, s48, 1
    s_cbranch_scc1 L_abort
    s_waitcnt vmcnt(1)
    v_max3_u32 v10, v64, v65, v66
    v_max_u32 v10, v10, v67
    v_cmp_eq_u32 vcc, -1, v10
    s_cbranch_vccz Bl_o21
    s_branch Bl_f21
Bl_f120:
    buffer_load_dwordx4 v[60:63], v2, s[4:7], s30 offen offset:1024 sc1
    s_sub_u32 s48, s48, 1
    s_cbranch_scc1 L_abort
    s_waitcnt vmcnt(2)
    v_max3_u32 v10, v64, v65, v66
    v_max_u32 v10, v10, v67
    v_cmp_eq_u32 vcc, -1, v10
    s_cbranch_vccz Bl_o201
    s_branch Bl_f201
Bl_f201:
    buffer_load_dwordx4 v[64:67], v2, s[4:7], s30 offen offset:2048 sc1
    s_sub_u32 s48, s48, 1
    s_cbranch_scc1 L_abort
    s_waitcnt vmcnt(2)
    v_max3_u32 v10, v56, v57, v58
    v_max_u32 v10, v10, v59
    v_cmp_eq_u32 vcc, -1, v10
    s_cbranch_vccz Bl_o012
    s_branch Bl_f012
Bl_f013:
    buffer_load_dwordx4 v[56:59], v2, s[4:7], s30 offen offset:0 sc1
    s_sub_u32 s48, s48, 1
    s_cbranch_scc1 L_abort
    s_waitcnt vmcnt(2)
    v_max3_u32 v10, v60, v61, v62
    v_max_u32 v10, v10, v63
    v_cmp_eq_u32 vcc, -1, v10
    s_cbranch_vccz Bl_o130
    s_branch Bl_f130
Bl_f130:
    buffer_load_dwordx4 v[60:63], v2, s[4:7], s30 offen offset:1024 sc1
    s_sub_u32 s48, s48, 1
    s_cbranch_scc1 L_abort
    s_waitcnt vmcnt(2)
    v_max3_u32 v10, v68, v69, v70
    v_max_u32 v10, v10, v71
    v_cmp_eq_u32 vcc, -1, v10
    s_cbranch_vccz Bl_o301
    s_branch Bl_f301
Bl_f023:
    buffer_load_dwordx4 v[56:59], v2, s[4:7], s30 offen offset:0 sc1
    s_sub_u32 s48, s48, 1
    s_cbranch_scc1 L_abort
    s_waitcnt vmcnt(2)
    v_max3_u32 v10, v64, v65, v66
    v_max_u32 v10, v10, v67
    v_cmp_eq_u32 vcc, -1, v10
    s_cbranch_vccz Bl_o230
    s_branch Bl_f230
Bl_f302:
    buffer_load_dwordx4 v[68:71], v2, s[4:7], s30 offen offset:3072 sc1
    s_sub_u32 s48, s48, 1
    s_cbranch_scc1 L_abort
    s_waitcnt vmcnt(2)
    v_max3_u32 v10, v56, v57, v58
    v_max_u32 v10, v10, v59
    v_cmp_eq_u32 vcc, -1, v10
    s_cbranch_vccz Bl_o023
    s_branch Bl_f023
Bl_f231:
    buffer_load_dwordx4 v[64:67], v2, s[4:7], s30 offen offset:2048 sc1
    s_sub_u32 s48, s48, 1
    s_cbranch_scc1 L_abort
    s_waitcnt vmcnt(2)
    v_max3_u32 v10, v68, v69, v70
    v_max_u32 v10, v10, v71
    v_cmp_eq_u32 vcc, -1, v10
    s_cbranch_vccz Bl_o312
    s_branch Bl_f312
Bl_f312:
    buffer_load_dwordx4 v[68:71], v2, s[4:7], s30 offen offset:3072 sc1
    s_sub_u32 s48, s48, 1
    s_cbranch_scc1 L_abort
    s_waitcnt vmcnt(2)
    v_max3_u32 v10, v60, v61, v62
    v_max_u32 v10, v10, v63
    v_cmp_eq_u32 vcc, -1, v10
    s_cbranch_vccz Bl_o123
    s_branch Bl_f123
Bl_f10:
    buffer_load_dwordx4 v[60:63], v2, s[4:7], s30 offen offset:1024 sc1
    s_sub_u32 s48, s48, 1
    s_cbranch_scc1 L_abort
    s_waitcnt vmcnt(1)
    v_max3_u32 v10, v56, v57, v58
    v_max_u32 v10, v10, v59
    v_cmp_eq_u32 vcc, -1, v10
    s_cbranch_vccz Bl_o01
    s_branch Bl_f01
Bl_f02:
    buffer_load_dwordx4 v[56:59], v2, s[4:7], s30 offen offset:0 sc1
    s_sub_u32 s48, s48, 1
    s_cbranch_scc1 L_abort
    s_waitcnt vmcnt(1)
    v_max3_u32 v10, v64, v65, v66
    v_max_u32 v10, v10, v67
    v_cmp_eq_u32 vcc, -1, v10
    s_cbranch_vccz Bl_o20
    s_branch Bl_f20
Bl_f20:
    buffer_load_dwordx4 v[64:67], v2, s[4:7], s30 offen offset:2048 sc1
    s_sub_u32 s48, s48, 1
    s_cbranch_scc1 L_abort
    s_waitcnt vmcnt(1)
    v_max3_u32 v10, v56, v57, v58
    v_max_u32 v10, v10, v59
    v_cmp_eq_u32 vcc, -1, v10
    s_cbranch_vccz Bl_o02
    s_branch Bl_f02
Bl_f03:
    buffer_load_dwordx4 v[56:59], v2, s[4:7], s30 offen offset:0 sc1
    s_sub_u32 s48, s48, 1
    s_cbranch_scc1 L_abort
    s_waitcnt vmcnt(1)
    v_max3_u32 v10, v68, v69, v70
    v_max_u32 v10, v10, v71
    v_cmp_eq_u32 vcc, -1, v10
    s_cbranch_vccz Bl_o30
    s_branch Bl_f30
Bl_f21:
    buffer_load_dwordx4 v[64:67], v2, s[4:7], s30 offen offset:2048 sc1
    s_sub_u32 s48, s48, 1
    s_cbranch_scc1 L_abort
    s_waitcnt vmcnt(1)
    v_max3_u32 v10, v60, v61, v62
    v_max_u32 v10, v10, v63
    v_cmp_eq_u32 vcc, -1, v10
    s_cbranch_vccz Bl_o12
    s_branch Bl_f12
Bl_f13:
    buffer_load_dwordx4 v[60:63], v2, s[4:7], s30 offen offset:1024 sc1
    s_sub_u32 s48, s48, 1
    s_cbranch_scc1 L_abort
    s_waitcnt vmcnt(1)
    v_max3_u32 v10, v68, v69, v70
    v_max_u32 v10, v10, v71
    v_cmp_eq_u32 vcc, -1, v10
    s_cbranch_vccz Bl_o31
    s_branch Bl_f31
Bl_f31:
    buffer_load_dwordx4 v[68:71], v2, s[4:7], s30 offen offset:3072 sc1
    s_sub_u32 s48, s48, 1
    s_cbranch_scc1 L_abort
    s_waitcnt vmcnt(1)
    v_max3_u32 v10, v60, v61, v62
    v_max_u32 v10, v10, v63
    v_cmp_eq_u32 vcc, -1, v10
    s_cbranch_vccz Bl_o13
    s_branch Bl_f13
Bl_f32:
    buffer_load_dwordx4 v[68:71], v2, s[4:7], s30 offen offset:3072 sc1
    s_sub_u32 s48, s48, 1
    s_cbranch_scc1 L_abort
    s_waitcnt vmcnt(1)
    v_max3_u32 v10, v64, v65, v66
    v_max_u32 v10, v10, v67
    v_cmp_eq_u32 vcc, -1, v10
    s_cbranch_vccz Bl_o23
    s_branch Bl_f23
    .p2align 6
Bl_soft:
    s_nop 0
    s_nop 1
    v_max3_f32 v40, v96, v97, v98
    v_max3_f32 v40, v40, v99, v100
    v_max3_f32 v40, v40, v101, v102
    s_nop 0
    v_max3_f32 v40, v40, v103, v110
    v_max_f32 v41, v40, v111
    v_max_f32 v40, v40, v111
    s_nop 1
    v_permlane16_swap_b32 v40, v41
    v_max_f32 v42, v40, v41
    v_max_f32 v43, v40, v41
    s_nop 1
    v_permlane32_swap_b32 v42, v43
    v_max_f32 v40, v42, v43
    v_fma_f32 v16, v40, s54, v15
    v_fma_f32 v96, v96, s54, -v16
    v_fma_f32 v97, v97, s54, -v16
    v_exp_f32 v96, v96
    v_exp_f32 v97, v97
    s_waitcnt vmcnt(1)
    v_smfmac_f32_16x16x64_bf16 v[80:83], v[72:75], v[192:199], v1
    v_fma_f32 v98, v98, s54, -v16
    v_fma_f32 v99, v99, s54, -v16
    v_exp_f32 v98, v98
    v_smfmac_f32_16x16x64_bf16 v[84:87], v[72:75], v[208:215], v1
    v_exp_f32 v99, v99
    v_cvt_pk_bf16_f32 v36, v96, v97
    v_smfmac_f32_16x16x64_bf16 v[88:91], v[72:75], v[224:231], v1
    v_fma_f32 v100, v100, s54, -v16
    v_fma_f32 v101, v101, s54, -v16
    v_exp_f32 v100, v100
    v_smfmac_f32_16x16x64_bf16 v[92:95], v[72:75], v[240:247], v1
    v_exp_f32 v101, v101
    v_cvt_pk_bf16_f32 v37, v98, v99
    s_waitcnt vmcnt(0)
    v_smfmac_f32_16x16x64_bf16 v[80:83], v[76:79], v[200:207], v1
    v_fma_f32 v102, v102, s54, -v16
    v_fma_f32 v103, v103, s54, -v16
    v_exp_f32 v102, v102
    v_smfmac_f32_16x16x64_bf16 v[84:87], v[76:79], v[216:223], v1
    v_exp_f32 v103, v103
    v_cvt_pk_bf16_f32 v38, v100, v101
    v_smfmac_f32_16x16x64_bf16 v[88:91], v[76:79], v[232:239], v1
    v_fma_f32 v110, v110, s54, -v16
    v_fma_f32 v111, v111, s54, -v16
    v_exp_f32 v110, v110
    v_smfmac_f32_16x16x64_bf16 v[92:95], v[76:79], v[248:255], v1
    v_exp_f32 v111, v111
    v_cvt_pk_bf16_f32 v39, v102, v103
    v_cvt_pk_bf16_f32 v26, v110, v111
Bl_fin:
    v_mov_b32_dpp v104, v36 quad_perm:[2,3,0,1] row_mask:0xf bank_mask:0xf
    v_mfma_f32_16x16x32_bf16 v[40:43], v[30:33], v[36:39], 0
    v_mov_b32_dpp v105, v37 quad_perm:[2,3,0,1] row_mask:0xf bank_mask:0xf
    v_mov_b32_dpp v106, v38 quad_perm:[2,3,0,1] row_mask:0xf bank_mask:0xf
    v_mfma_f32_16x16x32_bf16 v[40:43], v[32:35], v[26:29], v[40:43]
    v_mov_b32_dpp v107, v39 quad_perm:[2,3,0,1] row_mask:0xf bank_mask:0xf
    v_mov_b32_dpp v28, v26 quad_perm:[2,3,0,1] row_mask:0xf bank_mask:0xf
    v_mfma_f32_16x16x32_bf16 v[96:99], v[112:115], v[36:39], 0
    v_add_f32 v80, v80, v82
    v_add_f32 v81, v81, v83
    v_mfma_f32_16x16x32_bf16 v[96:99], v[116:119], v[104:107], v[96:99]
    v_add_f32 v84, v84, v86
    v_add_f32 v85, v85, v87
    v_cvt_pk_bf16_f32 v18, v80, v81
    v_cvt_pk_bf16_f32 v20, v84, v85
    v_mfma_f32_16x16x32_bf16 v[100:103], v[120:123], v[36:39], 0
    v_add_f32_dpp v17, v40, v40 quad_perm:[2,3,0,1] row_mask:0xf bank_mask:0xf
    v_mfma_f32_16x16x32_bf16 v[96:99], v[18:21], v[26:29], v[96:99]
    v_add_f32 v88, v88, v90
    v_add_f32 v89, v89, v91
    v_add_f32 v92, v92, v94
    v_add_f32 v93, v93, v95
    v_mfma_f32_16x16x32_bf16 v[100:103], v[124:127], v[104:107], v[100:103]
    v_cvt_pk_bf16_f32 v22, v88, v89
    v_cvt_pk_bf16_f32 v24, v92, v93
    v_rcp_f32 v17, v17
    v_max3_u32 v10, v72, v73, v74
    v_mfma_f32_16x16x32_bf16 v[100:103], v[22:25], v[26:29], v[100:103]
    v_mul_f32 v96, v96, v17
    v_mul_f32 v97, v97, v17
    v_mul_f32 v98, v98, v17
    v_mul_f32 v99, v99, v17
    ds_write_b128 v6, v[96:99] offset:0
    v_max3_u32 v10, v10, v75, v76
    v_max3_u32 v10, v10, v77, v78
    v_max_u32 v10, v10, v79
    v_mul_f32 v100, v100, v17
    v_mul_f32 v101, v101, v17
    v_mul_f32 v102, v102, v17
    v_mul_f32 v103, v103, v17
    ds_write_b128 v6, v[100:103] offset:1152
    v_cmp_eq_u32 vcc, -1, v10
    s_cbranch_vccnz Bl_slow
    s_waitcnt lgkmcnt(0)
    s_barrier
    s_setprio 0
    buffer_store_dword v11, v0, s[4:7], s59 offen sc1
    s_min_u32 s34, s52, 31981568
    s_add_u32 s34, s34, s50
    s_buffer_load_dword s33, s[4:7], s34 offset:0
    s_buffer_load_dword s33, s[4:7], s34 offset:64
    s_buffer_load_dword s33, s[4:7], s34 offset:128
    s_buffer_load_dword s33, s[4:7], s34 offset:192
    s_buffer_load_dword s33, s[4:7], s34 offset:256
    s_buffer_load_dword s33, s[4:7], s34 offset:320
    s_buffer_load_dword s33, s[4:7], s34 offset:384
    s_buffer_load_dword s33, s[4:7], s34 offset:448
    s_add_u32 s53, s52, 536576
    s_cmp_ge_u32 s28, 62
    s_cselect_b32 s53, 2146435056, s53
    s_add_u32 s37, s52, 4096
    s_nop 15
    s_nop 15
    s_nop 11
    buffer_load_dwordx4 v[176:179], v8, s[4:7], s37 offen offset:0 sc1
    buffer_load_dwordx4 v[180:183], v8, s[4:7], s37 offen offset:1024 sc1
    buffer_load_dwordx4 v[184:187], v8, s[4:7], s37 offen offset:2048 sc1
    buffer_load_dwordx4 v[188:191], v8, s[4:7], s37 offen offset:3072 sc1
    v_mfma_f32_16x16x32_bf16 v[96:99], v[144:147], v[192:195], 0
    v_mfma_f32_16x16x32_bf16 v[96:99], v[148:151], v[196:199], v[96:99]
    v_mfma_f32_16x16x32_bf16 v[96:99], v[152:155], v[200:203], v[96:99]
    v_mfma_f32_16x16x32_bf16 v[96:99], v[156:159], v[204:207], v[96:99]
    v_mfma_f32_16x16x32_bf16 v[100:103], v[144:147], v[208:211], 0
    v_mfma_f32_16x16x32_bf16 v[100:103], v[148:151], v[212:215], v[100:103]
    v_mfma_f32_16x16x32_bf16 v[100:103], v[152:155], v[216:219], v[100:103]
    v_mfma_f32_16x16x32_bf16 v[100:103], v[156:159], v[220:223], v[100:103]
    v_mfma_f32_16x16x32_bf16 v[104:107], v[144:147], v[224:227], 0
    v_mfma_f32_16x16x32_bf16 v[104:107], v[148:151], v[228:231], v[104:107]
    v_mfma_f32_16x16x32_bf16 v[104:107], v[152:155], v[232:235], v[104:107]
    v_mfma_f32_16x16x32_bf16 v[104:107], v[156:159], v[236:239], v[104:107]
    v_mfma_f32_16x16x32_bf16 v[108:111], v[144:147], v[240:243], 0
    v_mfma_f32_16x16x32_bf16 v[108:111], v[148:151], v[244:247], v[108:111]
    v_mfma_f32_16x16x32_bf16 v[108:111], v[152:155], v[248:251], v[108:111]
    v_mfma_f32_16x16x32_bf16 v[108:111], v[156:159], v[252:255], v[108:111]
    v_mfma_f32_16x16x32_bf16 v[80:83], v[128:131], v[192:195], 0
    v_mfma_f32_16x16x32_bf16 v[80:83], v[132:135], v[196:199], v[80:83]
    v_mfma_f32_16x16x32_bf16 v[80:83], v[136:139], v[200:203], v[80:83]
    v_mfma_f32_16x16x32_bf16 v[80:83], v[140:143], v[204:207], v[80:83]
    v_mfma_f32_16x16x32_bf16 v[84:87], v[128:131], v[208:211], 0
    v_mfma_f32_16x16x32_bf16 v[84:87], v[132:135], v[212:215], v[84:87]
    v_mfma_f32_16x16x32_bf16 v[84:87], v[136:139], v[216:219], v[84:87]
    buffer_load_dwordx4 v[144:147], v8, s[4:7], s53 offen offset:0 sc1
    v_mfma_f32_16x16x32_bf16 v[84:87], v[140:143], v[220:223], v[84:87]
    buffer_load_dwordx4 v[148:151], v8, s[4:7], s53 offen offset:1024 sc1
    v_mfma_f32_16x16x32_bf16 v[88:91], v[128:131], v[224:227], 0
    buffer_load_dwordx4 v[152:155], v8, s[4:7], s53 offen offset:2048 sc1
    v_mfma_f32_16x16x32_bf16 v[88:91], v[132:135], v[228:231], v[88:91]
    buffer_load_dwordx4 v[156:159], v8, s[4:7], s53 offen offset:3072 sc1
    v_mfma_f32_16x16x32_bf16 v[88:91], v[136:139], v[232:235], v[88:91]
    v_mfma_f32_16x16x32_bf16 v[88:91], v[140:143], v[236:239], v[88:91]
    v_mfma_f32_16x16x32_bf16 v[92:95], v[128:131], v[240:243], 0
    v_mfma_f32_16x16x32_bf16 v[92:95], v[132:135], v[244:247], v[92:95]
    v_mfma_f32_16x16x32_bf16 v[92:95], v[136:139], v[248:251], v[92:95]
    v_mfma_f32_16x16x32_bf16 v[92:95], v[140:143], v[252:255], v[92:95]
    v_cvt_pk_bf16_f32 v114, v96, v97
    v_cvt_pk_bf16_f32 v115, v98, v99
    v_cvt_pk_bf16_f32 v118, v100, v101
    v_cvt_pk_bf16_f32 v119, v102, v103
    v_cvt_pk_bf16_f32 v122, v104, v105
    v_cvt_pk_bf16_f32 v123, v106, v107
    v_cvt_pk_bf16_f32 v126, v108, v109
    v_cvt_pk_bf16_f32 v127, v110, v111
    v_cvt_pk_bf16_f32 v112, v80, v81
    v_cvt_pk_bf16_f32 v113, v82, v83
    v_cvt_pk_bf16_f32 v116, v84, v85
    v_cvt_pk_bf16_f32 v117, v86, v87
    v_cvt_pk_bf16_f32 v120, v88, v89
    v_cvt_pk_bf16_f32 v121, v90, v91
    v_cvt_pk_bf16_f32 v124, v92, v93
    v_cvt_pk_bf16_f32 v125, v94, v95
    s_waitcnt lgkmcnt(0)
    s_cmp_lt_u32 s28, 54
    s_cbranch_scc1 Bl_t6
    s_waitcnt vmcnt(8)
    ds_add_u32 v14, v13 offset:256
    s_cmp_lg_u32 s60, 3
    s_cbranch_scc1 Bl_t6
    s_sub_u32 s35, s28, 53
    s_lshl_b32 s35, s35, 3
Bl_t7:
    ds_read_b32 v10, v9 offset:256
    s_sub_u32 s48, s48, 1
    s_cbranch_scc1 L_abort
    s_waitcnt lgkmcnt(0)
    v_cmp_gt_u32 vcc, s35, v10
    s_cbranch_vccnz Bl_t7
    s_add_u32 s35, s28, 1
    s_atomic_smax s35, s[4:5], s51
Bl_t6:
    s_buffer_load_dword s33, s[4:7], s34 offset:512
    s_buffer_load_dword s33, s[4:7], s34 offset:576
    s_buffer_load_dword s33, s[4:7], s34 offset:640
    s_buffer_load_dword s33, s[4:7], s34 offset:704
    s_buffer_load_dword s33, s[4:7], s34 offset:768
    s_buffer_load_dword s33, s[4:7], s34 offset:832
    s_buffer_load_dword s33, s[4:7], s34 offset:896
    s_buffer_load_dword s33, s[4:7], s34 offset:960
    s_add_u32 s28, s28, 1
    s_branch Bl_loop
Bl_slow:
    buffer_load_dwordx4 v[72:75], v2, s[4:7], s49 offen offset:0 sc1
    buffer_load_dwordx4 v[76:79], v2, s[4:7], s49 offen offset:1024 sc1
    s_sub_u32 s48, s48, 1
    s_cbranch_scc1 L_abort
    v_mov_b64 v[80:81], 0
    v_mov_b64 v[82:83], 0
    v_mov_b64 v[84:85], 0
    v_mov_b64 v[86:87], 0
    v_mov_b64 v[88:89], 0
    v_mov_b64 v[90:91], 0
    v_mov_b64 v[92:93], 0
    v_mov_b64 v[94:95], 0
    s_waitcnt vmcnt(0)
    v_smfmac_f32_16x16x64_bf16 v[80:83], v[72:75], v[192:199], v1
    v_smfmac_f32_16x16x64_bf16 v[84:87], v[72:75], v[208:215], v1
    v_smfmac_f32_16x16x64_bf16 v[88:91], v[72:75], v[224:231], v1
    v_smfmac_f32_16x16x64_bf16 v[92:95], v[72:75], v[240:247], v1
    v_smfmac_f32_16x16x64_bf16 v[80:83], v[76:79], v[200:207], v1
    v_smfmac_f32_16x16x64_bf16 v[84:87], v[76:79], v[216:223], v1
    v_smfmac_f32_16x16x64_bf16 v[88:91], v[76:79], v[232:239], v1
    v_smfmac_f32_16x16x64_bf16 v[92:95], v[76:79], v[248:255], v1
    s_nop 7
    s_branch Bl_fin
    s_branch Bn_loop
    .p2align 6
Bn_loop:
    s_add_u32 s30, s28, 0
    s_and_b32 s30, s30, 3
    s_lshl_b32 s30, s30, 18
    s_add_u32 s30, s30, 96468992
    s_add_u32 s49, s30, 4096
    s_add_u32 s52, s28, 1
    s_lshl_b32 s52, s52, 19
    s_lshl_b32 s59, s28, 17
    s_add_u32 s59, s59, 37748736
    v_mov_b64 v[80:81], 0
    v_mov_b64 v[82:83], 0
    v_mov_b64 v[84:85], 0
    v_mov_b64 v[86:87], 0
    v_mov_b64 v[88:89], 0
    v_mov_b64 v[90:91], 0
    v_mov_b64 v[92:93], 0
    v_mov_b64 v[94:95], 0
    v_mov_b64 v[44:45], 0
    v_mov_b64 v[46:47], 0
    v_mov_b64 v[48:49], 0
    v_mov_b64 v[50:51], 0
    v_mov_b64 v[52:53], 0
    v_mov_b64 v[54:55], 0
    s_add_u32 s32, s28, 3
    s_min_u32 s32, s32, 64
    s_mov_b32 s48, 400000
KW_59:
    s_cmp_ge_u32 s58, s32
    s_cbranch_scc1 KD_60
    s_buffer_load_dwordx8 s[40:47], s[4:7], s70 glc
    s_sub_u32 s48, s48, 1
    s_cbranch_scc1 L_abort
    s_waitcnt lgkmcnt(0)
    s_min_u32 s58, s40, s41
    s_min_u32 s58, s58, s42
    s_min_u32 s58, s58, s43
    s_min_u32 s58, s58, s44
    s_min_u32 s58, s58, s45
    s_min_u32 s58, s58, s46
    s_min_u32 s58, s58, s47
    s_cmp_ge_u32 s58, s32
    s_cbranch_scc1 KD_60
    s_sleep 4
    s_branch KW_59
KD_60:
    s_mov_b32 s48, 400000
    s_lshl_b32 s36, s28, 2
    s_add_u32 s36, s36, 4
    s_sub_u32 s37, s52, 520192
    s_sub_u32 s38, s52, 524288
    s_waitcnt lgkmcnt(0)
    s_setprio 3
    s_waitcnt vmcnt(0)
    s_mov_b32 s48, 400000
    s_barrier
    ds_read_b64 v[96:97], v5 offset:0
    ds_read_b64 v[98:99], v5 offset:3264
    ds_read_b64 v[100:101], v5 offset:6528
    ds_read_b64 v[102:103], v5 offset:9792
    s_waitcnt lgkmcnt(2)
    v_pk_add_f32 v[96:97], v[96:97], v[98:99]
    s_waitcnt lgkmcnt(0)
    v_pk_add_f32 v[100:101], v[100:101], v[102:103]
    v_pk_add_f32 v[96:97], v[96:97], v[100:101]
    v_cvt_pk_bf16_f32 v11, v96, v97
    buffer_store_dword v11, v4, s[4:7], s30 offen sc1
    s_cmp_eq_u32 s28, 63
    s_cbranch_scc1 L_rec_lastB
    ds_read_b128 v[160:163], v7 offset:0
    ds_read_b128 v[164:167], v7 offset:1024
    ds_read_b128 v[168:171], v7 offset:2048
    ds_read_b128 v[172:175], v7 offset:3072
    ds_read_b128 v[128:131], v7 offset:4096
    ds_read_b128 v[132:135], v7 offset:5120
    ds_read_b128 v[136:139], v7 offset:6144
    ds_read_b128 v[140:143], v7 offset:7168
    s_nop 9
    buffer_load_dwordx4 v[56:59], v2, s[4:7], s30 offen offset:0 sc1
    s_nop 10
    buffer_load_dwordx4 v[60:63], v2, s[4:7], s30 offen offset:1024 sc1
    s_nop 10
    buffer_load_dwordx4 v[64:67], v2, s[4:7], s30 offen offset:2048 sc1
    s_nop 10
    buffer_load_dwordx4 v[68:71], v2, s[4:7], s30 offen offset:3072 sc1
    s_waitcnt vmcnt(3) lgkmcnt(0)
    v_max3_u32 v10, v56, v57, v58
    v_max_u32 v10, v10, v59
    v_cmp_eq_u32 vcc, -1, v10
    s_cbranch_vccnz Bn_f0123
Bn_o0123:
    v_mfma_f32_16x16x32_bf16 v[44:47], v[160:163], v[56:59], v[44:47]
    v_mfma_f32_16x16x32_bf16 v[48:51], v[176:179], v[56:59], v[48:51]
    s_waitcnt vmcnt(2)
    v_max3_u32 v10, v60, v61, v62
    v_max_u32 v10, v10, v63
    v_cmp_eq_u32 vcc, -1, v10
    v_mfma_f32_16x16x32_bf16 v[52:55], v[56:59], v[56:59], v[52:55]
    s_cbranch_vccnz Bn_f123
Bn_o123:
    v_mfma_f32_16x16x32_bf16 v[44:47], v[164:167], v[60:63], v[44:47]
    v_mfma_f32_16x16x32_bf16 v[48:51], v[180:183], v[60:63], v[48:51]
    s_waitcnt vmcnt(1)
    v_max3_u32 v10, v64, v65, v66
    v_max_u32 v10, v10, v67
    v_cmp_eq_u32 vcc, -1, v10
    v_mfma_f32_16x16x32_bf16 v[52:55], v[60:63], v[60:63], v[52:55]
    s_cbranch_vccnz Bn_f23
Bn_o23:
    v_mfma_f32_16x16x32_bf16 v[44:47], v[168:171], v[64:67], v[44:47]
    buffer_load_dwordx4 v[72:75], v2, s[4:7], s49 offen offset:0 sc1
    v_mfma_f32_16x16x32_bf16 v[48:51], v[184:187], v[64:67], v[48:51]
    buffer_load_dwordx4 v[76:79], v2, s[4:7], s49 offen offset:1024 sc1
    ds_add_u32 v14, v13
    v_mfma_f32_16x16x32_bf16 v[52:55], v[64:67], v[64:67], v[52:55]
Bn_k3:
    s_waitcnt vmcnt(2)
    v_mfma_f32_16x16x32_bf16 v[96:99], v[172:175], v[68:71], v[44:47]
    v_max3_u32 v10, v68, v69, v70
    v_mfma_f32_16x16x32_bf16 v[100:103], v[188:191], v[68:71], v[48:51]
    v_max_u32 v10, v10, v71
    v_cmp_eq_u32 vcc, -1, v10
    v_mfma_f32_16x16x32_bf16 v[108:111], v[68:71], v[68:71], v[52:55]
    s_cbranch_vccz Bn_soft
    buffer_load_dwordx4 v[68:71], v2, s[4:7], s30 offen offset:3072 sc1
    buffer_load_dwordx4 v[72:75], v2, s[4:7], s49 offen offset:0 sc1
    buffer_load_dwordx4 v[76:79], v2, s[4:7], s49 offen offset:1024 sc1
    s_sub_u32 s48, s48, 1
    s_cbranch_scc1 L_abort
    s_branch Bn_k3
Bn_o1230:
    v_mfma_f32_16x16x32_bf16 v[44:47], v[164:167], v[60:63], v[44:47]
    v_mfma_f32_16x16x32_bf16 v[48:51], v[180:183], v[60:63], v[48:51]
    s_waitcnt vmcnt(2)
    v_max3_u32 v10, v64, v65, v66
    v_max_u32 v10, v10, v67
    v_cmp_eq_u32 vcc, -1, v10
    v_mfma_f32_16x16x32_bf16 v[52:55], v[60:63], v[60:63], v[52:55]
    s_cbranch_vccnz Bn_f230
Bn_o230:
    v_mfma_f32_16x16x32_bf16 v[44:47], v[168:171], v[64:67], v[44:47]
    v_mfma_f32_16x16x32_bf16 v[48:51], v[184:187], v[64:67], v[48:51]
    s_waitcnt vmcnt(1)
    v_max3_u32 v10, v68, v69, v70
    v_max_u32 v10, v10, v71
    v_cmp_eq_u32 vcc, -1, v10
    v_mfma_f32_16x16x32_bf16 v[52:55], v[64:67], v[64:67], v[52:55]
    s_cbranch_vccnz Bn_f30
Bn_o30:
    v_mfma_f32_16x16x32_bf16 v[44:47], v[172:175], v[68:71], v[44:47]
    buffer_load_dwordx4 v[72:75], v2, s[4:7], s49 offen offset:0 sc1
    v_mfma_f32_16x16x32_bf16 v[48:51], v[188:191], v[68:71], v[48:51]
    buffer_load_dwordx4 v[76:79], v2, s[4:7], s49 offen offset:1024 sc1
    ds_add_u32 v14, v13
    v_mfma_f32_16x16x32_bf16 v[52:55], v[68:71], v[68:71], v[52:55]
Bn_k0:
    s_waitcnt vmcnt(2)
    v_mfma_f32_16x16x32_bf16 v[96:99], v[160:163], v[56:59], v[44:47]
    v_max3_u32 v10, v56, v57, v58
    v_mfma_f32_16x16x32_bf16 v[100:103], v[176:179], v[56:59], v[48:51]
    v_max_u32 v10, v10, v59
    v_cmp_eq_u32 vcc, -1, v10
    v_mfma_f32_16x16x32_bf16 v[108:111], v[56:59], v[56:59], v[52:55]
    s_cbranch_vccz Bn_soft
    buffer_load_dwordx4 v[56:59], v2, s[4:7], s30 offen offset:0 sc1
    buffer_load_dwordx4 v[72:75], v2, s[4:7], s49 offen offset:0 sc1
    buffer_load_dwordx4 v[76:79], v2, s[4:7], s49 offen offset:1024 sc1
    s_sub_u32 s48, s48, 1
    s_cbranch_scc1 L_abort
    s_branch Bn_k0
Bn_o2301:
    v_mfma_f32_16x16x32_bf16 v[44:47], v[168:171], v[64:67], v[44:47]
    v_mfma_f32_16x16x32_bf16 v[48:51], v[184:187], v[64:67], v[48:51]
    s_waitcnt vmcnt(2)
    v_max3_u32 v10, v68, v69, v70
    v_max_u32 v10, v10, v71
    v_cmp_eq_u32 vcc, -1, v10
    v_mfma_f32_16x16x32_bf16 v[52:55], v[64:67], v[64:67], v[52:55]
    s_cbranch_vccnz Bn_f301
Bn_o301:
    v_mfma_f32_16x16x32_bf16 v[44:47], v[172:175], v[68:71], v[44:47]
    v_mfma_f32_16x16x32_bf16 v[48:51], v[188:191], v[68:71], v[48:51]
    s_waitcnt vmcnt(1)
    v_max3_u32 v10, v56, v57, v58
    v_max_u32 v10, v10, v59
    v_cmp_eq_u32 vcc, -1, v10
    v_mfma_f32_16x16x32_bf16 v[52:55], v[68:71], v[68:71], v[52:55]
    s_cbranch_vccnz Bn_f01
Bn_o01:
    v_mfma_f32_16x16x32_bf16 v[44:47], v[160:163], v[56:59], v[44:47]
    buffer_load_dwordx4 v[72:75], v2, s[4:7], s49 offen offset:0 sc1
    v_mfma_f32_16x16x32_bf16 v[48:51], v[176:179], v[56:59], v[48:51]
    buffer_load_dwordx4 v[76:79], v2, s[4:7], s49 offen offset:1024 sc1
    ds_add_u32 v14, v13
    v_mfma_f32_16x16x32_bf16 v[52:55], v[56:59], v[56:59], v[52:55]
Bn_k1:
    s_waitcnt vmcnt(2)
    v_mfma_f32_16x16x32_bf16 v[96:99], v[164:167], v[60:63], v[44:47]
    v_max3_u32 v10, v60, v61, v62
    v_mfma_f32_16x16x32_bf16 v[100:103], v[180:183], v[60:63], v[48:51]
    v_max_u32 v10, v10, v63
    v_cmp_eq_u32 vcc, -1, v10
    v_mfma_f32_16x16x32_bf16 v[108:111], v[60:63], v[60:63], v[52:55]
    s_cbranch_vccz Bn_soft
    buffer_load_dwordx4 v[60:63], v2, s[4:7], s30 offen offset:1024 sc1
    buffer_load_dwordx4 v[72:75], v2, s[4:7], s49 offen offset:0 sc1
    buffer_load_dwordx4 v[76:79], v2, s[4:7], s49 offen offset:1024 sc1
    s_sub_u32 s48, s48, 1
    s_cbranch_scc1 L_abort
    s_branch Bn_k1
Bn_o3012:
    v_mfma_f32_16x16x32_bf16 v[44:47], v[172:175], v[68:71], v[44:47]
    v_mfma_f32_16x16x32_bf16 v[48:51], v[188:191], v[68:71], v[48:51]
    s_waitcnt vmcnt(2)
    v_max3_u32 v10, v56, v57, v58
    v_max_u32 v10, v10, v59
    v_cmp_eq_u32 vcc, -1, v10
    v_mfma_f32_16x16x32_bf16 v[52:55], v[68:71], v[68:71], v[52:55]
    s_cbranch_vccnz Bn_f012
Bn_o012:
    v_mfma_f32_16x16x32_bf16 v[44:47], v[160:163], v[56:59], v[44:47]
    v_mfma_f32_16x16x32_bf16 v[48:51], v[176:179], v[56:59], v[48:51]
    s_waitcnt vmcnt(1)
    v_max3_u32 v10, v60, v61, v62
    v_max_u32 v10, v10, v63
    v_cmp_eq_u32 vcc, -1, v10
    v_mfma_f32_16x16x32_bf16 v[52:55], v[56:59], v[56:59], v[52:55]
    s_cbranch_vccnz Bn_f12
Bn_o12:
    v_mfma_f32_16x16x32_bf16 v[44:47], v[164:167], v[60:63], v[44:47]
    buffer_load_dwordx4 v[72:75], v2, s[4:7], s49 offen offset:0 sc1
    v_mfma_f32_16x16x32_bf16 v[48:51], v[180:183], v[60:63], v[48:51]
    buffer_load_dwordx4 v[76:79], v2, s[4:7], s49 offen offset:1024 sc1
    ds_add_u32 v14, v13
    v_mfma_f32_16x16x32_bf16 v[52:55], v[60:63], v[60:63], v[52:55]
Bn_k2:
    s_waitcnt vmcnt(2)
    v_mfma_f32_16x16x32_bf16 v[96:99], v[168:171], v[64:67], v[44:47]
    v_max3_u32 v10, v64, v65, v66
    v_mfma_f32_16x16x32_bf16 v[100:103], v[184:187], v[64:67], v[48:51]
    v_max_u32 v10, v10, v67
    v_cmp_eq_u32 vcc, -1, v10
    v_mfma_f32_16x16x32_bf16 v[108:111], v[64:67], v[64:67], v[52:55]
    s_cbranch_vccz Bn_soft
    buffer_load_dwordx4 v[64:67], v2, s[4:7], s30 offen offset:2048 sc1
    buffer_load_dwordx4 v[72:75], v2, s[4:7], s49 offen offset:0 sc1
    buffer_load_dwordx4 v[76:79], v2, s[4:7], s49 offen offset:1024 sc1
    s_sub_u32 s48, s48, 1
    s_cbranch_scc1 L_abort
    s_branch Bn_k2
Bn_o120:
    v_mfma_f32_16x16x32_bf16 v[44:47], v[164:167], v[60:63], v[44:47]
    v_mfma_f32_16x16x32_bf16 v[48:51], v[180:183], v[60:63], v[48:51]
    s_waitcnt vmcnt(1)
    v_max3_u32 v10, v64, v65, v66
    v_max_u32 v10, v10, v67
    v_cmp_eq_u32 vcc, -1, v10
    v_mfma_f32_16x16x32_bf16 v[52:55], v[60:63], v[60:63], v[52:55]
    s_cbranch_vccnz Bn_f20
    s_branch Bn_o20
Bn_o201:
    v_mfma_f32_16x16x32_bf16 v[44:47], v[168:171], v[64:67], v[44:47]
    v_mfma_f32_16x16x32_bf16 v[48:51], v[184:187], v[64:67], v[48:51]
    s_waitcnt vmcnt(1)
    v_max3_u32 v10, v56, v57, v58
    v_max_u32 v10, v10, v59
    v_cmp_eq_u32 vcc, -1, v10
    v_mfma_f32_16x16x32_bf16 v[52:55], v[64:67], v[64:67], v[52:55]
    s_cbranch_vccnz Bn_f01
    s_branch Bn_o01
Bn_o013:
    v_mfma_f32_16x16x32_bf16 v[44:47], v[160:163], v[56:59], v[44:47]
    v_mfma_f32_16x16x32_bf16 v[48:51], v[176:179], v[56:59], v[48:51]
    s_waitcnt vmcnt(1)
    v_max3_u32 v10, v60, v61, v62
    v_max_u32 v10, v10, v63
    v_cmp_eq_u32 vcc, -1, v10
    v_mfma_f32_16x16x32_bf16 v[52:55], v[56:59], v[56:59], v[52:55]
    s_cbranch_vccnz Bn_f13
    s_branch Bn_o13
Bn_o130:
    v_mfma_f32_16x16x32_bf16 v[44:47], v[164:167], v[60:63], v[44:47]
    v_mfma_f32_16x16x32_bf16 v[48:51], v[180:183], v[60:63], v[48:51]
    s_waitcnt vmcnt(1)
    v_max3_u32 v10, v68, v69, v70
    v_max_u32 v10, v10, v71
    v_cmp_eq_u32 vcc, -1, v10
    v_mfma_f32_16x16x32_bf16 v[52:55], v[60:63], v[60:63], v[52:55]
    s_cbranch_vccnz Bn_f30
    s_branch Bn_o30
Bn_o023:
    v_mfma_f32_16x16x32_bf16 v[44:47], v[160:163], v[56:59], v[44:47]
    v_mfma_f32_16x16x32_bf16 v[48:51], v[176:179], v[56:59], v[48:51]
    s_waitcnt vmcnt(1)
    v_max3_u32 v10, v64, v65, v66
    v_max_u32 v10, v10, v67
    v_cmp_eq_u32 vcc, -1, v10
    v_mfma_f32_16x16x32_bf16 v[52:55], v[56:59], v[56:59], v[52:55]
    s_cbranch_vccnz Bn_f23
    s_branch Bn_o23
Bn_o302:
    v_mfma_f32_16x16x32_bf16 v[44:47], v[172:175], v[68:71], v[44:47]
    v_mfma_f32_16x16x32_bf16 v[48:51], v[188:191], v[68:71], v[48:51]
    s_waitcnt vmcnt(1)
    v_max3_u32 v10, v56, v57, v58
    v_max_u32 v10, v10, v59
    v_cmp_eq_u32 vcc, -1, v10
    v_mfma_f32_16x16x32_bf16 v[52:55], v[68:71], v[68:71], v[52:55]
    s_cbranch_vccnz Bn_f02
    s_branch Bn_o02
Bn_o231:
    v_mfma_f32_16x16x32_bf16 v[44:47], v[168:171], v[64:67], v[44:47]
    v_mfma_f32_16x16x32_bf16 v[48:51], v[184:187], v[64:67], v[48:51]
    s_waitcnt vmcnt(1)
    v_max3_u32 v10, v68, v69, v70
    v_max_u32 v10, v10, v71
    v_cmp_eq_u32 vcc, -1, v10
    v_mfma_f32_16x16x32_bf16 v[52:55], v[64:67], v[64:67], v[52:55]
    s_cbranch_vccnz Bn_f31
    s_branch Bn_o31
Bn_o312:
    v_mfma_f32_16x16x32_bf16 v[44:47], v[172:175], v[68:71], v[44:47]
    v_mfma_f32_16x16x32_bf16 v[48:51], v[188:191], v[68:71], v[48:51]
    s_waitcnt vmcnt(1)
    v_max3_u32 v10, v60, v61, v62
    v_max_u32 v10, v10, v63
    v_cmp_eq_u32 vcc, -1, v10
    v_mfma_f32_16x16x32_bf16 v[52:55], v[68:71], v[68:71], v[52:55]
    s_cbranch_vccnz Bn_f12
    s_branch Bn_o12
Bn_o10:
    v_mfma_f32_16x16x32_bf16 v[44:47], v[164:167], v[60:63], v[44:47]
    buffer_load_dwordx4 v[72:75], v2, s[4:7], s49 offen offset:0 sc1
    v_mfma_f32_16x16x32_bf16 v[48:51], v[180:183], v[60:63], v[48:51]
    buffer_load_dwordx4 v[76:79], v2, s[4:7], s49 offen offset:1024 sc1
    ds_add_u32 v14, v13
    v_mfma_f32_16x16x32_bf16 v[52:55], v[60:63], v[60:63], v[52:55]
    s_branch Bn_k0
Bn_o02:
    v_mfma_f32_16x16x32_bf16 v[44:47], v[160:163], v[56:59], v[44:47]
    buffer_load_dwordx4 v[72:75], v2, s[4:7], s49 offen offset:0 sc1
    v_mfma_f32_16x16x32_bf16 v[48:51], v[176:179], v[56:59], v[48:51]
    buffer_load_dwordx4 v[76:79], v2, s[4:7], s49 offen offset:1024 sc1
    ds_add_u32 v14, v13
    v_mfma_f32_16x16x32_bf16 v[52:55], v[56:59], v[56:59], v[52:55]
    s_branch Bn_k2
Bn_o20:
    v_mfma_f32_16x16x32_bf16 v[44:47], v[168:171], v[64:67], v[44:47]
    buffer_load_dwordx4 v[72:75], v2, s[4:7], s49 offen offset:0 sc1
    v_mfma_f32_16x16x32_bf16 v[48:51], v[184:187], v[64:67], v[48:51]
    buffer_load_dwordx4 v[76:79], v2, s[4:7], s49 offen offset:1024 sc1
    ds_add_u32 v14, v13
    v_mfma_f32_16x16x32_bf16 v[52:55], v[64:67], v[64:67], v[52:55]
    s_branch Bn_k0
Bn_o03:
    v_mfma_f32_16x16x32_bf16 v[44:47], v[160:163], v[56:59], v[44:47]
    buffer_load_dwordx4 v[72:75], v2, s[4:7], s49 offen offset:0 sc1
    v_mfma_f32_16x16x32_bf16 v[48:51], v[176:179], v[56:59], v[48:51]
    buffer_load_dwordx4 v[76:79], v2, s[4:7], s49 offen offset:1024 sc1
    ds_add_u32 v14, v13
    v_mfma_f32_16x16x32_bf16 v[52:55], v[56:59], v[56:59], v[52:55]
    s_branch Bn_k3
Bn_o21:
    v_mfma_f32_16x16x32_bf16 v[44:47], v[168:171], v[64:67], v[44:47]
    buffer_load_dwordx4 v[72:75], v2, s[4:7], s49 offen offset:0 sc1
    v_mfma_f32_16x16x32_bf16 v[48:51], v[184:187], v[64:67], v[48:51]
    buffer_load_dwordx4 v[76:79], v2, s[4:7], s49 offen offset:1024 sc1
    ds_add_u32 v14, v13
    v_mfma_f32_16x16x32_bf16 v[52:55], v[64:67], v[64:67], v[52:55]
    s_branch Bn_k1
Bn_o13:
    v_mfma_f32_16x16x32_bf16 v[44:47], v[164:167], v[60:63], v[44:47]
    buffer_load_dwordx4 v[72:75], v2, s[4:7], s49 offen offset:0 sc1
    v_mfma_f32_16x16x32_bf16 v[48:51], v[180:183], v[60:63], v[48:51]
    buffer_load_dwordx4 v[76:79], v2, s[4:7], s49 offen offset:1024 sc1
    ds_add_u32 v14, v13
    v_mfma_f32_16x16x32_bf16 v[52:55], v[60:63], v[60:63], v[52:55]
    s_branch Bn_k3
Bn_o31:
    v_mfma_f32_16x16x32_bf16 v[44:47], v[172:175], v[68:71], v[44:47]
    buffer_load_dwordx4 v[72:75], v2, s[4:7], s49 offen offset:0 sc1
    v_mfma_f32_16x16x32_bf16 v[48:51], v[188:191], v[68:71], v[48:51]
    buffer_load_dwordx4 v[76:79], v2, s[4:7], s49 offen offset:1024 sc1
    ds_add_u32 v14, v13
    v_mfma_f32_16x16x32_bf16 v[52:55], v[68:71], v[68:71], v[52:55]
    s_branch Bn_k1
Bn_o32:
    v_mfma_f32_16x16x32_bf16 v[44:47], v[172:175], v[68:71], v[44:47]
    buffer_load_dwordx4 v[72:75], v2, s[4:7], s49 offen offset:0 sc1
    v_mfma_f32_16x16x32_bf16 v[48:51], v[188:191], v[68:71], v[48:51]
    buffer_load_dwordx4 v[76:79], v2, s[4:7], s49 offen offset:1024 sc1
    ds_add_u32 v14, v13
    v_mfma_f32_16x16x32_bf16 v[52:55], v[68:71], v[68:71], v[52:55]
    s_branch Bn_k2
Bn_f0123:
    buffer_load_dwordx4 v[56:59], v2, s[4:7], s30 offen offset:0 sc1
    s_sub_u32 s48, s48, 1
    s_cbranch_scc1 L_abort
    s_waitcnt vmcnt(3)
    v_max3_u32 v10, v60, v61, v62
    v_max_u32 v10, v10, v63
    v_cmp_eq_u32 vcc, -1, v10
    s_cbranch_vccz Bn_o1230
    s_branch Bn_f1230
Bn_f123:
    buffer_load_dwordx4 v[60:63], v2, s[4:7], s30 offen offset:1024 sc1
    s_sub_u32 s48, s48, 1
    s_cbranch_scc1 L_abort
    s_waitcnt vmcnt(2)
    v_max3_u32 v10, v64, v65, v66
    v_max_u32 v10, v10, v67
    v_cmp_eq_u32 vcc, -1, v10
    s_cbranch_vccz Bn_o231
    s_branch Bn_f231
Bn_f23:
    buffer_load_dwordx4 v[64:67], v2, s[4:7], s30 offen offset:2048 sc1
    s_sub_u32 s48, s48, 1
    s_cbranch_scc1 L_abort
    s_waitcnt vmcnt(1)
    v_max3_u32 v10, v68, v69, v70
    v_max_u32 v10, v10, v71
    v_cmp_eq_u32 vcc, -1, v10
    s_cbranch_vccz Bn_o32
    s_branch Bn_f32
Bn_f1230:
    buffer_load_dwordx4 v[60:63], v2, s[4:7], s30 offen offset:1024 sc1
    s_sub_u32 s48, s48, 1
    s_cbranch_scc1 L_abort
    s_waitcnt vmcnt(3)
    v_max3_u32 v10, v64, v65, v66
    v_max_u32 v10, v10, v67
    v_cmp_eq_u32 vcc, -1, v10
    s_cbranch_vccz Bn_o2301
    s_branch Bn_f2301
Bn_f230:
    buffer_load_dwordx4 v[64:67], v2, s[4:7], s30 offen offset:2048 sc1
    s_sub_u32 s48, s48, 1
    s_cbranch_scc1 L_abort
    s_waitcnt vmcnt(2)
    v_max3_u32 v10, v68, v69, v70
    v_max_u32 v10, v10, v71
    v_cmp_eq_u32 vcc, -1, v10
    s_cbranch_vccz Bn_o302
    s_branch Bn_f302
Bn_f30:
    buffer_load_dwordx4 v[68:71], v2, s[4:7], s30 offen offset:3072 sc1
    s_sub_u32 s48, s48, 1
    s_cbranch_scc1 L_abort
    s_waitcnt vmcnt(1)
    v_max3_u32 v10, v56, v57, v58
    v_max_u32 v10, v10, v59
    v_cmp_eq_u32 vcc, -1, v10
    s_cbranch_vccz Bn_o03
    s_branch Bn_f03
Bn_f2301:
    buffer_load_dwordx4 v[64:67], v2, s[4:7], s30 offen offset:2048 sc1
    s_sub_u32 s48, s48, 1
    s_cbranch_scc1 L_abort
    s_waitcnt vmcnt(3)
    v_max3_u32 v10, v68, v69, v70
    v_max_u32 v10, v10, v71
    v_cmp_eq_u32 vcc, -1, v10
    s_cbranch_vccz Bn_o3012
    s_branch Bn_f3012
Bn_f301:
    buffer_load_dwordx4 v[68:71], v2, s[4:7], s30 offen offset:3072 sc1
    s_sub_u32 s48, s48, 1
    s_cbranch_scc1 L_abort
    s_waitcnt vmcnt(2)
    v_max3_u32 v10, v56, v57, v58
    v_max_u32 v10, v10, v59
    v_cmp_eq_u32 vcc, -1, v10
    s_cbranch_vccz Bn_o013
    s_branch Bn_f013
Bn_f01:
    buffer_load_dwordx4 v[56:59], v2, s[4:7], s30 offen offset:0 sc1
    s_sub_u32 s48, s48, 1
    s_cbranch_scc1 L_abort
    s_waitcnt vmcnt(1)
    v_max3_u32 v10, v60, v61, v62
    v_max_u32 v10, v10, v63
    v_cmp_eq_u32 vcc, -1, v10
    s_cbranch_vccz Bn_o10
    s_branch Bn_f10
Bn_f3012:
    buffer_load_dwordx4 v[68:71], v2, s[4:7], s30 offen offset:3072 sc1
    s_sub_u32 s48, s48, 1
    s_cbranch_scc1 L_abort
    s_waitcnt vmcnt(3)
    v_max3_u32 v10, v56, v57, v58
    v_max_u32 v10, v10, v59
    v_cmp_eq_u32 vcc, -1, v10
    s_cbranch_vccz Bn_o0123
    s_branch Bn_f0123
Bn_f012:
    buffer_load_dwordx4 v[56:59], v2, s[4:7], s30 offen offset:0 sc1
    s_sub_u32 s48, s48, 1
    s_cbranch_scc1 L_abort
    s_waitcnt vmcnt(2)
    v_max3_u32 v10, v60, v61, v62
    v_max_u32 v10, v10, v63
    v_cmp_eq_u32 vcc, -1, v10
    s_cbranch_vccz Bn_o120
    s_branch Bn_f120
Bn_f12:
    buffer_load_dwordx4 v[60:63], v2, s[4:7], s30 offen offset:1024 sc1
    s_sub_u32 s48, s48, 1
    s_cbranch_scc1 L_abort
    s_waitcnt vmcnt(1)
    v_max3_u32 v10, v64, v65, v66
    v_max_u32 v10, v10, v67
    v_cmp_eq_u32 vcc, -1, v10
    s_cbranch_vccz Bn_o21
    s_branch Bn_f21
Bn_f120:
    buffer_load_dwordx4 v[60:63], v2, s[4:7], s30 offen offset:1024 sc1
    s_sub_u32 s48, s48, 1
    s_cbranch_scc1 L_abort
    s_waitcnt vmcnt(2)
    v_max3_u32 v10, v64, v65, v66
    v_max_u32 v10, v10, v67
    v_cmp_eq_u32 vcc, -1, v10
    s_cbranch_vccz Bn_o201
    s_branch Bn_f201
Bn_f201:
    buffer_load_dwordx4 v[64:67], v2, s[4:7], s30 offen offset:2048 sc1
    s_sub_u32 s48, s48, 1
    s_cbranch_scc1 L_abort
    s_waitcnt vmcnt(2)
    v_max3_u32 v10, v56, v57, v58
    v_max_u32 v10, v10, v59
    v_cmp_eq_u32 vcc, -1, v10
    s_cbranch_vccz Bn_o012
    s_branch Bn_f012
Bn_f013:
    buffer_load_dwordx4 v[56:59], v2, s[4:7], s30 offen offset:0 sc1
    s_sub_u32 s48, s48, 1
    s_cbranch_scc1 L_abort
    s_waitcnt vmcnt(2)
    v_max3_u32 v10, v60, v61, v62
    v_max_u32 v10, v10, v63
    v_cmp_eq_u32 vcc, -1, v10
    s_cbranch_vccz Bn_o130
    s_branch Bn_f130
Bn_f130:
    buffer_load_dwordx4 v[60:63], v2, s[4:7], s30 offen offset:1024 sc1
    s_sub_u32 s48, s48, 1
    s_cbranch_scc1 L_abort
    s_waitcnt vmcnt(2)
    v_max3_u32 v10, v68, v69, v70
    v_max_u32 v10, v10, v71
    v_cmp_eq_u32 vcc, -1, v10
    s_cbranch_vccz Bn_o301
    s_branch Bn_f301
Bn_f023:
    buffer_load_dwordx4 v[56:59], v2, s[4:7], s30 offen offset:0 sc1
    s_sub_u32 s48, s48, 1
    s_cbranch_scc1 L_abort
    s_waitcnt vmcnt(2)
    v_max3_u32 v10, v64, v65, v66
    v_max_u32 v10, v10, v67
    v_cmp_eq_u32 vcc, -1, v10
    s_cbranch_vccz Bn_o230
    s_branch Bn_f230
Bn_f302:
    buffer_load_dwordx4 v[68:71], v2, s[4:7], s30 offen offset:3072 sc1
    s_sub_u32 s48, s48, 1
    s_cbranch_scc1 L_abort
    s_waitcnt vmcnt(2)
    v_max3_u32 v10, v56, v57, v58
    v_max_u32 v10, v10, v59
    v_cmp_eq_u32 vcc, -1, v10
    s_cbranch_vccz Bn_o023
    s_branch Bn_f023
Bn_f231:
    buffer_load_dwordx4 v[64:67], v2, s[4:7], s30 offen offset:2048 sc1
    s_sub_u32 s48, s48, 1
    s_cbranch_scc1 L_abort
    s_waitcnt vmcnt(2)
    v_max3_u32 v10, v68, v69, v70
    v_max_u32 v10, v10, v71
    v_cmp_eq_u32 vcc, -1, v10
    s_cbranch_vccz Bn_o312
    s_branch Bn_f312
Bn_f312:
    buffer_load_dwordx4 v[68:71], v2, s[4:7], s30 offen offset:3072 sc1
    s_sub_u32 s48, s48, 1
    s_cbranch_scc1 L_abort
    s_waitcnt vmcnt(2)
    v_max3_u32 v10, v60, v61, v62
    v_max_u32 v10, v10, v63
    v_cmp_eq_u32 vcc, -1, v10
    s_cbranch_vccz Bn_o123
    s_branch Bn_f123
Bn_f10:
    buffer_load_dwordx4 v[60:63], v2, s[4:7], s30 offen offset:1024 sc1
    s_sub_u32 s48, s48, 1
    s_cbranch_scc1 L_abort
    s_waitcnt vmcnt(1)
    v_max3_u32 v10, v56, v57, v58
    v_max_u32 v10, v10, v59
    v_cmp_eq_u32 vcc, -1, v10
    s_cbranch_vccz Bn_o01
    s_branch Bn_f01
Bn_f02:
    buffer_load_dwordx4 v[56:59], v2, s[4:7], s30 offen offset:0 sc1
    s_sub_u32 s48, s48, 1
    s_cbranch_scc1 L_abort
    s_waitcnt vmcnt(1)
    v_max3_u32 v10, v64, v65, v66
    v_max_u32 v10, v10, v67
    v_cmp_eq_u32 vcc, -1, v10
    s_cbranch_vccz Bn_o20
    s_branch Bn_f20
Bn_f20:
    buffer_load_dwordx4 v[64:67], v2, s[4:7], s30 offen offset:2048 sc1
    s_sub_u32 s48, s48, 1
    s_cbranch_scc1 L_abort
    s_waitcnt vmcnt(1)
    v_max3_u32 v10, v56, v57, v58
    v_max_u32 v10, v10, v59
    v_cmp_eq_u32 vcc, -1, v10
    s_cbranch_vccz Bn_o02
    s_branch Bn_f02
Bn_f03:
    buffer_load_dwordx4 v[56:59], v2, s[4:7], s30 offen offset:0 sc1
    s_sub_u32 s48, s48, 1
    s_cbranch_scc1 L_abort
    s_waitcnt vmcnt(1)
    v_max3_u32 v10, v68, v69, v70
    v_max_u32 v10, v10, v71
    v_cmp_eq_u32 vcc, -1, v10
    s_cbranch_vccz Bn_o30
    s_branch Bn_f30
Bn_f21:
    buffer_load_dwordx4 v[64:67], v2, s[4:7], s30 offen offset:2048 sc1
    s_sub_u32 s48, s48, 1
    s_cbranch_scc1 L_abort
    s_waitcnt vmcnt(1)
    v_max3_u32 v10, v60, v61, v62
    v_max_u32 v10, v10, v63
    v_cmp_eq_u32 vcc, -1, v10
    s_cbranch_vccz Bn_o12
    s_branch Bn_f12
Bn_f13:
    buffer_load_dwordx4 v[60:63], v2, s[4:7], s30 offen offset:1024 sc1
    s_sub_u32 s48, s48, 1
    s_cbranch_scc1 L_abort
    s_waitcnt vmcnt(1)
    v_max3_u32 v10, v68, v69, v70
    v_max_u32 v10, v10, v71
    v_cmp_eq_u32 vcc, -1, v10
    s_cbranch_vccz Bn_o31
    s_branch Bn_f31
Bn_f31:
    buffer_load_dwordx4 v[68:71], v2, s[4:7], s30 offen offset:3072 sc1
    s_sub_u32 s48, s48, 1
    s_cbranch_scc1 L_abort
    s_waitcnt vmcnt(1)
    v_max3_u32 v10, v60, v61, v62
    v_max_u32 v10, v10, v63
    v_cmp_eq_u32 vcc, -1, v10
    s_cbranch_vccz Bn_o13
    s_branch Bn_f13
Bn_f32:
    buffer_load_dwordx4 v[68:71], v2, s[4:7], s30 offen offset:3072 sc1
    s_sub_u32 s48, s48, 1
    s_cbranch_scc1 L_abort
    s_waitcnt vmcnt(1)
    v_max3_u32 v10, v64, v65, v66
    v_max_u32 v10, v10, v67
    v_cmp_eq_u32 vcc, -1, v10
    s_cbranch_vccz Bn_o23
    s_branch Bn_f23
    .p2align 6
Bn_soft:
    s_nop 0
    s_nop 1
    v_max3_f32 v40, v96, v97, v98
    v_max3_f32 v40, v40, v99, v100
    v_max3_f32 v40, v40, v101, v102
    s_nop 0
    v_max3_f32 v40, v40, v103, v110
    v_max_f32 v41, v40, v111
    v_max_f32 v40, v40, v111
    s_nop 1
    v_permlane16_swap_b32 v40, v41
    v_max_f32 v42, v40, v41
    v_max_f32 v43, v40, v41
    s_nop 1
    v_permlane32_swap_b32 v42, v43
    v_max_f32 v40, v42, v43
    v_fma_f32 v16, v40, s54, v15
    v_fma_f32 v96, v96, s54, -v16
    v_fma_f32 v97, v97, s54, -v16
    v_exp_f32 v96, v96
    v_exp_f32 v97, v97
    s_waitcnt vmcnt(1)
    v_smfmac_f32_16x16x64_bf16 v[80:83], v[72:75], v[192:199], v1
    v_fma_f32 v98, v98, s54, -v16
    v_fma_f32 v99, v99, s54, -v16
    v_exp_f32 v98, v98
    v_smfmac_f32_16x16x64_bf16 v[84:87], v[72:75], v[208:215], v1
    v_exp_f32 v99, v99
    v_cvt_pk_bf16_f32 v36, v96, v97
    v_smfmac_f32_16x16x64_bf16 v[88:91], v[72:75], v[224:231], v1
    v_fma_f32 v100, v100, s54, -v16
    v_fma_f32 v101, v101, s54, -v16
    v_exp_f32 v100, v100
    v_smfmac_f32_16x16x64_bf16 v[92:95], v[72:75], v[240:247], v1
    v_exp_f32 v101, v101
    v_cvt_pk_bf16_f32 v37, v98, v99
    s_waitcnt vmcnt(0)
    v_smfmac_f32_16x16x64_bf16 v[80:83], v[76:79], v[200:207], v1
    v_fma_f32 v102, v102, s54, -v16
    v_fma_f32 v103, v103, s54, -v16
    v_exp_f32 v102, v102
    v_smfmac_f32_16x16x64_bf16 v[84:87], v[76:79], v[216:223], v1
    v_exp_f32 v103, v103
    v_cvt_pk_bf16_f32 v38, v100, v101
    v_smfmac_f32_16x16x64_bf16 v[88:91], v[76:79], v[232:239], v1
    v_fma_f32 v110, v110, s54, -v16
    v_fma_f32 v111, v111, s54, -v16
    v_exp_f32 v110, v110
    v_smfmac_f32_16x16x64_bf16 v[92:95], v[76:79], v[248:255], v1
    v_exp_f32 v111, v111
    v_cvt_pk_bf16_f32 v39, v102, v103
    v_cvt_pk_bf16_f32 v26, v110, v111
Bn_fin:
    v_mov_b32_dpp v104, v36 quad_perm:[2,3,0,1] row_mask:0xf bank_mask:0xf
    v_mfma_f32_16x16x32_bf16 v[40:43], v[30:33], v[36:39], 0
    v_mov_b32_dpp v105, v37 quad_perm:[2,3,0,1] row_mask:0xf bank_mask:0xf
    v_mov_b32_dpp v106, v38 quad_perm:[2,3,0,1] row_mask:0xf bank_mask:0xf
    v_mfma_f32_16x16x32_bf16 v[40:43], v[32:35], v[26:29], v[40:43]
    v_mov_b32_dpp v107, v39 quad_perm:[2,3,0,1] row_mask:0xf bank_mask:0xf
    v_mov_b32_dpp v28, v26 quad_perm:[2,3,0,1] row_mask:0xf bank_mask:0xf
    v_mfma_f32_16x16x32_bf16 v[96:99], v[112:115], v[36:39], 0
    v_add_f32 v80, v80, v82
    v_add_f32 v81, v81, v83
    v_mfma_f32_16x16x32_bf16 v[96:99], v[116:119], v[104:107], v[96:99]
    v_add_f32 v84, v84, v86
    v_add_f32 v85, v85, v87
    v_cvt_pk_bf16_f32 v18, v80, v81
    v_cvt_pk_bf16_f32 v20, v84, v85
    v_mfma_f32_16x16x32_bf16 v[100:103], v[120:123], v[36:39], 0
    v_add_f32_dpp v17, v40, v40 quad_perm:[2,3,0,1] row_mask:0xf bank_mask:0xf
    v_mfma_f32_16x16x32_bf16 v[96:99], v[18:21], v[26:29], v[96:99]
    v_add_f32 v88, v88, v90
    v_add_f32 v89, v89, v91
    v_add_f32 v92, v92, v94
    v_add_f32 v93, v93, v95
    v_mfma_f32_16x16x32_bf16 v[100:103], v[124:127], v[104:107], v[100:103]
    v_cvt_pk_bf16_f32 v22, v88, v89
    v_cvt_pk_bf16_f32 v24, v92, v93
    v_rcp_f32 v17, v17
    v_max3_u32 v10, v72, v73, v74
    v_mfma_f32_16x16x32_bf16 v[100:103], v[22:25], v[26:29], v[100:103]
    v_mul_f32 v96, v96, v17
    v_mul_f32 v97, v97, v17
    v_mul_f32 v98, v98, v17
    v_mul_f32 v99, v99, v17
    ds_write_b128 v6, v[96:99] offset:0
    v_max3_u32 v10, v10, v75, v76
    v_max3_u32 v10, v10, v77, v78
    v_max_u32 v10, v10, v79
    v_mul_f32 v100, v100, v17
    v_mul_f32 v101, v101, v17
    v_mul_f32 v102, v102, v17
    v_mul_f32 v103, v103, v17
    ds_write_b128 v6, v[100:103] offset:1152
    v_cmp_eq_u32 vcc, -1, v10
    s_cbranch_vccnz Bn_slow
    s_waitcnt lgkmcnt(0)
    s_barrier
    s_setprio 0
    buffer_store_dword v11, v0, s[4:7], s59 offen sc1
    s_min_u32 s34, s52, 31981568
    s_add_u32 s34, s34, s50
    s_buffer_load_dword s33, s[4:7], s34 offset:0
    s_buffer_load_dword s33, s[4:7], s34 offset:64
    s_buffer_load_dword s33, s[4:7], s34 offset:128
    s_buffer_load_dword s33, s[4:7], s34 offset:192
    s_buffer_load_dword s33, s[4:7], s34 offset:256
    s_buffer_load_dword s33, s[4:7], s34 offset:320
    s_buffer_load_dword s33, s[4:7], s34 offset:384
    s_buffer_load_dword s33, s[4:7], s34 offset:448
    s_add_u32 s53, s52, 536576
    s_cmp_ge_u32 s28, 62
    s_cselect_b32 s53, 2146435056, s53
    s_add_u32 s37, s52, 4096
    s_nop 15
    s_nop 15
    s_nop 11
    buffer_load_dwordx4 v[176:179], v8, s[4:7], s37 offen offset:0 sc1
    buffer_load_dwordx4 v[180:183], v8, s[4:7], s37 offen offset:1024 sc1
    buffer_load_dwordx4 v[184:187], v8, s[4:7], s37 offen offset:2048 sc1
    buffer_load_dwordx4 v[188:191], v8, s[4:7], s37 offen offset:3072 sc1
    v_mfma_f32_16x16x32_bf16 v[96:99], v[144:147], v[192:195], 0
    v_mfma_f32_16x16x32_bf16 v[96:99], v[148:151], v[196:199], v[96:99]
    v_mfma_f32_16x16x32_bf16 v[96:99], v[152:155], v[200:203], v[96:99]
    v_mfma_f32_16x16x32_bf16 v[96:99], v[156:159], v[204:207], v[96:99]
    v_mfma_f32_16x16x32_bf16 v[100:103], v[144:147], v[208:211], 0
    v_mfma_f32_16x16x32_bf16 v[100:103], v[148:151], v[212:215], v[100:103]
    v_mfma_f32_16x16x32_bf16 v[100:103], v[152:155], v[216:219], v[100:103]
    v_mfma_f32_16x16x32_bf16 v[100:103], v[156:159], v[220:223], v[100:103]
    v_mfma_f32_16x16x32_bf16 v[104:107], v[144:147], v[224:227], 0
    v_mfma_f32_16x16x32_bf16 v[104:107], v[148:151], v[228:231], v[104:107]
    v_mfma_f32_16x16x32_bf16 v[104:107], v[152:155], v[232:235], v[104:107]
    v_mfma_f32_16x16x32_bf16 v[104:107], v[156:159], v[236:239], v[104:107]
    v_mfma_f32_16x16x32_bf16 v[108:111], v[144:147], v[240:243], 0
    v_mfma_f32_16x16x32_bf16 v[108:111], v[148:151], v[244:247], v[108:111]
    v_mfma_f32_16x16x32_bf16 v[108:111], v[152:155], v[248:251], v[108:111]
    v_mfma_f32_16x16x32_bf16 v[108:111], v[156:159], v[252:255], v[108:111]
    v_mfma_f32_16x16x32_bf16 v[80:83], v[128:131], v[192:195], 0
    v_mfma_f32_16x16x32_bf16 v[80:83], v[132:135], v[196:199], v[80:83]
    v_mfma_f32_16x16x32_bf16 v[80:83], v[136:139], v[200:203], v[80:83]
    v_mfma_f32_16x16x32_bf16 v[80:83], v[140:143], v[204:207], v[80:83]
    v_mfma_f32_16x16x32_bf16 v[84:87], v[128:131], v[208:211], 0
    v_mfma_f32_16x16x32_bf16 v[84:87], v[132:135], v[212:215], v[84:87]
    v_mfma_f32_16x16x32_bf16 v[84:87], v[136:139], v[216:219], v[84:87]
    buffer_load_dwordx4 v[144:147], v8, s[4:7], s53 offen offset:0 sc1
    v_mfma_f32_16x16x32_bf16 v[84:87], v[140:143], v[220:223], v[84:87]
    buffer_load_dwordx4 v[148:151], v8, s[4:7], s53 offen offset:1024 sc1
    v_mfma_f32_16x16x32_bf16 v[88:91], v[128:131], v[224:227], 0
    buffer_load_dwordx4 v[152:155], v8, s[4:7], s53 offen offset:2048 sc1
    v_mfma_f32_16x16x32_bf16 v[88:91], v[132:135], v[228:231], v[88:91]
    buffer_load_dwordx4 v[156:159], v8, s[4:7], s53 offen offset:3072 sc1
    v_mfma_f32_16x16x32_bf16 v[88:91], v[136:139], v[232:235], v[88:91]
    v_mfma_f32_16x16x32_bf16 v[88:91], v[140:143], v[236:239], v[88:91]
    v_mfma_f32_16x16x32_bf16 v[92:95], v[128:131], v[240:243], 0
    v_mfma_f32_16x16x32_bf16 v[92:95], v[132:135], v[244:247], v[92:95]
    v_mfma_f32_16x16x32_bf16 v[92:95], v[136:139], v[248:251], v[92:95]
    v_mfma_f32_16x16x32_bf16 v[92:95], v[140:143], v[252:255], v[92:95]
    v_cvt_pk_bf16_f32 v114, v96, v97
    v_cvt_pk_bf16_f32 v115, v98, v99
    v_cvt_pk_bf16_f32 v118, v100, v101
    v_cvt_pk_bf16_f32 v119, v102, v103
    v_cvt_pk_bf16_f32 v122, v104, v105
    v_cvt_pk_bf16_f32 v123, v106, v107
    v_cvt_pk_bf16_f32 v126, v108, v109
    v_cvt_pk_bf16_f32 v127, v110, v111
    v_cvt_pk_bf16_f32 v112, v80, v81
    v_cvt_pk_bf16_f32 v113, v82, v83
    v_cvt_pk_bf16_f32 v116, v84, v85
    v_cvt_pk_bf16_f32 v117, v86, v87
    v_cvt_pk_bf16_f32 v120, v88, v89
    v_cvt_pk_bf16_f32 v121, v90, v91
    v_cvt_pk_bf16_f32 v124, v92, v93
    v_cvt_pk_bf16_f32 v125, v94, v95
    s_waitcnt lgkmcnt(0)
    s_cmp_lt_u32 s28, 54
    s_cbranch_scc1 Bn_t6
    s_waitcnt vmcnt(8)
    ds_add_u32 v14, v13 offset:256
    s_cmp_lg_u32 s60, 3
    s_cbranch_scc1 Bn_t6
    s_sub_u32 s35, s28, 53
    s_lshl_b32 s35, s35, 3
Bn_t7:
    ds_read_b32 v10, v9 offset:256
    s_sub_u32 s48, s48, 1
    s_cbranch_scc1 L_abort
    s_waitcnt lgkmcnt(0)
    v_cmp_gt_u32 vcc, s35, v10
    s_cbranch_vccnz Bn_t7
    s_add_u32 s35, s28, 1
    s_atomic_smax s35, s[4:5], s51
Bn_t6:
    s_buffer_load_dword s33, s[4:7], s34 offset:512
    s_buffer_load_dword s33, s[4:7], s34 offset:576
    s_buffer_load_dword s33, s[4:7], s34 offset:640
    s_buffer_load_dword s33, s[4:7], s34 offset:704
    s_buffer_load_dword s33, s[4:7], s34 offset:768
    s_buffer_load_dword s33, s[4:7], s34 offset:832
    s_buffer_load_dword s33, s[4:7], s34 offset:896
    s_buffer_load_dword s33, s[4:7], s34 offset:960
    s_add_u32 s28, s28, 1
    s_branch Bn_loop
Bn_slow:
    buffer_load_dwordx4 v[72:75], v2, s[4:7], s49 offen offset:0 sc1
    buffer_load_dwordx4 v[76:79], v2, s[4:7], s49 offen offset:1024 sc1
    s_sub_u32 s48, s48, 1
    s_cbranch_scc1 L_abort
    v_mov_b64 v[80:81], 0
    v_mov_b64 v[82:83], 0
    v_mov_b64 v[84:85], 0
    v_mov_b64 v[86:87], 0
    v_mov_b64 v[88:89], 0
    v_mov_b64 v[90:91], 0
    v_mov_b64 v[92:93], 0
    v_mov_b64 v[94:95], 0
    s_waitcnt vmcnt(0)
    v_smfmac_f32_16x16x64_bf16 v[80:83], v[72:75], v[192:199], v1
    v_smfmac_f32_16x16x64_bf16 v[84:87], v[72:75], v[208:215], v1
    v_smfmac_f32_16x16x64_bf16 v[88:91], v[72:75], v[224:231], v1
    v_smfmac_f32_16x16x64_bf16 v[92:95], v[72:75], v[240:247], v1
    v_smfmac_f32_16x16x64_bf16 v[80:83], v[76:79], v[200:207], v1
    v_smfmac_f32_16x16x64_bf16 v[84:87], v[76:79], v[216:223], v1
    v_smfmac_f32_16x16x64_bf16 v[88:91], v[76:79], v[232:239], v1
    v_smfmac_f32_16x16x64_bf16 v[92:95], v[76:79], v[248:255], v1
    s_nop 7
    s_branch Bn_fin
L_rec_lastB:
    buffer_store_dword v11, v0, s[4:7], s59 offen sc1
    s_waitcnt vmcnt(0)
    s_barrier
    s_cmp_lg_u32 s60, 3
    s_cbranch_scc1 L_done
    s_mov_b32 s35, 64
    s_atomic_smax s35, s[4:5], s51
    s_branch L_done
L_code_end:
    s_endpgm
.section .rodata,"a"
.p2align 6
.amdhsa_kernel concat_heads__memory_aug_recurrent_mem_tr__ssm_conv_h3__prompt_kernel
  .amdhsa_next_free_vgpr 256
  .amdhsa_next_free_sgpr 102
  .amdhsa_accum_offset 256
  .amdhsa_group_segment_fixed_size 0
  .amdhsa_kernarg_size 128
  .amdhsa_user_sgpr_count 2
  .amdhsa_user_sgpr_kernarg_segment_ptr 1
  .amdhsa_system_sgpr_workgroup_id_x 1
.end_amdhsa_kernel
```
